```python
import torch

def _softmax(x, axis=-1):
    return torch.softmax(x, dim=axis)
def _gelu(x):
    return torch.nn.functional.gelu(x, approximate="tanh")
def _silu(x):
    return torch.nn.functional.silu(x)
def _sigmoid(x):
    return torch.sigmoid(x)
def _layernorm(x, axis=-1, eps=1e-5):
    m = x.mean(dim=axis, keepdim=True)
    v = x.var(dim=axis, keepdim=True, unbiased=False)
    return (x - m) / torch.sqrt(v + eps)
def _scatter_add(tgt, idx, src, axis=0):
    return tgt.clone().index_add_(axis, idx, src)
def _segment_sum(src, seg, n):
    out = torch.zeros((n,) + src.shape[1:], dtype=src.dtype)
    return out.index_add_(0, seg, src)
def _pad(x, pw):
    flat = tuple(v for pair in reversed(pw) for v in pair)
    return torch.nn.functional.pad(x, flat)

kernel_name = 'standalone__edge_featured_mpnn_gatedgcn__graph'

def setup_inputs():

    _w = (lambda a: (lambda t: t.to(torch.bfloat16) if t.is_floating_point() else t)(torch.as_tensor(a)))
    N, deg, D, De = 10000, 32, 128, max(16, 1)
    E = N * deg
    return {
        "x": _w((lambda *s: torch.randn(*s, dtype=torch.bfloat16) * 0.4)(N, D)),
        "e_attr": _w((lambda *s: torch.randn(*s, dtype=torch.bfloat16) * 0.8)(E, De)),
        "src": _w((lambda lo, hi, *s: torch.randint(lo, hi, s))(0, N, E).to(torch.int64)),
        "dst": _w((lambda lo, hi, *s: torch.randint(lo, hi, s))(0, N, E).to(torch.int64)),
        "w_a": _w((lambda *s: torch.randn(*s, dtype=torch.bfloat16) * 0.4)(D, D)),
        "w_b": _w((lambda *s: torch.randn(*s, dtype=torch.bfloat16) * 0.4)(D, D)),
        "w_c": _w((lambda *s: torch.randn(*s, dtype=torch.bfloat16) * 0.8)(De, D)),
        "w_u": _w((lambda *s: torch.randn(*s, dtype=torch.bfloat16) * 0.05)(D, D)),
        "w_v": _w((lambda *s: torch.randn(*s, dtype=torch.bfloat16) * 0.05)(D, D)),
    }

def reference(x, e_attr, src, dst, w_a, w_b, w_c, w_u, w_v):
    N, D = x.shape
    hv = x @ w_v
    g = x[dst] @ w_a + x[src] @ w_b + e_attr @ w_c
    eta = _sigmoid(g)
    denom = _segment_sum(eta, dst, N) + 1e-6
    eta_n = eta / denom[dst]
    agg = _segment_sum(eta_n * hv[src], dst, N)
    z = x @ w_u + agg
    relu_z = torch.where(z > 0, z, 0 * z)
    return x + relu_z
```

```asm
; @launch kernel=k1_kernel grid=(256,1,1) block=(512,1,1) lds=92160
; @launch kernel=k2_kernel grid=(256,1,1) block=(512,1,1) lds=163840
.amdgcn_target "amdgcn-amd-amdhsa--gfx950"
.text
.globl k1_kernel
.p2align 8
.type k1_kernel,@function
k1_kernel:
    s_cmp_ge_u32 s2, 256
    s_cbranch_scc1 K1_END
    s_load_dwordx16 s[4:19], s[0:1], 0
    s_load_dwordx2 s[20:21], s[0:1], 64
    s_load_dwordx2 s[22:23], s[0:1], 88
    s_cmp_lt_u32 s2, 128
    s_cbranch_scc0 K1_NOPC
    s_getpc_b64 s[72:73]
K1_PC:
    s_add_u32 s72, s72, K1_PC-K1_PC
    s_addc_u32 s73, s73, 0
    s_mov_b32 s74, K2_CODE_END-K1_PC
    s_mov_b32 s75, 0x20000
    s_bfe_u32 s53, s2, 0x40003
    s_lshl_b32 s53, s53, 12
    v_lshlrev_b32 v33, 7, v0
    v_cmp_gt_u32 vcc, 32, v0
    s_and_saveexec_b64 s[80:81], vcc
    s_cbranch_execz K1_NOPC0
    buffer_load_dword v34, v33, s[72:75], s53 offen
K1_NOPC0:
    s_mov_b64 exec, s[80:81]
K1_NOPC:
    v_lshrrev_b32 v2, 6, v0
    v_lshlrev_b32 v1, 2, v0
    v_readfirstlane_b32 s52, v2
    v_lshlrev_b32 v2, 4, v0
    s_mov_b32 s60, 8192
    s_sub_u32 s58, s2, 128
    s_and_b32 s69, s2, 1
    v_and_b32 v56, 63, v0
    v_lshrrev_b32 v57, 4, v56
    v_and_b32 v58, 15, v0
    s_and_b32 s53, s52, 3
    s_lshl_b32 s53, s53, 2
    v_add_u32 v59, s53, v57
    v_xor_b32 v59, v59, v58
    v_lshlrev_b32 v59, 4, v59
    v_lshl_add_u32 v59, v57, 8, v59
    v_lshrrev_b32 v60, 3, v56
    v_and_b32 v61, 2, v60
    s_lshr_b32 s53, s2, 3
    s_add_u32 s53, s53, s52
    s_and_b32 s53, s53, 1
    s_lshl_b32 s53, s53, 2
    v_and_b32 v62, 7, v0
    v_xor_b32 v61, v61, v62
    v_xor_b32 v61, s53, v61
    v_lshlrev_b32 v61, 4, v61
    v_lshl_add_u32 v60, v60, 8, v61
    s_lshr_b32 s53, s2, 1
    s_mul_i32 s71, s53, 96
    s_mul_i32 s53, s53, 64
    s_add_u32 s53, s53, 2048
    s_cmp_lt_u32 s2, 128
    s_cselect_b32 s71, s71, s53
    s_cselect_b32 s76, 96, 64
    s_min_u32 s71, s71, 10000
    s_sub_u32 s53, 10000, s71
    s_min_u32 s76, s76, s53
    s_mul_i32 s54, s58, 10000
    s_cmp_lt_u32 s2, 252
    s_waitcnt lgkmcnt(0)
    s_cselect_b64 s[32:33], s[14:15], s[12:13]
    s_cselect_b64 s[36:37], s[20:21], s[18:19]
    s_cmp_lt_u32 s2, 128
    s_cbranch_scc1 K1_NOIDX
    s_add_u32 s28, s10, s54
    s_addc_u32 s29, s11, 0
    s_mov_b32 s30, 10000
    s_mov_b32 s31, 0x20000
    s_add_u32 s24, s8, s54
    s_addc_u32 s25, s9, 0
    s_mov_b32 s26, 10000
    s_mov_b32 s27, 0x20000
    buffer_load_dwordx4 v[4:7], v2, s[28:31], 0 offen
    buffer_load_dwordx4 v[12:15], v2, s[24:27], 0 offen
    buffer_load_dword v8, v1, s[28:31], s60 offen
    buffer_load_dword v16, v1, s[24:27], s60 offen
    s_barrier
K1_NOIDX:
    s_lshl_b32 s53, s71, 8
    s_add_u32 s40, s4, s53
    s_addc_u32 s41, s5, 0
    s_lshl_b32 s42, s76, 8
    s_mov_b32 s43, 0x20000
    s_cmp_lt_u32 s2, 254
    s_cselect_b32 s34, 32768, 0
    s_mov_b32 s35, 0x20000
    s_and_b32 s53, s2, 0xfe
    s_cmp_lg_u32 s53, 252
    s_cselect_b32 s38, 32768, 0
    s_mov_b32 s39, 0x20000
    s_lshl_b32 s70, s69, 7
    s_lshl_b32 s54, s52, 10
    s_add_u32 m0, s54, 67584
    s_add_u32 s55, s54, 0
    buffer_load_dwordx4 v59, s[40:43], s55 offen lds
    s_add_u32 m0, s54, 75776
    s_add_u32 s55, s54, 8192
    buffer_load_dwordx4 v59, s[40:43], s55 offen lds
    s_sub_u32 s53, s2, 128
    s_cmp_lt_u32 s53, 124
    s_cbranch_scc1 K1_LATER
    s_add_u32 m0, s54, 83968
    s_add_u32 s55, s54, 16384
    buffer_load_dwordx4 v59, s[40:43], s55 offen lds
    s_lshr_b32 s55, s2, 3
    s_add_u32 s55, s55, s52
    s_and_b32 s55, s55, 15
    s_lshl_b32 s53, s55, 10
    s_add_u32 m0, s53, 34816
    s_lshl_b32 s54, s55, 11
    s_add_u32 s54, s54, s70
    buffer_load_dwordx4 v60, s[32:35], s54 offen lds
    s_add_u32 m0, s53, 51200
    s_xor_b32 s55, s55, 8
    buffer_load_dwordx4 v60, s[36:39], s54 offen lds
    s_lshl_b32 s53, s55, 10
    s_add_u32 m0, s53, 34816
    s_lshl_b32 s54, s55, 11
    s_add_u32 s54, s54, s70
    buffer_load_dwordx4 v60, s[32:35], s54 offen lds
    s_add_u32 m0, s53, 51200
    s_xor_b32 s55, s55, 8
    buffer_load_dwordx4 v60, s[36:39], s54 offen lds
K1_LATER:
    s_and_b32 s57, s52, 1
    s_lshr_b32 s56, s52, 1
    v_bfe_u32 v61, v0, 2, 2
    v_bfe_u32 v62, v0, 3, 2
    s_lshl_b32 s53, s57, 1
    v_xor_b32 v62, s53, v62
    v_and_b32 v63, 3, v0
    v_lshlrev_b32 v63, 3, v63
    v_lshl_add_u32 v63, v62, 5, v63
    v_lshl_add_u32 v61, v57, 3, v61
    v_lshl_add_u32 v64, v61, 7, v63
    v_xor_b32 v70, 32, v64
    v_xor_b32 v65, v57, v58
    v_lshlrev_b32 v65, 4, v65
    v_lshl_add_u32 v65, v58, 8, v65
    s_lshl_b32 s53, s56, 12
    s_add_u32 s53, s53, 67584
    v_add_u32 v65, s53, v65
    v_xor_b32 v67, 64, v65
    v_xor_b32 v68, 0x80, v65
    v_xor_b32 v69, 0xc0, v65
    v_mul_u32_u24 v66, 512, v58
    v_lshl_add_u32 v66, v57, 4, v66
    s_mul_i32 s66, s56, 8192
    s_lshl_b32 s54, s69, 8
    s_add_u32 s66, s66, s54
    s_lshl_b32 s54, s57, 6
    s_add_u32 s66, s66, s54
    s_mov_b32 s63, 0xbfb8aa3b
    s_mov_b32 s64, 0x00800000
    s_mov_b32 s65, 0x7fffffff
    s_mov_b32 s67, 0x07060100
    s_mov_b32 s68, 0x07060302
    s_mul_i32 s53, s71, 512
    s_add_u32 s53, s53, 16777216
    s_mul_i32 s54, s76, 512
    s_add_u32 s48, s22, s53
    s_addc_u32 s49, s23, 0
    s_mov_b32 s50, s54
    s_mov_b32 s51, 0x20000
    s_cmp_lt_u32 s2, 128
    s_cbranch_scc1 K1_NOBIN
    v_mov_b32 v36, -1
    v_mov_b32 v37, -1
    v_mov_b32 v38, -1
    v_mov_b32 v39, -1
    v_mov_b32 v41, 0
    v_and_b32 v42, 0x3fc, v1
    ds_write_b128 v2, v[36:39] offset:1024
    ds_write_b128 v2, v[36:39] offset:9216
    ds_write_b128 v2, v[36:39] offset:17408
    ds_write_b128 v2, v[36:39] offset:25600
    ds_write_b32 v42, v41 offset:0
    s_lshl_b32 s53, s58, 7
    s_add_u32 s53, s53, 7340032
    s_add_u32 s44, s22, s53
    s_addc_u32 s45, s23, 0
    s_mov_b32 s46, 4194304
    s_mov_b32 s47, 0x20000
    s_lshl_b32 s53, s58, 9
    s_add_u32 s54, s53, 11665408
    s_add_u32 s72, s22, s54
    s_addc_u32 s73, s23, 0
    s_mov_b32 s74, 512
    s_mov_b32 s75, 0x20000
    v_add_u32 v46, s53, v1
    v_and_b32 v47, 0x7fff, v46
    v_cmp_ne_u32 vcc, 0x7c00, v47
    v_or_b32 v47, 3, v46
    s_nop 0
    v_addc_co_u32 v46, vcc, 0, v46, vcc
    v_cvt_f32_f16 v47, v47
    v_cvt_f32_f16 v46, v46
    v_exp_f32 v47, v47
    v_exp_f32 v46, v46
    v_add_f32 v47, 1.0, v47
    v_add_f32 v46, 1.0, v46
    v_rcp_f32 v47, v47
    v_rcp_f32 v46, v46
    s_mov_b32 s62, -10
    v_cvt_pk_bf16_f32 v46, v46, v47
    v_mov_b32 v41, 1
    v_cmp_gt_u32 vcc, 452, v0
    s_mov_b64 s[80:81], vcc
    v_lshrrev_b32 v43, 3, v0
    v_and_b32 v44, 7, v0
    v_lshlrev_b32 v45, 14, v43
    v_lshl_add_u32 v45, v44, 4, v45
    v_lshlrev_b32 v43, 2, v43
    v_cmp_eq_u32 s[82:83], 7, v44
    v_and_b32 v44, 4, v44
    v_lshlrev_b32 v44, 0, v44
    v_and_b32 v44, 16, v44
    s_waitcnt lgkmcnt(0)
    s_barrier
    s_cmp_ge_u32 s2, 252
    s_cbranch_scc1 K1_W7
    s_waitcnt vmcnt(2)
K1_W7:
    s_waitcnt vmcnt(7)
    v_mul_u32_u24 v20, 53687, v4
    v_add_u32 v20, 52500, v20
    v_lshrrev_b32 v20, 21, v20
    v_mul_u32_u24 v36, 625, v20
    v_lshrrev_b32 v36, 4, v36
    v_sub_u32 v4, v4, v36
    v_mul_u32_u24 v36, 26, v4
    v_lshrrev_b32 v36, 8, v36
    v_mad_i32_i24 v4, v36, s62, v4
    v_lshl_or_b32 v4, v36, 30, v4
    v_lshlrev_b32 v36, 2, v20
    ds_add_rtn_u32 v28, v36, v41 offset:0
    v_mul_u32_u24 v21, 53687, v5
    v_add_u32 v21, 52500, v21
    v_lshrrev_b32 v21, 21, v21
    v_mul_u32_u24 v36, 625, v21
    v_lshrrev_b32 v36, 4, v36
    v_sub_u32 v5, v5, v36
    v_mul_u32_u24 v36, 26, v5
    v_lshrrev_b32 v36, 8, v36
    v_mad_i32_i24 v5, v36, s62, v5
    v_lshl_or_b32 v5, v36, 30, v5
    v_lshlrev_b32 v36, 2, v21
    ds_add_rtn_u32 v29, v36, v41 offset:0
    v_mul_u32_u24 v22, 53687, v6
    v_add_u32 v22, 52500, v22
    v_lshrrev_b32 v22, 21, v22
    v_mul_u32_u24 v36, 625, v22
    v_lshrrev_b32 v36, 4, v36
    v_sub_u32 v6, v6, v36
    v_mul_u32_u24 v36, 26, v6
    v_lshrrev_b32 v36, 8, v36
    v_mad_i32_i24 v6, v36, s62, v6
    v_lshl_or_b32 v6, v36, 30, v6
    v_lshlrev_b32 v36, 2, v22
    ds_add_rtn_u32 v30, v36, v41 offset:0
    v_mul_u32_u24 v23, 53687, v7
    v_add_u32 v23, 52500, v23
    v_lshrrev_b32 v23, 21, v23
    v_mul_u32_u24 v36, 625, v23
    v_lshrrev_b32 v36, 4, v36
    v_sub_u32 v7, v7, v36
    v_mul_u32_u24 v36, 26, v7
    v_lshrrev_b32 v36, 8, v36
    v_mad_i32_i24 v7, v36, s62, v7
    v_lshl_or_b32 v7, v36, 30, v7
    v_lshlrev_b32 v36, 2, v23
    ds_add_rtn_u32 v31, v36, v41 offset:0
    v_mul_u32_u24 v24, 53687, v8
    v_add_u32 v24, 52500, v24
    v_lshrrev_b32 v24, 21, v24
    v_mul_u32_u24 v36, 625, v24
    v_lshrrev_b32 v36, 4, v36
    v_sub_u32 v8, v8, v36
    v_mul_u32_u24 v36, 26, v8
    v_lshrrev_b32 v36, 8, v36
    v_mad_i32_i24 v8, v36, s62, v8
    v_lshl_or_b32 v8, v36, 30, v8
    v_lshlrev_b32 v36, 2, v24
    s_mov_b64 exec, s[80:81]
    ds_add_rtn_u32 v32, v36, v41 offset:0
    s_mov_b64 exec, -1
    s_cmp_ge_u32 s2, 252
    s_cbranch_scc1 K1_NOWC
    s_lshr_b32 s55, s2, 3
    s_add_u32 s55, s55, s52
    s_and_b32 s55, s55, 15
    s_lshl_b32 s53, s55, 10
    s_add_u32 m0, s53, 34816
    s_lshl_b32 s54, s55, 11
    s_add_u32 s54, s54, s70
    buffer_load_dwordx4 v60, s[32:35], s54 offen lds
    s_add_u32 m0, s53, 51200
    s_xor_b32 s55, s55, 8
    buffer_load_dwordx4 v60, s[36:39], s54 offen lds
    s_lshl_b32 s53, s55, 10
    s_add_u32 m0, s53, 34816
    s_lshl_b32 s54, s55, 11
    s_add_u32 s54, s54, s70
    buffer_load_dwordx4 v60, s[32:35], s54 offen lds
    s_add_u32 m0, s53, 51200
    s_xor_b32 s55, s55, 8
    buffer_load_dwordx4 v60, s[36:39], s54 offen lds
    s_cmp_eq_u32 s2, 250
    s_cbranch_scc0 K1_NOWC
    s_mov_b32 s24, s16
    s_mov_b32 s25, s17
    s_mov_b32 s26, 4096
    s_mov_b32 s27, 0x20000
    v_lshrrev_b32 v80, 5, v56
    v_and_b32 v81, 17, v0
    v_lshlrev_b32 v81, 2, v81
    v_bfe_u32 v82, v0, 1, 1
    v_lshl_add_u32 v81, v82, 5, v81
    v_bfe_u32 v82, v0, 2, 2
    v_lshl_add_u32 v81, v82, 3, v81
    v_lshl_add_u32 v81, v80, 11, v81
    s_bfe_u32 s54, s52, 0x10001
    s_lshl_b32 s54, s54, 7
    s_lshl_b32 s53, s57, 1
    s_add_u32 s54, s54, s53
    buffer_load_ushort v72, v81, s[24:27], s54 offen offset:0
    buffer_load_ushort v73, v81, s[24:27], s54 offen offset:256
    buffer_load_ushort v74, v81, s[24:27], s54 offen offset:512
    buffer_load_ushort v75, v81, s[24:27], s54 offen offset:768
    buffer_load_ushort v76, v81, s[24:27], s54 offen offset:1024
    buffer_load_ushort v77, v81, s[24:27], s54 offen offset:1280
    buffer_load_ushort v78, v81, s[24:27], s54 offen offset:1536
    buffer_load_ushort v79, v81, s[24:27], s54 offen offset:1792
K1_NOWC:
    v_lshl_or_b32 v4, v12, 16, v4
    v_add_u32 v12, 0, v1
    v_lshl_or_b32 v4, v12, 4, v4
    v_lshlrev_b32 v20, 7, v20
    v_lshl_or_b32 v5, v13, 16, v5
    v_add_u32 v13, 1, v1
    v_lshl_or_b32 v5, v13, 4, v5
    v_lshlrev_b32 v21, 7, v21
    v_lshl_or_b32 v6, v14, 16, v6
    v_add_u32 v14, 2, v1
    v_lshl_or_b32 v6, v14, 4, v6
    v_lshlrev_b32 v22, 7, v22
    v_lshl_or_b32 v7, v15, 16, v7
    v_add_u32 v15, 3, v1
    v_lshl_or_b32 v7, v15, 4, v7
    v_lshlrev_b32 v23, 7, v23
    v_lshl_or_b32 v8, v16, 16, v8
    v_add_u32 v16, 2048, v0
    v_lshl_or_b32 v8, v16, 4, v8
    v_lshlrev_b32 v24, 7, v24
    s_waitcnt lgkmcnt(4)
    v_and_b32 v36, 12, v28
    v_add_u32 v20, v20, v36
    v_and_b32 v36, 3, v28
    v_lshl_add_u32 v20, v36, 4, v20
    v_and_b32 v36, 16, v28
    v_lshl_add_u32 v20, v36, 2, v20
    v_cmpx_gt_u32 vcc, 32, v28
    ds_write_b32 v20, v4 offset:1024
    s_mov_b64 exec, -1
    s_waitcnt lgkmcnt(4)
    v_and_b32 v36, 12, v29
    v_add_u32 v21, v21, v36
    v_and_b32 v36, 3, v29
    v_lshl_add_u32 v21, v36, 4, v21
    v_and_b32 v36, 16, v29
    v_lshl_add_u32 v21, v36, 2, v21
    v_cmpx_gt_u32 vcc, 32, v29
    ds_write_b32 v21, v5 offset:1024
    s_mov_b64 exec, -1
    s_waitcnt lgkmcnt(4)
    v_and_b32 v36, 12, v30
    v_add_u32 v22, v22, v36
    v_and_b32 v36, 3, v30
    v_lshl_add_u32 v22, v36, 4, v22
    v_and_b32 v36, 16, v30
    v_lshl_add_u32 v22, v36, 2, v22
    v_cmpx_gt_u32 vcc, 32, v30
    ds_write_b32 v22, v6 offset:1024
    s_mov_b64 exec, -1
    s_waitcnt lgkmcnt(4)
    v_and_b32 v36, 12, v31
    v_add_u32 v23, v23, v36
    v_and_b32 v36, 3, v31
    v_lshl_add_u32 v23, v36, 4, v23
    v_and_b32 v36, 16, v31
    v_lshl_add_u32 v23, v36, 2, v23
    v_cmpx_gt_u32 vcc, 32, v31
    ds_write_b32 v23, v7 offset:1024
    s_mov_b64 exec, -1
    s_waitcnt lgkmcnt(4)
    s_mov_b64 exec, s[80:81]
    v_and_b32 v36, 12, v32
    v_add_u32 v24, v24, v36
    v_and_b32 v36, 3, v32
    v_lshl_add_u32 v24, v36, 4, v24
    v_and_b32 v36, 16, v32
    v_lshl_add_u32 v24, v36, 2, v24
    v_cmpx_gt_u32 vcc, 32, v32
    ds_write_b32 v24, v8 offset:1024
    s_mov_b64 exec, -1
    s_waitcnt vmcnt(0) lgkmcnt(0)
    s_barrier
    ds_read_b128 v[4:7], v2 offset:1024
    ds_read_b32 v20, v43 offset:0
    ds_read_b128 v[8:11], v2 offset:9216
    ds_read_b32 v21, v43 offset:256
    ds_read_b128 v[12:15], v2 offset:17408
    ds_read_b32 v22, v43 offset:512
    ds_read_b128 v[16:19], v2 offset:25600
    ds_read_b32 v23, v43 offset:768
    v_mov_b32 v38, -2
    s_mov_b32 s55, 0
    buffer_store_dword v46, v1, s[72:75], 0 offen sc1
    s_waitcnt lgkmcnt(6)
    v_cmp_lt_u32 vcc, 32, v20
    v_cmp_le_u32 s[78:79], v44, v20
    s_and_b64 vcc, vcc, s[82:83]
    s_nop 0
    v_cndmask_b32 v7, v7, v38, vcc
    s_mov_b64 exec, s[78:79]
    buffer_store_dwordx4 v[4:7], v45, s[44:47], s55 offen sc1
    s_mov_b64 exec, -1
    s_add_u32 s55, s55, 1048576
    s_waitcnt lgkmcnt(4)
    v_cmp_lt_u32 vcc, 32, v21
    v_cmp_le_u32 s[78:79], v44, v21
    s_and_b64 vcc, vcc, s[82:83]
    s_nop 0
    v_cndmask_b32 v11, v11, v38, vcc
    s_mov_b64 exec, s[78:79]
    buffer_store_dwordx4 v[8:11], v45, s[44:47], s55 offen sc1
    s_mov_b64 exec, -1
    s_add_u32 s55, s55, 1048576
    s_waitcnt lgkmcnt(2)
    v_cmp_lt_u32 vcc, 32, v22
    v_cmp_le_u32 s[78:79], v44, v22
    s_and_b64 vcc, vcc, s[82:83]
    s_nop 0
    v_cndmask_b32 v15, v15, v38, vcc
    s_mov_b64 exec, s[78:79]
    buffer_store_dwordx4 v[12:15], v45, s[44:47], s55 offen sc1
    s_mov_b64 exec, -1
    s_add_u32 s55, s55, 1048576
    s_waitcnt lgkmcnt(0)
    v_cmp_lt_u32 vcc, 32, v23
    v_cmp_le_u32 s[78:79], v44, v23
    s_and_b64 vcc, vcc, s[82:83]
    s_nop 0
    v_cndmask_b32 v19, v19, v38, vcc
    s_mov_b64 exec, s[78:79]
    buffer_store_dwordx4 v[16:19], v45, s[44:47], s55 offen sc1
    s_mov_b64 exec, -1
    s_add_u32 s55, s55, 1048576
    s_branch K1_STAGED2
K1_NOBIN:
    s_waitcnt vmcnt(0)
K1_STAGED:
    s_barrier
K1_STAGED2:
    s_cmp_eq_u32 s2, 250
    s_cbranch_scc1 K1_WC
    ds_read_b128 v[160:163], v65 offset:0
    ds_read_b128 v[164:167], v67 offset:0
    ds_read_b128 v[168:171], v68 offset:0
    ds_read_b128 v[172:175], v69 offset:0
    ds_read_b64_tr_b16 v[96:97], v64 offset:34816
    ds_read_b64_tr_b16 v[98:99], v64 offset:35328
    ds_read_b64_tr_b16 v[112:113], v70 offset:34816
    ds_read_b64_tr_b16 v[114:115], v70 offset:35328
    ds_read_b64_tr_b16 v[128:129], v64 offset:51200
    ds_read_b64_tr_b16 v[130:131], v64 offset:51712
    ds_read_b64_tr_b16 v[144:145], v70 offset:51200
    ds_read_b64_tr_b16 v[146:147], v70 offset:51712
    s_waitcnt lgkmcnt(6)
    ds_read_b64_tr_b16 v[100:101], v64 offset:38912
    ds_read_b64_tr_b16 v[102:103], v64 offset:39424
    ds_read_b64_tr_b16 v[116:117], v70 offset:38912
    ds_read_b64_tr_b16 v[118:119], v70 offset:39424
    ds_read_b64_tr_b16 v[132:133], v64 offset:55296
    ds_read_b64_tr_b16 v[134:135], v64 offset:55808
    ds_read_b64_tr_b16 v[148:149], v70 offset:55296
    ds_read_b64_tr_b16 v[150:151], v70 offset:55808
    s_waitcnt lgkmcnt(8)
    v_mfma_f32_16x16x32_bf16 v[176:179], v[96:99], v[160:163], 0
    v_mfma_f32_16x16x32_bf16 v[180:183], v[112:115], v[160:163], 0
    v_mfma_f32_16x16x32_bf16 v[184:187], v[128:131], v[160:163], 0
    v_mfma_f32_16x16x32_bf16 v[188:191], v[144:147], v[160:163], 0
    s_waitcnt lgkmcnt(6)
    ds_read_b64_tr_b16 v[104:105], v64 offset:43008
    ds_read_b64_tr_b16 v[106:107], v64 offset:43520
    ds_read_b64_tr_b16 v[120:121], v70 offset:43008
    ds_read_b64_tr_b16 v[122:123], v70 offset:43520
    ds_read_b64_tr_b16 v[136:137], v64 offset:59392
    ds_read_b64_tr_b16 v[138:139], v64 offset:59904
    ds_read_b64_tr_b16 v[152:153], v70 offset:59392
    ds_read_b64_tr_b16 v[154:155], v70 offset:59904
    s_waitcnt lgkmcnt(8)
    v_mfma_f32_16x16x32_bf16 v[176:179], v[100:103], v[164:167], v[176:179]
    v_mfma_f32_16x16x32_bf16 v[180:183], v[116:119], v[164:167], v[180:183]
    v_mfma_f32_16x16x32_bf16 v[184:187], v[132:135], v[164:167], v[184:187]
    v_mfma_f32_16x16x32_bf16 v[188:191], v[148:151], v[164:167], v[188:191]
    s_waitcnt lgkmcnt(6)
    ds_read_b64_tr_b16 v[108:109], v64 offset:47104
    ds_read_b64_tr_b16 v[110:111], v64 offset:47616
    ds_read_b64_tr_b16 v[124:125], v70 offset:47104
    ds_read_b64_tr_b16 v[126:127], v70 offset:47616
    ds_read_b64_tr_b16 v[140:141], v64 offset:63488
    ds_read_b64_tr_b16 v[142:143], v64 offset:64000
    ds_read_b64_tr_b16 v[156:157], v70 offset:63488
    ds_read_b64_tr_b16 v[158:159], v70 offset:64000
    s_waitcnt lgkmcnt(8)
    v_mfma_f32_16x16x32_bf16 v[176:179], v[104:107], v[168:171], v[176:179]
    v_mfma_f32_16x16x32_bf16 v[180:183], v[120:123], v[168:171], v[180:183]
    v_mfma_f32_16x16x32_bf16 v[184:187], v[136:139], v[168:171], v[184:187]
    v_mfma_f32_16x16x32_bf16 v[188:191], v[152:155], v[168:171], v[188:191]
    s_waitcnt lgkmcnt(0)
    s_cmp_ge_u32 s2, 252
    s_cbranch_scc1 K1_WT
    s_lshl_b32 s53, s56, 4
    s_add_u32 s53, s53, 64
    s_cmp_lt_u32 s53, s76
    s_cbranch_scc0 K1_ONE
    ds_read_b128 v[208:211], v65 offset:16384
    ds_read_b128 v[212:215], v67 offset:16384
    ds_read_b128 v[216:219], v68 offset:16384
    ds_read_b128 v[220:223], v69 offset:16384
    v_mfma_f32_16x16x32_bf16 v[176:179], v[108:111], v[172:175], v[176:179]
    v_mfma_f32_16x16x32_bf16 v[180:183], v[124:127], v[172:175], v[180:183]
    v_mfma_f32_16x16x32_bf16 v[184:187], v[140:143], v[172:175], v[184:187]
    v_mfma_f32_16x16x32_bf16 v[188:191], v[156:159], v[172:175], v[188:191]
    s_waitcnt lgkmcnt(0)
    v_mfma_f32_16x16x32_bf16 v[224:227], v[96:99], v[208:211], 0
    v_mfma_f32_16x16x32_bf16 v[228:231], v[112:115], v[208:211], 0
    v_mfma_f32_16x16x32_bf16 v[232:235], v[128:131], v[208:211], 0
    v_mfma_f32_16x16x32_bf16 v[236:239], v[144:147], v[208:211], 0
    v_mfma_f32_16x16x32_bf16 v[224:227], v[100:103], v[212:215], v[224:227]
    v_mfma_f32_16x16x32_bf16 v[228:231], v[116:119], v[212:215], v[228:231]
    v_mfma_f32_16x16x32_bf16 v[232:235], v[132:135], v[212:215], v[232:235]
    v_mul_f32 v176, s63, v176
    v_mul_f32 v178, s63, v178
    v_max_f32 v30, abs(v184), s64
    v_mfma_f32_16x16x32_bf16 v[236:239], v[148:151], v[212:215], v[236:239]
    v_bfi_b32 v184, s65, v30, v184
    v_max_f32 v31, abs(v186), s64
    v_bfi_b32 v186, s65, v31, v186
    v_mfma_f32_16x16x32_bf16 v[224:227], v[104:107], v[216:219], v[224:227]
    v_cvt_pk_bf16_f32 v176, v176, v178
    v_add_u32 v184, 0x8000, v184
    v_add_u32 v186, 0x8000, v186
    v_mfma_f32_16x16x32_bf16 v[228:231], v[120:123], v[216:219], v[228:231]
    v_sub_u32_sdwa v184, v184, v176 dst_sel:DWORD dst_unused:UNUSED_PAD src0_sel:DWORD src1_sel:WORD_0
    v_sub_u32_sdwa v186, v186, v176 dst_sel:DWORD dst_unused:UNUSED_PAD src0_sel:DWORD src1_sel:WORD_1
    v_perm_b32 v192, v184, v176, s67
    v_mfma_f32_16x16x32_bf16 v[232:235], v[136:139], v[216:219], v[232:235]
    v_perm_b32 v193, v186, v176, s68
    v_mul_f32 v180, s63, v180
    v_mul_f32 v182, s63, v182
    v_mfma_f32_16x16x32_bf16 v[236:239], v[152:155], v[216:219], v[236:239]
    v_max_f32 v30, abs(v188), s64
    v_bfi_b32 v188, s65, v30, v188
    v_max_f32 v31, abs(v190), s64
    v_mfma_f32_16x16x32_bf16 v[224:227], v[108:111], v[220:223], v[224:227]
    v_bfi_b32 v190, s65, v31, v190
    v_cvt_pk_bf16_f32 v180, v180, v182
    v_add_u32 v188, 0x8000, v188
    v_mfma_f32_16x16x32_bf16 v[228:231], v[124:127], v[220:223], v[228:231]
    v_add_u32 v190, 0x8000, v190
    v_sub_u32_sdwa v188, v188, v180 dst_sel:DWORD dst_unused:UNUSED_PAD src0_sel:DWORD src1_sel:WORD_0
    v_sub_u32_sdwa v190, v190, v180 dst_sel:DWORD dst_unused:UNUSED_PAD src0_sel:DWORD src1_sel:WORD_1
    v_mfma_f32_16x16x32_bf16 v[232:235], v[140:143], v[220:223], v[232:235]
    v_perm_b32 v194, v188, v180, s67
    v_perm_b32 v195, v190, v180, s68
    buffer_store_dwordx4 v[192:195], v66, s[48:51], s66 offen offset:0 sc1
    v_mfma_f32_16x16x32_bf16 v[236:239], v[156:159], v[220:223], v[236:239]
    v_mul_f32 v177, s63, v177
    v_mul_f32 v179, s63, v179
    v_max_f32 v30, abs(v185), s64
    v_bfi_b32 v185, s65, v30, v185
    v_max_f32 v31, abs(v187), s64
    v_bfi_b32 v187, s65, v31, v187
    v_cvt_pk_bf16_f32 v177, v177, v179
    v_add_u32 v185, 0x8000, v185
    v_add_u32 v187, 0x8000, v187
    v_sub_u32_sdwa v185, v185, v177 dst_sel:DWORD dst_unused:UNUSED_PAD src0_sel:DWORD src1_sel:WORD_0
    v_sub_u32_sdwa v187, v187, v177 dst_sel:DWORD dst_unused:UNUSED_PAD src0_sel:DWORD src1_sel:WORD_1
    v_perm_b32 v196, v185, v177, s67
    v_perm_b32 v197, v187, v177, s68
    v_mul_f32 v181, s63, v181
    v_mul_f32 v183, s63, v183
    v_max_f32 v30, abs(v189), s64
    v_bfi_b32 v189, s65, v30, v189
    v_max_f32 v31, abs(v191), s64
    v_bfi_b32 v191, s65, v31, v191
    v_cvt_pk_bf16_f32 v181, v181, v183
    v_add_u32 v189, 0x8000, v189
    v_add_u32 v191, 0x8000, v191
    v_sub_u32_sdwa v189, v189, v181 dst_sel:DWORD dst_unused:UNUSED_PAD src0_sel:DWORD src1_sel:WORD_0
    v_sub_u32_sdwa v191, v191, v181 dst_sel:DWORD dst_unused:UNUSED_PAD src0_sel:DWORD src1_sel:WORD_1
    v_perm_b32 v198, v189, v181, s67
    v_perm_b32 v199, v191, v181, s68
    buffer_store_dwordx4 v[196:199], v66, s[48:51], s66 offen offset:128 sc1
    s_add_u32 s66, s66, 32768
    v_mul_f32 v224, s63, v224
    v_mul_f32 v226, s63, v226
    v_max_f32 v30, abs(v232), s64
    v_bfi_b32 v232, s65, v30, v232
    v_max_f32 v31, abs(v234), s64
    v_bfi_b32 v234, s65, v31, v234
    v_cvt_pk_bf16_f32 v224, v224, v226
    v_add_u32 v232, 0x8000, v232
    v_add_u32 v234, 0x8000, v234
    v_sub_u32_sdwa v232, v232, v224 dst_sel:DWORD dst_unused:UNUSED_PAD src0_sel:DWORD src1_sel:WORD_0
    v_sub_u32_sdwa v234, v234, v224 dst_sel:DWORD dst_unused:UNUSED_PAD src0_sel:DWORD src1_sel:WORD_1
    v_perm_b32 v200, v232, v224, s67
    v_perm_b32 v201, v234, v224, s68
    v_mul_f32 v228, s63, v228
    v_mul_f32 v230, s63, v230
    v_max_f32 v30, abs(v236), s64
    v_bfi_b32 v236, s65, v30, v236
    v_max_f32 v31, abs(v238), s64
    v_bfi_b32 v238, s65, v31, v238
    v_cvt_pk_bf16_f32 v228, v228, v230
    v_add_u32 v236, 0x8000, v236
    v_add_u32 v238, 0x8000, v238
    v_sub_u32_sdwa v236, v236, v228 dst_sel:DWORD dst_unused:UNUSED_PAD src0_sel:DWORD src1_sel:WORD_0
    v_sub_u32_sdwa v238, v238, v228 dst_sel:DWORD dst_unused:UNUSED_PAD src0_sel:DWORD src1_sel:WORD_1
    v_perm_b32 v202, v236, v228, s67
    v_perm_b32 v203, v238, v228, s68
    buffer_store_dwordx4 v[200:203], v66, s[48:51], s66 offen offset:0 sc1
    v_mul_f32 v225, s63, v225
    v_mul_f32 v227, s63, v227
    v_max_f32 v30, abs(v233), s64
    v_bfi_b32 v233, s65, v30, v233
    v_max_f32 v31, abs(v235), s64
    v_bfi_b32 v235, s65, v31, v235
    v_cvt_pk_bf16_f32 v225, v225, v227
    v_add_u32 v233, 0x8000, v233
    v_add_u32 v235, 0x8000, v235
    v_sub_u32_sdwa v233, v233, v225 dst_sel:DWORD dst_unused:UNUSED_PAD src0_sel:DWORD src1_sel:WORD_0
    v_sub_u32_sdwa v235, v235, v225 dst_sel:DWORD dst_unused:UNUSED_PAD src0_sel:DWORD src1_sel:WORD_1
    v_perm_b32 v204, v233, v225, s67
    v_perm_b32 v205, v235, v225, s68
    v_mul_f32 v229, s63, v229
    v_mul_f32 v231, s63, v231
    v_max_f32 v30, abs(v237), s64
    v_bfi_b32 v237, s65, v30, v237
    v_max_f32 v31, abs(v239), s64
    v_bfi_b32 v239, s65, v31, v239
    v_cvt_pk_bf16_f32 v229, v229, v231
    v_add_u32 v237, 0x8000, v237
    v_add_u32 v239, 0x8000, v239
    v_sub_u32_sdwa v237, v237, v229 dst_sel:DWORD dst_unused:UNUSED_PAD src0_sel:DWORD src1_sel:WORD_0
    v_sub_u32_sdwa v239, v239, v229 dst_sel:DWORD dst_unused:UNUSED_PAD src0_sel:DWORD src1_sel:WORD_1
    v_perm_b32 v206, v237, v229, s67
    v_perm_b32 v207, v239, v229, s68
    buffer_store_dwordx4 v[204:207], v66, s[48:51], s66 offen offset:128 sc1
    s_branch K1_TAIL
K1_ONE:
    v_mfma_f32_16x16x32_bf16 v[176:179], v[108:111], v[172:175], v[176:179]
    v_mfma_f32_16x16x32_bf16 v[180:183], v[124:127], v[172:175], v[180:183]
    v_mfma_f32_16x16x32_bf16 v[184:187], v[140:143], v[172:175], v[184:187]
    v_mfma_f32_16x16x32_bf16 v[188:191], v[156:159], v[172:175], v[188:191]
    s_nop 7
    v_mul_f32 v176, s63, v176
    v_mul_f32 v178, s63, v178
    v_max_f32 v30, abs(v184), s64
    v_bfi_b32 v184, s65, v30, v184
    v_max_f32 v31, abs(v186), s64
    v_bfi_b32 v186, s65, v31, v186
    v_cvt_pk_bf16_f32 v176, v176, v178
    v_add_u32 v184, 0x8000, v184
    v_add_u32 v186, 0x8000, v186
    v_sub_u32_sdwa v184, v184, v176 dst_sel:DWORD dst_unused:UNUSED_PAD src0_sel:DWORD src1_sel:WORD_0
    v_sub_u32_sdwa v186, v186, v176 dst_sel:DWORD dst_unused:UNUSED_PAD src0_sel:DWORD src1_sel:WORD_1
    v_perm_b32 v192, v184, v176, s67
    v_perm_b32 v193, v186, v176, s68
    v_mul_f32 v180, s63, v180
    v_mul_f32 v182, s63, v182
    v_max_f32 v30, abs(v188), s64
    v_bfi_b32 v188, s65, v30, v188
    v_max_f32 v31, abs(v190), s64
    v_bfi_b32 v190, s65, v31, v190
    v_cvt_pk_bf16_f32 v180, v180, v182
    v_add_u32 v188, 0x8000, v188
    v_add_u32 v190, 0x8000, v190
    v_sub_u32_sdwa v188, v188, v180 dst_sel:DWORD dst_unused:UNUSED_PAD src0_sel:DWORD src1_sel:WORD_0
    v_sub_u32_sdwa v190, v190, v180 dst_sel:DWORD dst_unused:UNUSED_PAD src0_sel:DWORD src1_sel:WORD_1
    v_perm_b32 v194, v188, v180, s67
    v_perm_b32 v195, v190, v180, s68
    buffer_store_dwordx4 v[192:195], v66, s[48:51], s66 offen offset:0 sc1
    v_mul_f32 v177, s63, v177
    v_mul_f32 v179, s63, v179
    v_max_f32 v30, abs(v185), s64
    v_bfi_b32 v185, s65, v30, v185
    v_max_f32 v31, abs(v187), s64
    v_bfi_b32 v187, s65, v31, v187
    v_cvt_pk_bf16_f32 v177, v177, v179
    v_add_u32 v185, 0x8000, v185
    v_add_u32 v187, 0x8000, v187
    v_sub_u32_sdwa v185, v185, v177 dst_sel:DWORD dst_unused:UNUSED_PAD src0_sel:DWORD src1_sel:WORD_0
    v_sub_u32_sdwa v187, v187, v177 dst_sel:DWORD dst_unused:UNUSED_PAD src0_sel:DWORD src1_sel:WORD_1
    v_perm_b32 v196, v185, v177, s67
    v_perm_b32 v197, v187, v177, s68
    v_mul_f32 v181, s63, v181
    v_mul_f32 v183, s63, v183
    v_max_f32 v30, abs(v189), s64
    v_bfi_b32 v189, s65, v30, v189
    v_max_f32 v31, abs(v191), s64
    v_bfi_b32 v191, s65, v31, v191
    v_cvt_pk_bf16_f32 v181, v181, v183
    v_add_u32 v189, 0x8000, v189
    v_add_u32 v191, 0x8000, v191
    v_sub_u32_sdwa v189, v189, v181 dst_sel:DWORD dst_unused:UNUSED_PAD src0_sel:DWORD src1_sel:WORD_0
    v_sub_u32_sdwa v191, v191, v181 dst_sel:DWORD dst_unused:UNUSED_PAD src0_sel:DWORD src1_sel:WORD_1
    v_perm_b32 v198, v189, v181, s67
    v_perm_b32 v199, v191, v181, s68
    buffer_store_dwordx4 v[196:199], v66, s[48:51], s66 offen offset:128 sc1
K1_TAIL:
    s_endpgm
K1_WT:
    s_add_u32 s48, s22, 11534336
    s_addc_u32 s49, s23, 0
    s_mov_b32 s50, 65536
    s_mov_b32 s51, 0x20000
    s_cmp_ge_u32 s52, 4
    s_cbranch_scc1 K1_END
    v_lshlrev_b32 v2, 4, v56
    s_and_b32 s53, s2, 3
    s_lshl_b32 s53, s53, 1
    s_add_u32 s53, s53, s57
    s_lshl_b32 s53, s53, 1
    s_add_u32 s53, s53, s56
    s_lshl_b32 s53, s53, 12
    s_and_b32 s54, s2, 2
    s_add_u32 s54, s54, s56
    s_cmp_eq_u32 s54, 0
    s_cbranch_scc0 K1_WT0
    buffer_store_dwordx4 v[96:99], v2, s[48:51], s53 offen offset:0 sc1
    buffer_store_dwordx4 v[100:103], v2, s[48:51], s53 offen offset:1024 sc1
    buffer_store_dwordx4 v[104:107], v2, s[48:51], s53 offen offset:2048 sc1
    buffer_store_dwordx4 v[108:111], v2, s[48:51], s53 offen offset:3072 sc1
    s_endpgm
K1_WT0:
    s_cmp_eq_u32 s54, 1
    s_cbranch_scc0 K1_WT1
    buffer_store_dwordx4 v[112:115], v2, s[48:51], s53 offen offset:0 sc1
    buffer_store_dwordx4 v[116:119], v2, s[48:51], s53 offen offset:1024 sc1
    buffer_store_dwordx4 v[120:123], v2, s[48:51], s53 offen offset:2048 sc1
    buffer_store_dwordx4 v[124:127], v2, s[48:51], s53 offen offset:3072 sc1
    s_endpgm
K1_WT1:
    s_cmp_eq_u32 s54, 2
    s_cbranch_scc0 K1_WT2
    buffer_store_dwordx4 v[128:131], v2, s[48:51], s53 offen offset:0 sc1
    buffer_store_dwordx4 v[132:135], v2, s[48:51], s53 offen offset:1024 sc1
    buffer_store_dwordx4 v[136:139], v2, s[48:51], s53 offen offset:2048 sc1
    buffer_store_dwordx4 v[140:143], v2, s[48:51], s53 offen offset:3072 sc1
    s_endpgm
K1_WT2:
    buffer_store_dwordx4 v[144:147], v2, s[48:51], s53 offen offset:0 sc1
    buffer_store_dwordx4 v[148:151], v2, s[48:51], s53 offen offset:1024 sc1
    buffer_store_dwordx4 v[152:155], v2, s[48:51], s53 offen offset:2048 sc1
    buffer_store_dwordx4 v[156:159], v2, s[48:51], s53 offen offset:3072 sc1
    s_endpgm
K1_WC:
    s_add_u32 s48, s22, 11599872
    s_addc_u32 s49, s23, 0
    s_mov_b32 s50, 4096
    s_mov_b32 s51, 0x20000
    v_lshlrev_b32 v2, 4, v56
    s_lshl_b32 s53, s52, 10
    v_lshlrev_b32 v72, 16, v72
    v_mul_f32 v72, s63, v72
    v_lshlrev_b32 v73, 16, v73
    v_mul_f32 v73, s63, v73
    v_lshlrev_b32 v74, 16, v74
    v_mul_f32 v74, s63, v74
    v_lshlrev_b32 v75, 16, v75
    v_mul_f32 v75, s63, v75
    v_lshlrev_b32 v76, 16, v76
    v_mul_f32 v76, s63, v76
    v_lshlrev_b32 v77, 16, v77
    v_mul_f32 v77, s63, v77
    v_lshlrev_b32 v78, 16, v78
    v_mul_f32 v78, s63, v78
    v_lshlrev_b32 v79, 16, v79
    v_mul_f32 v79, s63, v79
    v_cvt_pk_bf16_f32 v84, v72, v73
    v_cvt_pk_bf16_f32 v85, v74, v75
    v_cvt_pk_bf16_f32 v86, v76, v77
    v_cvt_pk_bf16_f32 v87, v78, v79
    buffer_store_dwordx4 v[84:87], v2, s[48:51], s53 offen sc1
K1_END:
    s_endpgm
.globl k2_kernel
.p2align 8
.type k2_kernel,@function
k2_kernel:
    s_cmp_ge_u32 s2, 256
    s_cbranch_scc1 K2_END
    s_load_dwordx8 s[4:11], s[0:1], 0
    s_load_dwordx2 s[12:13], s[0:1], 72
    s_load_dwordx2 s[14:15], s[0:1], 88
    v_lshrrev_b32 v160, 6, v0
    v_lshrrev_b32 v161, 2, v0
    v_readfirstlane_b32 s48, v160
    v_and_b32 v162, 3, v0
    v_lshlrev_b32 v163, 7, v161
    v_lshl_add_u32 v163, v162, 4, v163
    s_lshl_b32 s51, s2, 14
    s_add_u32 s51, s51, 7340032
    v_and_b32 v160, 63, v0
    v_lshlrev_b32 v165, 3, v160
    v_mov_b32 v96, 0
    v_mov_b32 v97, 0
    ds_write_b64 v165, v[96:97] offset:0
    s_and_b32 s49, s48, 3
    s_lshr_b32 s50, s48, 2
    v_lshlrev_b32 v3, 4, v160
    s_mov_b32 s52, 8192
    s_waitcnt lgkmcnt(0)
    s_cmp_lg_u32 s50, 0
    s_cbranch_scc1 K2_NOREC
    s_add_u32 s24, s14, s51
    s_addc_u32 s25, s15, 0
    s_mov_b32 s26, 16384
    s_mov_b32 s27, 0x20000
    buffer_load_dwordx4 v[208:211], v163, s[24:27], 0 offen offset:0
    buffer_load_dwordx4 v[216:219], v163, s[24:27], 0 offen offset:64
    buffer_load_dwordx4 v[212:215], v163, s[24:27], s52 offen offset:0
    buffer_load_dwordx4 v[220:223], v163, s[24:27], s52 offen offset:64
K2_NOREC:
    s_mul_i32 s51, s2, 625
    s_add_u32 s65, s51, 625
    s_lshr_b32 s51, s51, 4
    s_lshr_b32 s65, s65, 4
    s_sub_u32 s65, s65, s51
    s_lshl_b32 s65, s65, 8
    s_lshl_b32 s51, s51, 8
    s_add_u32 s28, s4, s51
    s_addc_u32 s29, s5, 0
    s_mov_b32 s30, s65
    s_mov_b32 s31, 0x20000
    s_add_u32 s44, s12, s51
    s_addc_u32 s45, s13, 0
    s_mov_b32 s46, s65
    s_mov_b32 s47, 0x20000
    s_add_u32 s32, s14, 11534336
    s_addc_u32 s33, s15, 0
    s_mov_b32 s34, 196608
    s_mov_b32 s35, 0x20000
    s_barrier
    s_cmp_lg_u32 s50, 0
    s_cbranch_scc1 K2_LOADER
    s_lshl_b32 s52, s50, 11
    s_add_u32 s52, s52, 65536
    buffer_load_dwordx4 v[8:11], v3, s[32:35], s52 offen
    buffer_load_dwordx4 v[12:15], v3, s[32:35], s52 offen offset:1024
    s_lshl_b32 s51, s50, 8
    s_add_u32 s51, s51, 16777088
    s_add_u32 s36, s14, s51
    s_addc_u32 s37, s15, 0
    s_or_b32 s37, s37, 0x40000
    s_mov_b32 s38, 64
    s_mov_b32 s39, 0x800000
    s_mov_b32 s40, s6
    s_mov_b32 s41, s7
    s_mov_b32 s42, 10240000
    s_mov_b32 s43, 0x20000
    s_mov_b32 s60, 0xffffffe0
    s_mov_b32 s61, 128
    s_mov_b32 s62, 0xc7b8aa3b
    s_mov_b32 s63, 0xfc
    s_mov_b32 s67, 0xfffe
    s_mov_b32 s64, 512
    s_mov_b32 s55, 0
    s_mov_b32 s56, 0
    s_mov_b32 s58, 0
    s_mov_b32 s80, 0
    s_mul_i32 s51, s50, 3
    s_xor_b32 s83, s49, s51
    v_lshrrev_b32 v98, 5, v160
    v_and_b32 v99, 31, v0
    v_lshlrev_b32 v1, 4, v98
    v_lshlrev_b32 v253, 8, v98
    v_and_b32 v100, 3, v0
    v_mov_b32 v102, 0x3f80
    v_cmp_eq_u32 vcc, 0, v100
    s_nop 1
    v_cndmask_b32 v24, 0, v102, vcc
    v_cmp_eq_u32 vcc, 1, v100
    s_nop 1
    v_cndmask_b32 v25, 0, v102, vcc
    v_cmp_eq_u32 vcc, 2, v100
    s_nop 1
    v_cndmask_b32 v26, 0, v102, vcc
    v_cmp_eq_u32 vcc, 3, v100
    s_nop 1
    v_cndmask_b32 v27, 0, v102, vcc
    v_cmp_gt_u32 s[78:79], 16, v99
    v_mov_b32 v101, 0x3fe
    v_mov_b32 v103, 0x4780
    v_cndmask_b32 v101, v103, v101, s[78:79]
    v_and_b32 v100, 15, v0
    v_lshlrev_b32 v104, 3, v98
    v_sub_u32 v100, v100, v104
    v_lshlrev_b32 v102, 16, v101
    v_cmp_eq_u32 vcc, 0, v100
    v_cmp_eq_u32 s[78:79], 1, v100
    s_nop 0
    v_cndmask_b32 v28, 0, v101, vcc
    v_cndmask_b32 v104, 0, v102, s[78:79]
    v_or_b32 v28, v28, v104
    v_cmp_eq_u32 vcc, 2, v100
    v_cmp_eq_u32 s[78:79], 3, v100
    s_nop 0
    v_cndmask_b32 v29, 0, v101, vcc
    v_cndmask_b32 v104, 0, v102, s[78:79]
    v_or_b32 v29, v29, v104
    v_cmp_eq_u32 vcc, 4, v100
    v_cmp_eq_u32 s[78:79], 5, v100
    s_nop 0
    v_cndmask_b32 v30, 0, v101, vcc
    v_cndmask_b32 v104, 0, v102, s[78:79]
    v_or_b32 v30, v30, v104
    v_cmp_eq_u32 vcc, 6, v100
    v_cmp_eq_u32 s[78:79], 7, v100
    s_nop 0
    v_cndmask_b32 v31, 0, v101, vcc
    v_cndmask_b32 v104, 0, v102, s[78:79]
    v_or_b32 v31, v31, v104
    v_and_b32 v163, 15, v0
    v_lshlrev_b32 v163, 4, v163
    v_bfe_u32 v164, v0, 4, 2
    v_lshl_add_u32 v163, v164, 10, v163
    s_lshl_b32 s51, s49, 8
    v_add_u32 v163, s51, v163
    v_add_u32 v164, 40960, v163
    v_mov_b32 v40, 0x3f003f00
    v_mov_b32 v41, 0x3f003f00
    v_mov_b32 v42, 0x3f003f00
    v_mov_b32 v43, 0x3f003f00
    ds_write_b128 v163, v[40:43] offset:40960
    ds_write_b128 v163, v[40:43] offset:44032
    ds_write_b128 v164, v[40:43] offset:32768
    ds_write_b128 v164, v[40:43] offset:35840
    v_mov_b32 v44, 0x0
    v_mov_b32 v45, 0x0
    v_mov_b32 v46, 0x0
    v_mov_b32 v47, 0x0
    ds_write_b128 v163, v[44:47] offset:64512
    ds_write_b128 v164, v[44:47] offset:27648
    v_mov_b32 v32, 0x3f803f80
    v_mov_b32 v33, 0x3f803f80
    v_mov_b32 v34, 0x3f803f80
    v_mov_b32 v35, 0x3f803f80
    ds_write_b128 v164, v[32:35] offset:52224
    ds_write_b128 v164, v[32:35] offset:56320
    ds_write_b128 v164, v[32:35] offset:60416
    v_and_b32 v163, 127, v0
    v_bfe_u32 v164, v0, 2, 4
    v_and_b32 v100, 3, v0
    v_lshrrev_b32 v101, 6, v163
    v_lshlrev_b32 v163, 2, v163
    v_lshl_add_u32 v100, v101, 2, v100
    v_lshlrev_b32 v101, 1, v100
    v_mov_b32 v102, 0x3780
    v_mov_b32 v103, 0x37800000
    v_cmp_eq_u32 vcc, v101, v164
    v_add_u32 v101, 1, v101
    s_nop 0
    v_cndmask_b32 v104, 0, v102, vcc
    v_cmp_eq_u32 vcc, v101, v164
    s_nop 1
    v_cndmask_b32 v105, 0, v103, vcc
    v_or_b32 v104, v104, v105
    v_cmp_gt_u32 vcc, 15, v164
    s_nop 1
    v_cndmask_b32 v104, 0, v104, vcc
    ds_write_b32 v163, v104 offset:1024
    v_mul_u32_u24 v110, 80000, v161
    v_add_u32 v111, 5120000, v110
    v_mov_b32 v163, 4
    v_mov_b32 v48, 128
    v_mov_b32 v49, 128
    v_mov_b32 v50, 128
    v_mov_b32 v51, 128
    v_mov_b32 v52, 128
    v_mov_b32 v53, 128
    v_mov_b32 v54, 128
    v_mov_b32 v55, 128
    v_mov_b32 v56, 128
    v_mov_b32 v57, 128
    v_mov_b32 v58, 128
    v_mov_b32 v59, 128
    v_mov_b32 v60, 128
    v_mov_b32 v61, 128
    v_mov_b32 v62, 128
    v_mov_b32 v63, 128
    s_waitcnt vmcnt(2)
    v_cmp_eq_u32 vcc, -2, v219
    v_cmp_eq_u32 s[78:79], -2, v223
    s_or_b64 vcc, vcc, s[78:79]
    s_cbranch_vccz K2_NOOVF
    v_mov_b32 v164, 0x10000
    v_mov_b32 v160, 60
    ds_add_u32 v160, v164 offset:0
K2_NOOVF:
    v_and_b32_sdwa v224, s63, v208 dst_sel:DWORD dst_unused:UNUSED_PAD src0_sel:DWORD src1_sel:BYTE_3
    v_and_b32_sdwa v225, s63, v209 dst_sel:DWORD dst_unused:UNUSED_PAD src0_sel:DWORD src1_sel:BYTE_3
    v_and_b32_sdwa v226, s63, v210 dst_sel:DWORD dst_unused:UNUSED_PAD src0_sel:DWORD src1_sel:BYTE_3
    v_and_b32_sdwa v227, s63, v211 dst_sel:DWORD dst_unused:UNUSED_PAD src0_sel:DWORD src1_sel:BYTE_3
    v_and_b32_sdwa v232, s63, v216 dst_sel:DWORD dst_unused:UNUSED_PAD src0_sel:DWORD src1_sel:BYTE_3
    v_and_b32_sdwa v233, s63, v217 dst_sel:DWORD dst_unused:UNUSED_PAD src0_sel:DWORD src1_sel:BYTE_3
    v_and_b32_sdwa v228, s63, v212 dst_sel:DWORD dst_unused:UNUSED_PAD src0_sel:DWORD src1_sel:BYTE_3
    v_and_b32_sdwa v229, s63, v213 dst_sel:DWORD dst_unused:UNUSED_PAD src0_sel:DWORD src1_sel:BYTE_3
    v_and_b32_sdwa v230, s63, v214 dst_sel:DWORD dst_unused:UNUSED_PAD src0_sel:DWORD src1_sel:BYTE_3
    v_and_b32_sdwa v231, s63, v215 dst_sel:DWORD dst_unused:UNUSED_PAD src0_sel:DWORD src1_sel:BYTE_3
    v_and_b32_sdwa v236, s63, v220 dst_sel:DWORD dst_unused:UNUSED_PAD src0_sel:DWORD src1_sel:BYTE_3
    v_and_b32_sdwa v237, s63, v221 dst_sel:DWORD dst_unused:UNUSED_PAD src0_sel:DWORD src1_sel:BYTE_3
    v_cmp_gt_u32 s[68:69], -2, v208
    v_cmp_gt_u32 s[70:71], -2, v209
    v_cmp_gt_u32 s[72:73], -2, v210
    v_cmp_gt_u32 s[74:75], -2, v211
    v_cmp_gt_u32 s[76:77], -2, v216
    v_cmp_gt_u32 s[78:79], -2, v217
    s_mov_b64 exec, s[68:69]
    ds_add_rtn_u32 v112, v224, v163 offset:0
    s_mov_b64 exec, s[70:71]
    ds_add_rtn_u32 v113, v225, v163 offset:0
    s_mov_b64 exec, s[72:73]
    ds_add_rtn_u32 v114, v226, v163 offset:0
    s_mov_b64 exec, s[74:75]
    ds_add_rtn_u32 v115, v227, v163 offset:0
    s_mov_b64 exec, s[76:77]
    ds_add_rtn_u32 v120, v232, v163 offset:0
    s_mov_b64 exec, s[78:79]
    ds_add_rtn_u32 v121, v233, v163 offset:0
    s_mov_b64 exec, -1
    v_cmp_gt_u32 s[68:69], -2, v212
    v_cmp_gt_u32 s[70:71], -2, v213
    v_cmp_gt_u32 s[72:73], -2, v214
    v_cmp_gt_u32 s[74:75], -2, v215
    v_cmp_gt_u32 s[76:77], -2, v220
    v_cmp_gt_u32 s[78:79], -2, v221
    s_mov_b64 exec, s[68:69]
    ds_add_rtn_u32 v116, v228, v163 offset:0
    s_mov_b64 exec, s[70:71]
    ds_add_rtn_u32 v117, v229, v163 offset:0
    s_mov_b64 exec, s[72:73]
    ds_add_rtn_u32 v118, v230, v163 offset:0
    s_mov_b64 exec, s[74:75]
    ds_add_rtn_u32 v119, v231, v163 offset:0
    s_mov_b64 exec, s[76:77]
    ds_add_rtn_u32 v124, v236, v163 offset:0
    s_mov_b64 exec, s[78:79]
    ds_add_rtn_u32 v125, v237, v163 offset:0
    s_mov_b64 exec, -1
    v_min_u32 v164, v218, v222
    v_cmp_gt_u32 s[26:27], -2, v164
    s_cmp_eq_u64 s[26:27], 0
    s_cbranch_scc1 K2_C1
    s_waitcnt lgkmcnt(0)
    v_cmpx_gt_u32 vcc, -2, v218
    s_cbranch_execz K2_C0
    v_and_b32_sdwa v234, s63, v218 dst_sel:DWORD dst_unused:UNUSED_PAD src0_sel:DWORD src1_sel:BYTE_3
    ds_add_rtn_u32 v122, v234, v163 offset:0
    v_cmpx_gt_u32 vcc, -2, v219
    s_cbranch_execz K2_C0
    v_and_b32_sdwa v235, s63, v219 dst_sel:DWORD dst_unused:UNUSED_PAD src0_sel:DWORD src1_sel:BYTE_3
    ds_add_rtn_u32 v123, v235, v163 offset:0
K2_C0:
    s_mov_b64 exec, -1
    v_cmpx_gt_u32 vcc, -2, v222
    s_cbranch_execz K2_C1
    v_and_b32_sdwa v238, s63, v222 dst_sel:DWORD dst_unused:UNUSED_PAD src0_sel:DWORD src1_sel:BYTE_3
    ds_add_rtn_u32 v126, v238, v163 offset:0
    v_cmpx_gt_u32 vcc, -2, v223
    s_cbranch_execz K2_C1
    v_and_b32_sdwa v239, s63, v223 dst_sel:DWORD dst_unused:UNUSED_PAD src0_sel:DWORD src1_sel:BYTE_3
    ds_add_rtn_u32 v127, v239, v163 offset:0
K2_C1:
    s_mov_b64 exec, -1
    v_mov_b32 v166, 256
    v_mov_b32 v167, 1
    s_mov_b64 exec, 1
    ds_add_u32 v166, v167
    s_mov_b64 exec, -1
    v_bfe_u32 v176, v208, 16, 14
    v_mad_u32_u16 v192, v208, 2, v110
    v_bfe_u32 v177, v209, 16, 14
    v_mad_u32_u16 v193, v209, 2, v110
    v_bfe_u32 v178, v210, 16, 14
    v_mad_u32_u16 v194, v210, 2, v110
    v_bfe_u32 v179, v211, 16, 14
    v_mad_u32_u16 v195, v211, 2, v110
    v_bfe_u32 v180, v216, 16, 14
    v_mad_u32_u16 v196, v216, 2, v110
    v_bfe_u32 v181, v217, 16, 14
    v_mad_u32_u16 v197, v217, 2, v110
    v_bfe_u32 v182, v212, 16, 14
    v_mad_u32_u16 v198, v212, 2, v111
    v_bfe_u32 v183, v213, 16, 14
    v_mad_u32_u16 v199, v213, 2, v111
    v_bfe_u32 v184, v214, 16, 14
    v_mad_u32_u16 v200, v214, 2, v111
    v_bfe_u32 v185, v215, 16, 14
    v_mad_u32_u16 v201, v215, 2, v111
    v_bfe_u32 v186, v220, 16, 14
    v_mad_u32_u16 v202, v220, 2, v111
    v_bfe_u32 v187, v221, 16, 14
    v_mad_u32_u16 v203, v221, 2, v111
    v_mul_u32_u24 v176, s64, v176
    v_mul_u32_u24 v177, s64, v177
    v_mul_u32_u24 v178, s64, v178
    v_mul_u32_u24 v179, s64, v179
    v_mul_u32_u24 v180, s64, v180
    v_mul_u32_u24 v181, s64, v181
    v_mul_u32_u24 v182, s64, v182
    v_mul_u32_u24 v183, s64, v183
    v_mul_u32_u24 v184, s64, v184
    v_mul_u32_u24 v185, s64, v185
    v_mul_u32_u24 v186, s64, v186
    v_mul_u32_u24 v187, s64, v187
    v_mov_b32 v166, 256
K2_SPINA:
    ds_read_b32 v167, v166
    s_waitcnt lgkmcnt(0)
    v_cmp_gt_u32 vcc, 4, v167
    s_cbranch_vccnz K2_SPINA
    v_and_b32 v160, 63, v0
    v_lshlrev_b32 v161, 2, v160
    ds_read_b32 v96, v161 offset:0
    v_lshrrev_b32 v160, 4, v160
    v_mul_u32_u24 v160, 1664, v160
    v_and_b32 v162, 31, v0
    v_lshlrev_b32 v162, 2, v162
    v_mov_b32 v164, 0xfffffe
    s_waitcnt lgkmcnt(0)
    v_sub_u32 v160, v160, v96
    v_add_u32_dpp v96, v96, v96 row_shr:1 row_mask:0xf bank_mask:0xf bound_ctrl:0
    s_nop 1
    v_add_u32_dpp v96, v96, v96 row_shr:2 row_mask:0xf bank_mask:0xf bound_ctrl:0
    s_nop 1
    v_add_u32_dpp v96, v96, v96 row_shr:4 row_mask:0xf bank_mask:0xf bound_ctrl:0
    s_nop 1
    v_add_u32_dpp v96, v96, v96 row_shr:8 row_mask:0xf bank_mask:0xf bound_ctrl:0
    s_nop 1
    v_add_u32 v160, v160, v96
    v_cmp_lt_u32 vcc, 1664, v96
    ds_write2st64_b32 v161, v160, v96 offset0:2 offset1:3
    v_readlane_b32 s16, v96, 15
    v_readlane_b32 s17, v96, 31
    v_readlane_b32 s18, v96, 47
    v_readlane_b32 s19, v96, 63
    s_cbranch_vccnz K2_GIVEUP
    ds_read_b32 v128, v224 offset:512
    ds_read_b32 v129, v225 offset:512
    ds_read_b32 v130, v226 offset:512
    ds_read_b32 v131, v227 offset:512
    ds_read_b32 v132, v232 offset:512
    ds_read_b32 v133, v233 offset:512
    ds_read_b32 v134, v228 offset:512
    ds_read_b32 v135, v229 offset:512
    ds_read_b32 v136, v230 offset:512
    ds_read_b32 v137, v231 offset:512
    ds_read_b32 v138, v236 offset:512
    ds_read_b32 v139, v237 offset:512
    s_add_u32 s80, s16, s17
    s_add_u32 s52, s18, s19
    s_add_u32 s80, s80, s52
    s_or_b32 s17, s17, 1
    s_or_b32 s18, s18, 2
    s_or_b32 s19, s19, 3
    s_max_u32 s20, s16, s17
    s_min_u32 s17, s16, s17
    s_max_u32 s16, s18, s19
    s_min_u32 s19, s18, s19
    s_max_u32 s18, s20, s16
    s_min_u32 s16, s20, s16
    s_max_u32 s20, s17, s19
    s_min_u32 s19, s17, s19
    s_max_u32 s17, s20, s16
    s_min_u32 s16, s20, s16
    s_bitcmp1_b32 s83, 0
    s_cselect_b32 s18, s17, s18
    s_cselect_b32 s16, s19, s16
    s_bitcmp1_b32 s83, 1
    s_cselect_b32 s51, s16, s18
    s_and_b32 s49, s51, 3
    s_andn2_b32 s51, s51, 3
    s_mul_i32 s58, s49, 1664
    s_add_u32 s54, s51, 127
    s_lshr_b32 s54, s54, 7
    s_add_u32 s20, s51, 124
    s_bfe_u32 s20, s20, 0x20005
    s_lshl_b32 s20, s20, 1
    s_add_u32 s20, s20, 2
    s_add_u32 s51, s51, s58
    v_add_u32 v162, s51, v162
    s_lshl_b32 s52, s54, 7
    s_add_u32 s52, s52, s58
    v_lshlrev_b32 v163, 3, v162
    v_and_b32 v163, 128, v163
    v_cmpx_gt_u32 vcc, s52, v162
    ds_write2st64_b32 v162, v163, v164 offset0:6 offset1:32
    s_mov_b64 exec, -1
    s_waitcnt lgkmcnt(1)
    v_add_u32 v128, v128, v112
    v_add_u32 v129, v129, v113
    v_add_u32 v130, v130, v114
    v_add_u32 v131, v131, v115
    v_add_u32 v132, v132, v120
    v_add_u32 v133, v133, v121
    v_add_u32 v134, v134, v116
    v_add_u32 v135, v135, v117
    v_add_u32 v136, v136, v118
    v_add_u32 v137, v137, v119
    v_add_u32 v138, v138, v124
    v_add_u32 v139, v139, v125
    v_lshlrev_b32 v112, 3, v128
    v_lshlrev_b32 v113, 3, v129
    v_lshlrev_b32 v114, 3, v130
    v_lshlrev_b32 v115, 3, v131
    v_lshlrev_b32 v120, 3, v132
    v_lshlrev_b32 v121, 3, v133
    v_lshlrev_b32 v116, 3, v134
    v_lshlrev_b32 v117, 3, v135
    v_lshlrev_b32 v118, 3, v136
    v_lshlrev_b32 v119, 3, v137
    v_lshlrev_b32 v124, 3, v138
    v_lshlrev_b32 v125, 3, v139
    v_and_or_b32 v176, v112, s61, v176
    v_and_or_b32 v177, v113, s61, v177
    v_and_or_b32 v178, v114, s61, v178
    v_and_or_b32 v179, v115, s61, v179
    v_and_or_b32 v180, v120, s61, v180
    v_and_or_b32 v181, v121, s61, v181
    v_and_or_b32 v182, v116, s61, v182
    v_and_or_b32 v183, v117, s61, v183
    v_and_or_b32 v184, v118, s61, v184
    v_and_or_b32 v185, v119, s61, v185
    v_and_or_b32 v186, v124, s61, v186
    v_and_or_b32 v187, v125, s61, v187
    v_cmp_gt_u32 s[68:69], -2, v208
    v_cmp_gt_u32 s[70:71], -2, v209
    v_cmp_gt_u32 s[72:73], -2, v210
    v_cmp_gt_u32 s[74:75], -2, v211
    v_cmp_gt_u32 s[76:77], -2, v216
    v_cmp_gt_u32 s[78:79], -2, v217
    s_mov_b64 exec, s[68:69]
    ds_write2st64_b32 v128, v176, v192 offset0:6 offset1:32
    s_mov_b64 exec, s[70:71]
    ds_write2st64_b32 v129, v177, v193 offset0:6 offset1:32
    s_mov_b64 exec, s[72:73]
    ds_write2st64_b32 v130, v178, v194 offset0:6 offset1:32
    s_mov_b64 exec, s[74:75]
    ds_write2st64_b32 v131, v179, v195 offset0:6 offset1:32
    s_mov_b64 exec, s[76:77]
    ds_write2st64_b32 v132, v180, v196 offset0:6 offset1:32
    s_mov_b64 exec, s[78:79]
    ds_write2st64_b32 v133, v181, v197 offset0:6 offset1:32
    s_mov_b64 exec, -1
    v_cmp_gt_u32 s[68:69], -2, v212
    v_cmp_gt_u32 s[70:71], -2, v213
    v_cmp_gt_u32 s[72:73], -2, v214
    v_cmp_gt_u32 s[74:75], -2, v215
    v_cmp_gt_u32 s[76:77], -2, v220
    v_cmp_gt_u32 s[78:79], -2, v221
    s_mov_b64 exec, s[68:69]
    ds_write2st64_b32 v134, v182, v198 offset0:6 offset1:32
    s_mov_b64 exec, s[70:71]
    ds_write2st64_b32 v135, v183, v199 offset0:6 offset1:32
    s_mov_b64 exec, s[72:73]
    ds_write2st64_b32 v136, v184, v200 offset0:6 offset1:32
    s_mov_b64 exec, s[74:75]
    ds_write2st64_b32 v137, v185, v201 offset0:6 offset1:32
    s_mov_b64 exec, s[76:77]
    ds_write2st64_b32 v138, v186, v202 offset0:6 offset1:32
    s_mov_b64 exec, s[78:79]
    ds_write2st64_b32 v139, v187, v203 offset0:6 offset1:32
    s_mov_b64 exec, -1
    s_cmp_eq_u64 s[26:27], 0
    s_cbranch_scc1 K2_P1
    s_waitcnt lgkmcnt(0)
    v_cmpx_gt_u32 vcc, -2, v218
    s_cbranch_execz K2_P0
    ds_read_b32 v140, v234 offset:512
    s_waitcnt lgkmcnt(0)
    v_add_u32 v140, v140, v122
    v_bfe_u32 v160, v218, 16, 14
    v_lshlrev_b32 v161, 3, v140
    v_mad_u32_u16 v162, v218, 2, v110
    v_and_b32 v161, 128, v161
    v_mad_u32_u24 v160, v160, s64, v161
    ds_write2st64_b32 v140, v160, v162 offset0:6 offset1:32
    v_cmpx_gt_u32 vcc, -2, v219
    s_cbranch_execz K2_P0
    ds_read_b32 v140, v235 offset:512
    s_waitcnt lgkmcnt(0)
    v_add_u32 v140, v140, v123
    v_bfe_u32 v160, v219, 16, 14
    v_lshlrev_b32 v161, 3, v140
    v_mad_u32_u16 v162, v219, 2, v110
    v_and_b32 v161, 128, v161
    v_mad_u32_u24 v160, v160, s64, v161
    ds_write2st64_b32 v140, v160, v162 offset0:6 offset1:32
K2_P0:
    s_mov_b64 exec, -1
    v_cmpx_gt_u32 vcc, -2, v222
    s_cbranch_execz K2_P1
    ds_read_b32 v140, v238 offset:512
    s_waitcnt lgkmcnt(0)
    v_add_u32 v140, v140, v126
    v_bfe_u32 v160, v222, 16, 14
    v_lshlrev_b32 v161, 3, v140
    v_mad_u32_u16 v162, v222, 2, v111
    v_and_b32 v161, 128, v161
    v_mad_u32_u24 v160, v160, s64, v161
    ds_write2st64_b32 v140, v160, v162 offset0:6 offset1:32
    v_cmpx_gt_u32 vcc, -2, v223
    s_cbranch_execz K2_P1
    ds_read_b32 v140, v239 offset:512
    s_waitcnt lgkmcnt(0)
    v_add_u32 v140, v140, v127
    v_bfe_u32 v160, v223, 16, 14
    v_lshlrev_b32 v161, 3, v140
    v_mad_u32_u16 v162, v223, 2, v111
    v_and_b32 v161, 128, v161
    v_mad_u32_u24 v160, v160, s64, v161
    ds_write2st64_b32 v140, v160, v162 offset0:6 offset1:32
K2_P1:
    s_mov_b64 exec, -1
    v_mov_b32 v166, 260
    v_mov_b32 v167, 1
    s_mov_b64 exec, 1
    ds_add_u32 v166, v167
    s_mov_b64 exec, -1
    v_and_b32 v160, 31, v0
    v_xor_b32 v2, 16, v1
    v_xor_b32 v3, 4, v160
    v_lshlrev_b32 v3, 2, v3
    v_add_u32 v2, s58, v2
    v_add_u32 v3, s58, v3
    s_mul_i32 s51, s49, 2560
    s_lshl_b32 s52, s50, 7
    s_add_u32 s51, s51, s52
    v_and_b32 v6, 17, v0
    v_lshlrev_b32 v6, 2, v6
    v_bfe_u32 v161, v0, 1, 1
    v_lshl_add_u32 v6, v161, 5, v6
    v_bfe_u32 v161, v0, 2, 2
    v_lshl_add_u32 v6, v161, 3, v6
    v_lshl_add_u32 v6, v253, 2, v6
    v_add_u32 v6, s51, v6
    v_bfe_u32 v7, v0, 1, 5
    v_lshlrev_b32 v7, 2, v7
    v_add_u32 v7, s58, v7
    v_lshlrev_b32 v252, 4, v0
    v_xor_b32 v252, v252, v0
    v_and_b32 v252, 16, v252
    v_lshlrev_b32 v254, 1, v0
    v_xor_b32 v254, v254, v1
    v_and_b32 v254, 16, v254
    v_add_u32 v254, 106496, v254
    s_lshl_b32 s51, s49, 2
    s_add_u32 s51, s51, 288
    v_mov_b32 v255, s51
    s_lshl_b32 s22, s58, 3
    s_add_u32 s22, s22, 106496
    s_mov_b32 s21, 0
    s_mov_b32 s23, 0
    s_mov_b32 s57, s54
    v_mov_b32 v166, 260
K2_SPINB:
    ds_read2_b32 v[168:169], v166 offset0:0 offset1:1
    s_waitcnt lgkmcnt(0)
    v_min_u32 v167, v168, v169
    v_cmp_gt_u32 vcc, 4, v167
    s_cbranch_vccnz K2_SPINB
K2_REFILLP:
    s_cmp_eq_u32 s54, 0
    s_cbranch_scc1 K2_FILLEDP
    ds_read_b32 v4, v7 offset:8192
    ds_read_b32 v96, v7 offset:8320
    ds_read_b128 v[48:51], v2 offset:1536
    ds_read_b128 v[52:55], v2 offset:1568
    ds_read_b128 v[56:59], v2 offset:1600
    ds_read_b128 v[60:63], v2 offset:1632
    ds_read_b32 v5, v3 offset:8192
    ds_read_b32 v97, v3 offset:8320
    s_waitcnt lgkmcnt(6)
    s_cmp_lt_u32 s21, s57
    s_cbranch_scc0 K2_ND1
    s_mov_b32 m0, s22
    v_and_or_b32 v4, v4, s60, v252
    buffer_load_dwordx4 v4, s[40:43], 0 offen  lds
K2_ND1:
    s_add_u32 s21, s21, 1
    s_add_u32 s22, s22, 1024
    v_mov_b32 v4, v96
    s_waitcnt lgkmcnt(0)
    buffer_load_dword v176, v48, s[36:39], 0 offen
    buffer_load_dword v177, v49, s[36:39], 0 offen
    buffer_load_dword v178, v50, s[36:39], 0 offen
    buffer_load_dword v179, v51, s[36:39], 0 offen
    buffer_load_dword v180, v52, s[36:39], 0 offen
    buffer_load_dword v181, v53, s[36:39], 0 offen
    buffer_load_dword v182, v54, s[36:39], 0 offen
    buffer_load_dword v183, v55, s[36:39], 0 offen
    buffer_load_dword v184, v56, s[36:39], 0 offen
    buffer_load_dword v185, v57, s[36:39], 0 offen
    buffer_load_dword v186, v58, s[36:39], 0 offen
    buffer_load_dword v187, v59, s[36:39], 0 offen
    buffer_load_dword v188, v60, s[36:39], 0 offen
    buffer_load_dword v189, v61, s[36:39], 0 offen
    buffer_load_dword v190, v62, s[36:39], 0 offen
    buffer_load_dword v191, v63, s[36:39], 0 offen
    v_and_b32 v5, 30, v5
    v_lshl_add_u32 v5, v5, 3, v253
    ds_read_b128 v[32:35], v5 offset:1024
    v_mov_b32 v5, v97
    v_and_b32 v5, 30, v5
    v_lshl_add_u32 v5, v5, 3, v253
    ds_read_b128 v[36:39], v5 offset:1024
    buffer_load_dword v192, v48, s[36:39], 0 offen offset:128
    buffer_load_dword v193, v49, s[36:39], 0 offen offset:128
    buffer_load_dword v194, v50, s[36:39], 0 offen offset:128
    buffer_load_dword v195, v51, s[36:39], 0 offen offset:128
    buffer_load_dword v196, v52, s[36:39], 0 offen offset:128
    buffer_load_dword v197, v53, s[36:39], 0 offen offset:128
    buffer_load_dword v198, v54, s[36:39], 0 offen offset:128
    buffer_load_dword v199, v55, s[36:39], 0 offen offset:128
    buffer_load_dword v200, v56, s[36:39], 0 offen offset:128
    buffer_load_dword v201, v57, s[36:39], 0 offen offset:128
    buffer_load_dword v202, v58, s[36:39], 0 offen offset:128
    buffer_load_dword v203, v59, s[36:39], 0 offen offset:128
    buffer_load_dword v204, v60, s[36:39], 0 offen offset:128
    buffer_load_dword v205, v61, s[36:39], 0 offen offset:128
    buffer_load_dword v206, v62, s[36:39], 0 offen offset:128
    buffer_load_dword v207, v63, s[36:39], 0 offen offset:128
    ds_read_b128 v[48:51], v2 offset:1664
    ds_read_b128 v[52:55], v2 offset:1696
    ds_read_b128 v[56:59], v2 offset:1728
    ds_read_b128 v[60:63], v2 offset:1760
K2_FILLEDP:
    s_cmp_lg_u32 s55, 0
    s_cbranch_scc1 K2_GOP
    v_mov_b32 v64, 0
    v_mov_b32 v65, 0
    v_mov_b32 v66, 0
    v_mov_b32 v67, 0
    v_mov_b32 v68, 0
    v_mov_b32 v69, 0
    v_mov_b32 v70, 0
    v_mov_b32 v71, 0
    v_mov_b32 v72, 0
    v_mov_b32 v73, 0
    v_mov_b32 v74, 0
    v_mov_b32 v75, 0
    v_mov_b32 v76, 0
    v_mov_b32 v77, 0
    v_mov_b32 v78, 0
    v_mov_b32 v79, 0
    v_mov_b32 v80, 0
    v_mov_b32 v81, 0
    v_mov_b32 v82, 0
    v_mov_b32 v83, 0
    v_mov_b32 v84, 0
    v_mov_b32 v85, 0
    v_mov_b32 v86, 0
    v_mov_b32 v87, 0
    v_mov_b32 v88, 0
    v_mov_b32 v89, 0
    v_mov_b32 v90, 0
    v_mov_b32 v91, 0
    v_mov_b32 v92, 0
    v_mov_b32 v93, 0
    v_mov_b32 v94, 0
    v_mov_b32 v95, 0
    v_bfe_u32 v160, v0, 2, 2
    v_lshrrev_b32 v161, 1, v1
    v_add_u32 v160, v160, v161
    v_mul_u32_u24 v160, 272, v160
    v_bfe_u32 v162, v0, 4, 1
    v_lshl_add_u32 v160, v162, 5, v160
    v_and_b32 v162, 3, v0
    v_lshl_add_u32 v160, v162, 3, v160
    s_mul_i32 s51, s49, 2720
    s_lshl_b32 s52, s50, 7
    s_add_u32 s51, s51, s52
    v_add_u32 v160, s51, v160
    v_mul_u32_u24 v161, 136, v161
    v_and_b32 v162, 127, v6
    v_add3_u32 v161, v162, s51, v161
    v_mov_b32 v166, 268
K2_SPIND:
    ds_read_b32 v167, v166
    s_waitcnt lgkmcnt(0)
    v_cmp_gt_u32 vcc, 4, v167
    s_cbranch_vccnz K2_SPIND
    ds_read_b64_tr_b16 v[16:17], v160 offset:14848
    ds_read_b64_tr_b16 v[18:19], v160 offset:15936
    ds_read_b64_tr_b16 v[20:21], v160 offset:14912
    ds_read_b64_tr_b16 v[22:23], v160 offset:16000
    ds_read_b32 v246, v161 offset:27904
    ds_read_b32 v247, v161 offset:28176
    ds_read_b32 v248, v161 offset:28448
    ds_read_b32 v249, v161 offset:28720
    ds_read_b32 v250, v161 offset:30080
    ds_read_b32 v251, v161 offset:30352
K2_GOP:
    s_cmp_eq_u32 s54, 0
    s_cbranch_scc1 K2_EMPTY
    s_cmp_gt_u32 s54, 2
    s_cbranch_scc1 K2_ENTFP
    s_cmp_eq_u32 s54, 2
    s_cbranch_scc1 K2_ENTPP
    s_waitcnt vmcnt(32)
    s_add_u32 s23, s23, 1
    v_mov_b32 v4, s23
    ds_write_b32 v255, v4
    v_lshl_add_u32 v4, v3, 3, v254
    ds_read_b128 v[40:43], v4 offset:0
    s_waitcnt lgkmcnt(0)
    v_mfma_f32_32x32x16_bf16 v[112:127], v[40:43], v[8:11], 0
    v_mfma_f32_32x32x16_bf16 v[112:127], v[32:35], v[16:19], v[112:127]
    v_mfma_f32_32x32x16_bf16 v[128:143], v[40:43], v[12:15], 0
    v_mfma_f32_32x32x16_bf16 v[128:143], v[32:35], v[20:23], v[128:143]
    s_nop 7
    s_waitcnt vmcnt(16)
    v_mfma_f32_4x4x4_16b_bf16 v[112:115], v[24:25], v[176:177], v[112:115]
    v_mfma_f32_4x4x4_16b_bf16 v[116:119], v[24:25], v[180:181], v[116:119]
    v_mfma_f32_4x4x4_16b_bf16 v[120:123], v[24:25], v[184:185], v[120:123]
    v_mfma_f32_4x4x4_16b_bf16 v[124:127], v[24:25], v[188:189], v[124:127]
    v_mfma_f32_4x4x4_16b_bf16 v[112:115], v[26:27], v[178:179], v[112:115]
    v_mfma_f32_4x4x4_16b_bf16 v[116:119], v[26:27], v[182:183], v[116:119]
    v_mfma_f32_4x4x4_16b_bf16 v[120:123], v[26:27], v[186:187], v[120:123]
    v_mfma_f32_4x4x4_16b_bf16 v[124:127], v[26:27], v[190:191], v[124:127]
    s_nop 3
    v_exp_f32 v112, v112
    v_exp_f32 v113, v113
    s_nop 0
    v_add_f32 v112, 1.0, v112
    v_add_f32 v113, 1.0, v113
    v_rcp_f32 v112, v112
    v_rcp_f32 v113, v113
    v_cvt_pkrtz_f16_f32 v114, v114, v115
    v_and_b32_sdwa v115, s67, v114 dst_sel:DWORD dst_unused:UNUSED_PAD src0_sel:DWORD src1_sel:WORD_1
    v_and_b32 v114, s67, v114
    ds_read_u16_d16_hi v115, v115 offset:40960
    ds_read_u16_d16_hi v114, v114 offset:40960
    v_cvt_pkrtz_f16_f32 v116, v116, v117
    v_and_b32_sdwa v117, s67, v116 dst_sel:DWORD dst_unused:UNUSED_PAD src0_sel:DWORD src1_sel:WORD_1
    v_and_b32 v116, s67, v116
    ds_read_u16_d16_hi v117, v117 offset:40960
    ds_read_u16_d16_hi v116, v116 offset:40960
    v_cvt_pkrtz_f16_f32 v118, v118, v119
    v_and_b32_sdwa v119, s67, v118 dst_sel:DWORD dst_unused:UNUSED_PAD src0_sel:DWORD src1_sel:WORD_1
    v_and_b32 v118, s67, v118
    ds_read_u16_d16_hi v119, v119 offset:40960
    ds_read_u16_d16_hi v118, v118 offset:40960
    s_waitcnt vmcnt(0)
    v_mfma_f32_4x4x4_16b_bf16 v[128:131], v[24:25], v[192:193], v[128:131]
    v_mfma_f32_4x4x4_16b_bf16 v[132:135], v[24:25], v[196:197], v[132:135]
    v_mfma_f32_4x4x4_16b_bf16 v[136:139], v[24:25], v[200:201], v[136:139]
    v_mfma_f32_4x4x4_16b_bf16 v[140:143], v[24:25], v[204:205], v[140:143]
    v_mfma_f32_4x4x4_16b_bf16 v[128:131], v[26:27], v[194:195], v[128:131]
    v_mfma_f32_4x4x4_16b_bf16 v[132:135], v[26:27], v[198:199], v[132:135]
    v_mfma_f32_4x4x4_16b_bf16 v[136:139], v[26:27], v[202:203], v[136:139]
    v_mfma_f32_4x4x4_16b_bf16 v[140:143], v[26:27], v[206:207], v[140:143]
    s_waitcnt lgkmcnt(13)
    v_cvt_pkrtz_f16_f32 v120, v120, v121
    v_and_b32_sdwa v121, s67, v120 dst_sel:DWORD dst_unused:UNUSED_PAD src0_sel:DWORD src1_sel:WORD_1
    v_and_b32 v120, s67, v120
    ds_read_u16_d16_hi v121, v121 offset:40960
    ds_read_u16_d16_hi v120, v120 offset:40960
    s_waitcnt lgkmcnt(13)
    v_cvt_pkrtz_f16_f32 v122, v122, v123
    v_and_b32_sdwa v123, s67, v122 dst_sel:DWORD dst_unused:UNUSED_PAD src0_sel:DWORD src1_sel:WORD_1
    v_and_b32 v122, s67, v122
    ds_read_u16_d16_hi v123, v123 offset:40960
    ds_read_u16_d16_hi v122, v122 offset:40960
    s_waitcnt lgkmcnt(13)
    v_cvt_pkrtz_f16_f32 v124, v124, v125
    v_and_b32_sdwa v125, s67, v124 dst_sel:DWORD dst_unused:UNUSED_PAD src0_sel:DWORD src1_sel:WORD_1
    v_and_b32 v124, s67, v124
    ds_read_u16_d16_hi v125, v125 offset:40960
    ds_read_u16_d16_hi v124, v124 offset:40960
    s_waitcnt lgkmcnt(13)
    v_cvt_pkrtz_f16_f32 v126, v126, v127
    v_and_b32_sdwa v127, s67, v126 dst_sel:DWORD dst_unused:UNUSED_PAD src0_sel:DWORD src1_sel:WORD_1
    v_and_b32 v126, s67, v126
    ds_read_u16_d16_hi v127, v127 offset:40960
    ds_read_u16_d16_hi v126, v126 offset:40960
    s_waitcnt lgkmcnt(12)
    v_mfma_f32_32x32x16_bf16 v[96:111], v[32:35], v[28:31], 0
    v_exp_f32 v128, v128
    v_mul_f32 v176, v112, v176
    v_exp_f32 v129, v129
    v_mul_f32 v177, v113, v177
    v_add_f32 v128, 1.0, v128
    v_cvt_pk_bf16_f32 v112, v112, v176
    v_add_f32 v129, 1.0, v129
    v_cvt_pk_bf16_f32 v113, v113, v177
    v_rcp_f32 v128, v128
    v_rcp_f32 v129, v129
    v_cvt_pkrtz_f16_f32 v130, v130, v131
    v_mul_f32 v178, v114, v178
    v_and_b32_sdwa v131, s67, v130 dst_sel:DWORD dst_unused:UNUSED_PAD src0_sel:DWORD src1_sel:WORD_1
    v_mul_f32 v179, v115, v179
    v_and_b32 v130, s67, v130
    v_cvt_pk_bf16_f32 v114, v114, v178
    v_cvt_pk_bf16_f32 v115, v115, v179
    ds_read_u16_d16_hi v131, v131 offset:40960
    ds_read_u16_d16_hi v130, v130 offset:40960
    s_waitcnt lgkmcnt(10)
    v_cvt_pkrtz_f16_f32 v132, v132, v133
    v_mul_f32 v180, v116, v180
    v_and_b32_sdwa v133, s67, v132 dst_sel:DWORD dst_unused:UNUSED_PAD src0_sel:DWORD src1_sel:WORD_1
    v_mul_f32 v181, v117, v181
    v_and_b32 v132, s67, v132
    v_cvt_pk_bf16_f32 v116, v116, v180
    v_cvt_pk_bf16_f32 v117, v117, v181
    ds_read_u16_d16_hi v133, v133 offset:40960
    ds_read_u16_d16_hi v132, v132 offset:40960
    v_cvt_pkrtz_f16_f32 v134, v134, v135
    v_mul_f32 v182, v118, v182
    v_and_b32_sdwa v135, s67, v134 dst_sel:DWORD dst_unused:UNUSED_PAD src0_sel:DWORD src1_sel:WORD_1
    v_mul_f32 v183, v119, v183
    v_and_b32 v134, s67, v134
    v_cvt_pk_bf16_f32 v118, v118, v182
    v_cvt_pk_bf16_f32 v119, v119, v183
    ds_read_u16_d16_hi v135, v135 offset:40960
    ds_read_u16_d16_hi v134, v134 offset:40960
    s_waitcnt lgkmcnt(10)
    v_cvt_pkrtz_f16_f32 v136, v136, v137
    v_mul_f32 v184, v120, v184
    v_and_b32_sdwa v137, s67, v136 dst_sel:DWORD dst_unused:UNUSED_PAD src0_sel:DWORD src1_sel:WORD_1
    v_mul_f32 v185, v121, v185
    v_and_b32 v136, s67, v136
    v_cvt_pk_bf16_f32 v120, v120, v184
    v_cvt_pk_bf16_f32 v121, v121, v185
    ds_read_u16_d16_hi v137, v137 offset:40960
    ds_read_u16_d16_hi v136, v136 offset:40960
    v_cvt_pkrtz_f16_f32 v138, v138, v139
    v_mul_f32 v186, v122, v186
    v_and_b32_sdwa v139, s67, v138 dst_sel:DWORD dst_unused:UNUSED_PAD src0_sel:DWORD src1_sel:WORD_1
    v_mul_f32 v187, v123, v187
    v_and_b32 v138, s67, v138
    v_cvt_pk_bf16_f32 v122, v122, v186
    v_cvt_pk_bf16_f32 v123, v123, v187
    ds_read_u16_d16_hi v139, v139 offset:40960
    ds_read_u16_d16_hi v138, v138 offset:40960
    s_waitcnt lgkmcnt(10)
    v_cvt_pkrtz_f16_f32 v140, v140, v141
    v_mul_f32 v188, v124, v188
    v_and_b32_sdwa v141, s67, v140 dst_sel:DWORD dst_unused:UNUSED_PAD src0_sel:DWORD src1_sel:WORD_1
    v_mul_f32 v189, v125, v189
    v_and_b32 v140, s67, v140
    v_cvt_pk_bf16_f32 v124, v124, v188
    v_cvt_pk_bf16_f32 v125, v125, v189
    ds_read_u16_d16_hi v141, v141 offset:40960
    ds_read_u16_d16_hi v140, v140 offset:40960
    v_cvt_pkrtz_f16_f32 v142, v142, v143
    v_mul_f32 v190, v126, v190
    v_and_b32_sdwa v143, s67, v142 dst_sel:DWORD dst_unused:UNUSED_PAD src0_sel:DWORD src1_sel:WORD_1
    v_mul_f32 v191, v127, v191
    v_and_b32 v142, s67, v142
    v_cvt_pk_bf16_f32 v126, v126, v190
    v_cvt_pk_bf16_f32 v127, v127, v191
    ds_read_u16_d16_hi v143, v143 offset:40960
    ds_read_u16_d16_hi v142, v142 offset:40960
    s_branch K2_MIDL0P
K2_ENTPP:
    s_waitcnt vmcnt(32)
    s_add_u32 s23, s23, 1
    v_mov_b32 v4, s23
    ds_write_b32 v255, v4
    v_lshl_add_u32 v4, v3, 3, v254
    ds_read_b128 v[40:43], v4 offset:0
    ds_read_b32 v4, v7 offset:8320
    s_waitcnt lgkmcnt(0)
    v_mfma_f32_32x32x16_bf16 v[112:127], v[40:43], v[8:11], 0
    v_mfma_f32_32x32x16_bf16 v[112:127], v[32:35], v[16:19], v[112:127]
    v_mfma_f32_32x32x16_bf16 v[128:143], v[40:43], v[12:15], 0
    v_mfma_f32_32x32x16_bf16 v[128:143], v[32:35], v[20:23], v[128:143]
    s_mov_b32 m0, s22
    v_and_or_b32 v4, v4, s60, v252
    buffer_load_dwordx4 v4, s[40:43], 0 offen  lds
    s_add_u32 s22, s22, 1024
    s_nop 7
    s_waitcnt vmcnt(17)
    v_mfma_f32_4x4x4_16b_bf16 v[112:115], v[24:25], v[176:177], v[112:115]
    v_mfma_f32_4x4x4_16b_bf16 v[116:119], v[24:25], v[180:181], v[116:119]
    v_mfma_f32_4x4x4_16b_bf16 v[120:123], v[24:25], v[184:185], v[120:123]
    v_mfma_f32_4x4x4_16b_bf16 v[124:127], v[24:25], v[188:189], v[124:127]
    v_mfma_f32_4x4x4_16b_bf16 v[112:115], v[26:27], v[178:179], v[112:115]
    v_mfma_f32_4x4x4_16b_bf16 v[116:119], v[26:27], v[182:183], v[116:119]
    v_mfma_f32_4x4x4_16b_bf16 v[120:123], v[26:27], v[186:187], v[120:123]
    v_mfma_f32_4x4x4_16b_bf16 v[124:127], v[26:27], v[190:191], v[124:127]
    s_nop 3
    s_waitcnt lgkmcnt(6)
    v_exp_f32 v112, v112
    v_exp_f32 v113, v113
    s_nop 0
    v_add_f32 v112, 1.0, v112
    v_add_f32 v113, 1.0, v113
    v_rcp_f32 v112, v112
    v_rcp_f32 v113, v113
    buffer_load_dword v208, v48, s[36:39], 0 offen
    buffer_load_dword v209, v49, s[36:39], 0 offen
    buffer_load_dword v210, v50, s[36:39], 0 offen
    buffer_load_dword v211, v51, s[36:39], 0 offen
    s_waitcnt lgkmcnt(5)
    v_cvt_pkrtz_f16_f32 v114, v114, v115
    v_and_b32_sdwa v115, s67, v114 dst_sel:DWORD dst_unused:UNUSED_PAD src0_sel:DWORD src1_sel:WORD_1
    v_and_b32 v114, s67, v114
    ds_read_u16_d16_hi v115, v115 offset:40960
    ds_read_u16_d16_hi v114, v114 offset:40960
    buffer_load_dword v212, v52, s[36:39], 0 offen
    buffer_load_dword v213, v53, s[36:39], 0 offen
    buffer_load_dword v214, v54, s[36:39], 0 offen
    buffer_load_dword v215, v55, s[36:39], 0 offen
    s_waitcnt lgkmcnt(6)
    v_cvt_pkrtz_f16_f32 v116, v116, v117
    v_and_b32_sdwa v117, s67, v116 dst_sel:DWORD dst_unused:UNUSED_PAD src0_sel:DWORD src1_sel:WORD_1
    v_and_b32 v116, s67, v116
    ds_read_u16_d16_hi v117, v117 offset:40960
    ds_read_u16_d16_hi v116, v116 offset:40960
    buffer_load_dword v216, v56, s[36:39], 0 offen
    buffer_load_dword v217, v57, s[36:39], 0 offen
    buffer_load_dword v218, v58, s[36:39], 0 offen
    buffer_load_dword v219, v59, s[36:39], 0 offen
    s_waitcnt lgkmcnt(7)
    v_cvt_pkrtz_f16_f32 v118, v118, v119
    v_and_b32_sdwa v119, s67, v118 dst_sel:DWORD dst_unused:UNUSED_PAD src0_sel:DWORD src1_sel:WORD_1
    v_and_b32 v118, s67, v118
    ds_read_u16_d16_hi v119, v119 offset:40960
    ds_read_u16_d16_hi v118, v118 offset:40960
    buffer_load_dword v220, v60, s[36:39], 0 offen
    buffer_load_dword v221, v61, s[36:39], 0 offen
    buffer_load_dword v222, v62, s[36:39], 0 offen
    buffer_load_dword v223, v63, s[36:39], 0 offen
    s_waitcnt vmcnt(17)
    v_mfma_f32_4x4x4_16b_bf16 v[128:131], v[24:25], v[192:193], v[128:131]
    v_mfma_f32_4x4x4_16b_bf16 v[132:135], v[24:25], v[196:197], v[132:135]
    v_mfma_f32_4x4x4_16b_bf16 v[136:139], v[24:25], v[200:201], v[136:139]
    v_mfma_f32_4x4x4_16b_bf16 v[140:143], v[24:25], v[204:205], v[140:143]
    v_mfma_f32_4x4x4_16b_bf16 v[128:131], v[26:27], v[194:195], v[128:131]
    v_mfma_f32_4x4x4_16b_bf16 v[132:135], v[26:27], v[198:199], v[132:135]
    v_mfma_f32_4x4x4_16b_bf16 v[136:139], v[26:27], v[202:203], v[136:139]
    v_mfma_f32_4x4x4_16b_bf16 v[140:143], v[26:27], v[206:207], v[140:143]
    s_waitcnt lgkmcnt(13)
    v_cvt_pkrtz_f16_f32 v120, v120, v121
    v_and_b32_sdwa v121, s67, v120 dst_sel:DWORD dst_unused:UNUSED_PAD src0_sel:DWORD src1_sel:WORD_1
    v_and_b32 v120, s67, v120
    ds_read_u16_d16_hi v121, v121 offset:40960
    ds_read_u16_d16_hi v120, v120 offset:40960
    s_waitcnt lgkmcnt(13)
    v_cvt_pkrtz_f16_f32 v122, v122, v123
    v_and_b32_sdwa v123, s67, v122 dst_sel:DWORD dst_unused:UNUSED_PAD src0_sel:DWORD src1_sel:WORD_1
    v_and_b32 v122, s67, v122
    ds_read_u16_d16_hi v123, v123 offset:40960
    ds_read_u16_d16_hi v122, v122 offset:40960
    s_waitcnt lgkmcnt(10)
    v_cvt_pkrtz_f16_f32 v124, v124, v125
    v_and_b32_sdwa v125, s67, v124 dst_sel:DWORD dst_unused:UNUSED_PAD src0_sel:DWORD src1_sel:WORD_1
    v_and_b32 v124, s67, v124
    ds_read_u16_d16_hi v125, v125 offset:40960
    ds_read_u16_d16_hi v124, v124 offset:40960
    s_waitcnt vmcnt(16)
    s_add_u32 s23, s23, 1
    v_mov_b32 v4, s23
    ds_write_b32 v255, v4
    v_lshl_add_u32 v4, v3, 3, v254
    ds_read_b128 v[44:47], v4 offset:1024
    s_waitcnt lgkmcnt(13)
    v_cvt_pkrtz_f16_f32 v126, v126, v127
    v_and_b32_sdwa v127, s67, v126 dst_sel:DWORD dst_unused:UNUSED_PAD src0_sel:DWORD src1_sel:WORD_1
    v_and_b32 v126, s67, v126
    ds_read_u16_d16_hi v127, v127 offset:40960
    ds_read_u16_d16_hi v126, v126 offset:40960
    s_waitcnt lgkmcnt(2)
    s_setprio 2
    v_mfma_f32_32x32x16_bf16 v[144:159], v[44:47], v[8:11], 0
    v_exp_f32 v128, v128
    v_mul_f32 v176, v112, v176
    v_exp_f32 v129, v129
    v_mul_f32 v177, v113, v177
    v_add_f32 v128, 1.0, v128
    v_cvt_pk_bf16_f32 v112, v112, v176
    v_add_f32 v129, 1.0, v129
    v_cvt_pk_bf16_f32 v113, v113, v177
    v_rcp_f32 v128, v128
    v_rcp_f32 v129, v129
    buffer_load_dword v224, v48, s[36:39], 0 offen offset:128
    buffer_load_dword v225, v49, s[36:39], 0 offen offset:128
    buffer_load_dword v226, v50, s[36:39], 0 offen offset:128
    buffer_load_dword v227, v51, s[36:39], 0 offen offset:128
    v_mfma_f32_32x32x16_bf16 v[144:159], v[36:39], v[16:19], v[144:159]
    v_cvt_pkrtz_f16_f32 v130, v130, v131
    v_mul_f32 v178, v114, v178
    v_and_b32_sdwa v131, s67, v130 dst_sel:DWORD dst_unused:UNUSED_PAD src0_sel:DWORD src1_sel:WORD_1
    v_mul_f32 v179, v115, v179
    v_and_b32 v130, s67, v130
    v_cvt_pk_bf16_f32 v114, v114, v178
    v_cvt_pk_bf16_f32 v115, v115, v179
    ds_read_u16_d16_hi v131, v131 offset:40960
    ds_read_u16_d16_hi v130, v130 offset:40960
    buffer_load_dword v228, v52, s[36:39], 0 offen offset:128
    buffer_load_dword v229, v53, s[36:39], 0 offen offset:128
    buffer_load_dword v230, v54, s[36:39], 0 offen offset:128
    buffer_load_dword v231, v55, s[36:39], 0 offen offset:128
    s_waitcnt lgkmcnt(11)
    v_mfma_f32_32x32x16_bf16 v[96:111], v[32:35], v[28:31], 0
    v_cvt_pkrtz_f16_f32 v132, v132, v133
    v_mul_f32 v180, v116, v180
    v_and_b32_sdwa v133, s67, v132 dst_sel:DWORD dst_unused:UNUSED_PAD src0_sel:DWORD src1_sel:WORD_1
    v_mul_f32 v181, v117, v181
    v_and_b32 v132, s67, v132
    v_cvt_pk_bf16_f32 v116, v116, v180
    v_cvt_pk_bf16_f32 v117, v117, v181
    ds_read_u16_d16_hi v133, v133 offset:40960
    ds_read_u16_d16_hi v132, v132 offset:40960
    buffer_load_dword v232, v56, s[36:39], 0 offen offset:128
    buffer_load_dword v233, v57, s[36:39], 0 offen offset:128
    buffer_load_dword v234, v58, s[36:39], 0 offen offset:128
    buffer_load_dword v235, v59, s[36:39], 0 offen offset:128
    v_cvt_pkrtz_f16_f32 v134, v134, v135
    v_mul_f32 v182, v118, v182
    v_and_b32_sdwa v135, s67, v134 dst_sel:DWORD dst_unused:UNUSED_PAD src0_sel:DWORD src1_sel:WORD_1
    v_mul_f32 v183, v119, v183
    v_and_b32 v134, s67, v134
    v_cvt_pk_bf16_f32 v118, v118, v182
    v_cvt_pk_bf16_f32 v119, v119, v183
    ds_read_u16_d16_hi v135, v135 offset:40960
    ds_read_u16_d16_hi v134, v134 offset:40960
    buffer_load_dword v236, v60, s[36:39], 0 offen offset:128
    buffer_load_dword v237, v61, s[36:39], 0 offen offset:128
    buffer_load_dword v238, v62, s[36:39], 0 offen offset:128
    buffer_load_dword v239, v63, s[36:39], 0 offen offset:128
    s_waitcnt lgkmcnt(11)
    v_cvt_pkrtz_f16_f32 v136, v136, v137
    v_mul_f32 v184, v120, v184
    v_and_b32_sdwa v137, s67, v136 dst_sel:DWORD dst_unused:UNUSED_PAD src0_sel:DWORD src1_sel:WORD_1
    v_mul_f32 v185, v121, v185
    v_and_b32 v136, s67, v136
    v_cvt_pk_bf16_f32 v120, v120, v184
    v_cvt_pk_bf16_f32 v121, v121, v185
    ds_read_u16_d16_hi v137, v137 offset:40960
    ds_read_u16_d16_hi v136, v136 offset:40960
    buffer_load_dword v240, v6, s[28:31], 0 offen offset:0
    buffer_load_dword v241, v6, s[28:31], 0 offen offset:256
    buffer_load_dword v242, v6, s[28:31], 0 offen offset:512
    buffer_load_dword v243, v6, s[28:31], 0 offen offset:768
    buffer_load_dword v244, v6, s[28:31], 0 offen offset:2048
    buffer_load_dword v245, v6, s[28:31], 0 offen offset:2304
    v_cvt_pkrtz_f16_f32 v138, v138, v139
    v_mul_f32 v186, v122, v186
    v_and_b32_sdwa v139, s67, v138 dst_sel:DWORD dst_unused:UNUSED_PAD src0_sel:DWORD src1_sel:WORD_1
    v_mul_f32 v187, v123, v187
    s_waitcnt vmcnt(22)
    v_mfma_f32_4x4x4_16b_bf16 v[144:147], v[24:25], v[208:209], v[144:147]
    v_and_b32 v138, s67, v138
    v_mfma_f32_4x4x4_16b_bf16 v[148:151], v[24:25], v[212:213], v[148:151]
    v_cvt_pk_bf16_f32 v122, v122, v186
    v_cvt_pk_bf16_f32 v123, v123, v187
    ds_read_u16_d16_hi v139, v139 offset:40960
    ds_read_u16_d16_hi v138, v138 offset:40960
    s_waitcnt lgkmcnt(10)
    v_mfma_f32_4x4x4_16b_bf16 v[152:155], v[24:25], v[216:217], v[152:155]
    v_cvt_pkrtz_f16_f32 v140, v140, v141
    v_mfma_f32_4x4x4_16b_bf16 v[156:159], v[24:25], v[220:221], v[156:159]
    v_mul_f32 v188, v124, v188
    v_mfma_f32_4x4x4_16b_bf16 v[144:147], v[26:27], v[210:211], v[144:147]
    v_and_b32_sdwa v141, s67, v140 dst_sel:DWORD dst_unused:UNUSED_PAD src0_sel:DWORD src1_sel:WORD_1
    v_mfma_f32_4x4x4_16b_bf16 v[148:151], v[26:27], v[214:215], v[148:151]
    v_mul_f32 v189, v125, v189
    v_and_b32 v140, s67, v140
    v_cvt_pk_bf16_f32 v124, v124, v188
    v_cvt_pk_bf16_f32 v125, v125, v189
    ds_read_u16_d16_hi v141, v141 offset:40960
    ds_read_u16_d16_hi v140, v140 offset:40960
    v_mfma_f32_4x4x4_16b_bf16 v[152:155], v[26:27], v[218:219], v[152:155]
    v_cvt_pkrtz_f16_f32 v142, v142, v143
    v_mfma_f32_4x4x4_16b_bf16 v[156:159], v[26:27], v[222:223], v[156:159]
    v_mul_f32 v190, v126, v190
    v_and_b32_sdwa v143, s67, v142 dst_sel:DWORD dst_unused:UNUSED_PAD src0_sel:DWORD src1_sel:WORD_1
    v_mul_f32 v191, v127, v191
    v_and_b32 v142, s67, v142
    v_cvt_pk_bf16_f32 v126, v126, v190
    v_cvt_pk_bf16_f32 v127, v127, v191
    ds_read_u16_d16_hi v143, v143 offset:40960
    ds_read_u16_d16_hi v142, v142 offset:40960
    s_branch K2_MIDP0P
K2_ENTFP:
    s_waitcnt vmcnt(32)
    s_add_u32 s23, s23, 1
    v_mov_b32 v4, s23
    ds_write_b32 v255, v4
    v_lshl_add_u32 v4, v3, 3, v254
    ds_read_b128 v[40:43], v4 offset:0
    ds_read_b32 v4, v7 offset:8320
    s_waitcnt lgkmcnt(0)
    v_mfma_f32_32x32x16_bf16 v[112:127], v[40:43], v[8:11], 0
    v_mfma_f32_32x32x16_bf16 v[112:127], v[32:35], v[16:19], v[112:127]
    v_mfma_f32_32x32x16_bf16 v[128:143], v[40:43], v[12:15], 0
    v_mfma_f32_32x32x16_bf16 v[128:143], v[32:35], v[20:23], v[128:143]
    s_mov_b32 m0, s22
    v_and_or_b32 v4, v4, s60, v252
    buffer_load_dwordx4 v4, s[40:43], 0 offen  lds
    s_add_u32 s22, s22, 1024
    s_nop 7
    s_waitcnt vmcnt(17)
    v_mfma_f32_4x4x4_16b_bf16 v[112:115], v[24:25], v[176:177], v[112:115]
    v_mfma_f32_4x4x4_16b_bf16 v[116:119], v[24:25], v[180:181], v[116:119]
    v_mfma_f32_4x4x4_16b_bf16 v[120:123], v[24:25], v[184:185], v[120:123]
    v_mfma_f32_4x4x4_16b_bf16 v[124:127], v[24:25], v[188:189], v[124:127]
    v_mfma_f32_4x4x4_16b_bf16 v[112:115], v[26:27], v[178:179], v[112:115]
    v_mfma_f32_4x4x4_16b_bf16 v[116:119], v[26:27], v[182:183], v[116:119]
    v_mfma_f32_4x4x4_16b_bf16 v[120:123], v[26:27], v[186:187], v[120:123]
    v_mfma_f32_4x4x4_16b_bf16 v[124:127], v[26:27], v[190:191], v[124:127]
    s_nop 3
    s_waitcnt lgkmcnt(6)
    v_exp_f32 v112, v112
    v_exp_f32 v113, v113
    s_nop 0
    v_add_f32 v112, 1.0, v112
    v_add_f32 v113, 1.0, v113
    v_rcp_f32 v112, v112
    v_rcp_f32 v113, v113
    buffer_load_dword v208, v48, s[36:39], 0 offen
    buffer_load_dword v209, v49, s[36:39], 0 offen
    buffer_load_dword v210, v50, s[36:39], 0 offen
    buffer_load_dword v211, v51, s[36:39], 0 offen
    s_waitcnt lgkmcnt(5)
    v_cvt_pkrtz_f16_f32 v114, v114, v115
    v_and_b32_sdwa v115, s67, v114 dst_sel:DWORD dst_unused:UNUSED_PAD src0_sel:DWORD src1_sel:WORD_1
    v_and_b32 v114, s67, v114
    ds_read_u16_d16_hi v115, v115 offset:40960
    ds_read_u16_d16_hi v114, v114 offset:40960
    buffer_load_dword v212, v52, s[36:39], 0 offen
    buffer_load_dword v213, v53, s[36:39], 0 offen
    buffer_load_dword v214, v54, s[36:39], 0 offen
    buffer_load_dword v215, v55, s[36:39], 0 offen
    s_waitcnt lgkmcnt(6)
    v_cvt_pkrtz_f16_f32 v116, v116, v117
    v_and_b32_sdwa v117, s67, v116 dst_sel:DWORD dst_unused:UNUSED_PAD src0_sel:DWORD src1_sel:WORD_1
    v_and_b32 v116, s67, v116
    ds_read_u16_d16_hi v117, v117 offset:40960
    ds_read_u16_d16_hi v116, v116 offset:40960
    buffer_load_dword v216, v56, s[36:39], 0 offen
    buffer_load_dword v217, v57, s[36:39], 0 offen
    buffer_load_dword v218, v58, s[36:39], 0 offen
    buffer_load_dword v219, v59, s[36:39], 0 offen
    ds_read_b32 v5, v7 offset:8448
    s_waitcnt lgkmcnt(8)
    v_cvt_pkrtz_f16_f32 v118, v118, v119
    v_and_b32_sdwa v119, s67, v118 dst_sel:DWORD dst_unused:UNUSED_PAD src0_sel:DWORD src1_sel:WORD_1
    v_and_b32 v118, s67, v118
    ds_read_u16_d16_hi v119, v119 offset:40960
    ds_read_u16_d16_hi v118, v118 offset:40960
    buffer_load_dword v220, v60, s[36:39], 0 offen
    buffer_load_dword v221, v61, s[36:39], 0 offen
    buffer_load_dword v222, v62, s[36:39], 0 offen
    buffer_load_dword v223, v63, s[36:39], 0 offen
    s_waitcnt vmcnt(17)
    v_mfma_f32_4x4x4_16b_bf16 v[128:131], v[24:25], v[192:193], v[128:131]
    v_mfma_f32_4x4x4_16b_bf16 v[132:135], v[24:25], v[196:197], v[132:135]
    v_mfma_f32_4x4x4_16b_bf16 v[136:139], v[24:25], v[200:201], v[136:139]
    v_mfma_f32_4x4x4_16b_bf16 v[140:143], v[24:25], v[204:205], v[140:143]
    v_mfma_f32_4x4x4_16b_bf16 v[128:131], v[26:27], v[194:195], v[128:131]
    v_mfma_f32_4x4x4_16b_bf16 v[132:135], v[26:27], v[198:199], v[132:135]
    v_mfma_f32_4x4x4_16b_bf16 v[136:139], v[26:27], v[202:203], v[136:139]
    v_mfma_f32_4x4x4_16b_bf16 v[140:143], v[26:27], v[206:207], v[140:143]
    s_waitcnt lgkmcnt(13)
    v_cvt_pkrtz_f16_f32 v120, v120, v121
    v_and_b32_sdwa v121, s67, v120 dst_sel:DWORD dst_unused:UNUSED_PAD src0_sel:DWORD src1_sel:WORD_1
    v_and_b32 v120, s67, v120
    ds_read_u16_d16_hi v121, v121 offset:40960
    ds_read_u16_d16_hi v120, v120 offset:40960
    s_waitcnt lgkmcnt(13)
    v_cvt_pkrtz_f16_f32 v122, v122, v123
    v_and_b32_sdwa v123, s67, v122 dst_sel:DWORD dst_unused:UNUSED_PAD src0_sel:DWORD src1_sel:WORD_1
    v_and_b32 v122, s67, v122
    ds_read_u16_d16_hi v123, v123 offset:40960
    ds_read_u16_d16_hi v122, v122 offset:40960
    s_waitcnt lgkmcnt(11)
    v_cvt_pkrtz_f16_f32 v124, v124, v125
    v_and_b32_sdwa v125, s67, v124 dst_sel:DWORD dst_unused:UNUSED_PAD src0_sel:DWORD src1_sel:WORD_1
    v_and_b32 v124, s67, v124
    ds_read_u16_d16_hi v125, v125 offset:40960
    ds_read_u16_d16_hi v124, v124 offset:40960
    s_waitcnt vmcnt(16)
    s_add_u32 s23, s23, 1
    v_mov_b32 v4, s23
    ds_write_b32 v255, v4
    v_lshl_add_u32 v4, v3, 3, v254
    ds_read_b128 v[44:47], v4 offset:1024
    s_waitcnt lgkmcnt(13)
    v_cvt_pkrtz_f16_f32 v126, v126, v127
    v_and_b32_sdwa v127, s67, v126 dst_sel:DWORD dst_unused:UNUSED_PAD src0_sel:DWORD src1_sel:WORD_1
    v_and_b32 v126, s67, v126
    ds_read_u16_d16_hi v127, v127 offset:40960
    ds_read_u16_d16_hi v126, v126 offset:40960
    s_waitcnt lgkmcnt(2)
    s_setprio 2
    v_mfma_f32_32x32x16_bf16 v[144:159], v[44:47], v[8:11], 0
    v_exp_f32 v128, v128
    v_mul_f32 v176, v112, v176
    v_exp_f32 v129, v129
    v_mul_f32 v177, v113, v177
    v_add_f32 v128, 1.0, v128
    v_cvt_pk_bf16_f32 v112, v112, v176
    v_add_f32 v129, 1.0, v129
    v_cvt_pk_bf16_f32 v113, v113, v177
    v_rcp_f32 v128, v128
    v_rcp_f32 v129, v129
    buffer_load_dword v224, v48, s[36:39], 0 offen offset:128
    buffer_load_dword v225, v49, s[36:39], 0 offen offset:128
    buffer_load_dword v226, v50, s[36:39], 0 offen offset:128
    buffer_load_dword v227, v51, s[36:39], 0 offen offset:128
    ds_read_b128 v[48:51], v2 offset:1792
    v_mfma_f32_32x32x16_bf16 v[144:159], v[36:39], v[16:19], v[144:159]
    v_cvt_pkrtz_f16_f32 v130, v130, v131
    v_mul_f32 v178, v114, v178
    v_and_b32_sdwa v131, s67, v130 dst_sel:DWORD dst_unused:UNUSED_PAD src0_sel:DWORD src1_sel:WORD_1
    v_mul_f32 v179, v115, v179
    v_and_b32 v130, s67, v130
    v_cvt_pk_bf16_f32 v114, v114, v178
    v_cvt_pk_bf16_f32 v115, v115, v179
    ds_read_u16_d16_hi v131, v131 offset:40960
    ds_read_u16_d16_hi v130, v130 offset:40960
    buffer_load_dword v228, v52, s[36:39], 0 offen offset:128
    buffer_load_dword v229, v53, s[36:39], 0 offen offset:128
    buffer_load_dword v230, v54, s[36:39], 0 offen offset:128
    buffer_load_dword v231, v55, s[36:39], 0 offen offset:128
    ds_read_b128 v[52:55], v2 offset:1824
    s_waitcnt lgkmcnt(9)
    v_mfma_f32_32x32x16_bf16 v[96:111], v[32:35], v[28:31], 0
    v_cvt_pkrtz_f16_f32 v132, v132, v133
    v_mul_f32 v180, v116, v180
    v_and_b32_sdwa v133, s67, v132 dst_sel:DWORD dst_unused:UNUSED_PAD src0_sel:DWORD src1_sel:WORD_1
    v_mul_f32 v181, v117, v181
    v_and_b32 v132, s67, v132
    v_cvt_pk_bf16_f32 v116, v116, v180
    v_cvt_pk_bf16_f32 v117, v117, v181
    ds_read_u16_d16_hi v133, v133 offset:40960
    ds_read_u16_d16_hi v132, v132 offset:40960
    buffer_load_dword v232, v56, s[36:39], 0 offen offset:128
    buffer_load_dword v233, v57, s[36:39], 0 offen offset:128
    buffer_load_dword v234, v58, s[36:39], 0 offen offset:128
    buffer_load_dword v235, v59, s[36:39], 0 offen offset:128
    ds_read_b128 v[56:59], v2 offset:1856
    v_cvt_pkrtz_f16_f32 v134, v134, v135
    v_mul_f32 v182, v118, v182
    v_and_b32_sdwa v135, s67, v134 dst_sel:DWORD dst_unused:UNUSED_PAD src0_sel:DWORD src1_sel:WORD_1
    v_mul_f32 v183, v119, v183
    v_and_b32 v134, s67, v134
    v_cvt_pk_bf16_f32 v118, v118, v182
    v_cvt_pk_bf16_f32 v119, v119, v183
    ds_read_u16_d16_hi v135, v135 offset:40960
    ds_read_u16_d16_hi v134, v134 offset:40960
    buffer_load_dword v236, v60, s[36:39], 0 offen offset:128
    buffer_load_dword v237, v61, s[36:39], 0 offen offset:128
    buffer_load_dword v238, v62, s[36:39], 0 offen offset:128
    buffer_load_dword v239, v63, s[36:39], 0 offen offset:128
    ds_read_b128 v[60:63], v2 offset:1888
    s_waitcnt lgkmcnt(10)
    s_mov_b32 m0, s22
    v_and_or_b32 v5, v5, s60, v252
    buffer_load_dwordx4 v5, s[40:43], 0 offen  lds
    s_add_u32 s22, s22, 1024
    v_cvt_pkrtz_f16_f32 v136, v136, v137
    v_mul_f32 v184, v120, v184
    v_and_b32_sdwa v137, s67, v136 dst_sel:DWORD dst_unused:UNUSED_PAD src0_sel:DWORD src1_sel:WORD_1
    v_mul_f32 v185, v121, v185
    v_and_b32 v136, s67, v136
    v_cvt_pk_bf16_f32 v120, v120, v184
    v_cvt_pk_bf16_f32 v121, v121, v185
    ds_read_u16_d16_hi v137, v137 offset:40960
    ds_read_u16_d16_hi v136, v136 offset:40960
    v_cvt_pkrtz_f16_f32 v138, v138, v139
    v_mul_f32 v186, v122, v186
    v_and_b32_sdwa v139, s67, v138 dst_sel:DWORD dst_unused:UNUSED_PAD src0_sel:DWORD src1_sel:WORD_1
    v_mul_f32 v187, v123, v187
    s_waitcnt vmcnt(17)
    v_mfma_f32_4x4x4_16b_bf16 v[144:147], v[24:25], v[208:209], v[144:147]
    v_and_b32 v138, s67, v138
    v_mfma_f32_4x4x4_16b_bf16 v[148:151], v[24:25], v[212:213], v[148:151]
    v_cvt_pk_bf16_f32 v122, v122, v186
    v_cvt_pk_bf16_f32 v123, v123, v187
    ds_read_u16_d16_hi v139, v139 offset:40960
    ds_read_u16_d16_hi v138, v138 offset:40960
    ds_read_b32 v5, v3 offset:8448
    s_waitcnt lgkmcnt(11)
    v_mfma_f32_4x4x4_16b_bf16 v[152:155], v[24:25], v[216:217], v[152:155]
    v_cvt_pkrtz_f16_f32 v140, v140, v141
    v_mfma_f32_4x4x4_16b_bf16 v[156:159], v[24:25], v[220:221], v[156:159]
    v_mul_f32 v188, v124, v188
    v_mfma_f32_4x4x4_16b_bf16 v[144:147], v[26:27], v[210:211], v[144:147]
    v_and_b32_sdwa v141, s67, v140 dst_sel:DWORD dst_unused:UNUSED_PAD src0_sel:DWORD src1_sel:WORD_1
    v_mfma_f32_4x4x4_16b_bf16 v[148:151], v[26:27], v[214:215], v[148:151]
    v_mul_f32 v189, v125, v189
    v_and_b32 v140, s67, v140
    v_cvt_pk_bf16_f32 v124, v124, v188
    v_cvt_pk_bf16_f32 v125, v125, v189
    ds_read_u16_d16_hi v141, v141 offset:40960
    ds_read_u16_d16_hi v140, v140 offset:40960
    v_mfma_f32_4x4x4_16b_bf16 v[152:155], v[26:27], v[218:219], v[152:155]
    v_cvt_pkrtz_f16_f32 v142, v142, v143
    v_mfma_f32_4x4x4_16b_bf16 v[156:159], v[26:27], v[222:223], v[156:159]
    v_mul_f32 v190, v126, v190
    v_and_b32_sdwa v143, s67, v142 dst_sel:DWORD dst_unused:UNUSED_PAD src0_sel:DWORD src1_sel:WORD_1
    v_mul_f32 v191, v127, v191
    v_and_b32 v142, s67, v142
    v_cvt_pk_bf16_f32 v126, v126, v190
    v_cvt_pk_bf16_f32 v127, v127, v191
    ds_read_u16_d16_hi v143, v143 offset:40960
    ds_read_u16_d16_hi v142, v142 offset:40960
    s_branch K2_MIDF0P
    .p2align 6
K2_BODYF0P:
    s_waitcnt lgkmcnt(11)
    s_setprio 2
    v_mfma_f32_32x32x16_bf16 v[80:95], v[96:99], v[160:163], v[80:95]
    v_exp_f32 v128, v128
    v_mul_f32 v176, v112, v176
    v_exp_f32 v129, v129
    v_mul_f32 v177, v113, v177
    v_add_f32 v128, 1.0, v128
    v_cvt_pk_bf16_f32 v112, v112, v176
    v_mfma_f32_32x32x16_bf16 v[80:95], v[100:103], v[164:167], v[80:95]
    v_add_f32 v129, 1.0, v129
    v_cvt_pk_bf16_f32 v113, v113, v177
    v_rcp_f32 v128, v128
    v_rcp_f32 v129, v129
    buffer_load_dword v224, v48, s[36:39], 0 offen offset:128
    buffer_load_dword v225, v49, s[36:39], 0 offen offset:128
    buffer_load_dword v226, v50, s[36:39], 0 offen offset:128
    buffer_load_dword v227, v51, s[36:39], 0 offen offset:128
    ds_read_b128 v[48:51], v2 offset:1792
    v_mfma_f32_32x32x16_bf16 v[80:95], v[104:107], v[168:171], v[80:95]
    v_cvt_pkrtz_f16_f32 v130, v130, v131
    v_mul_f32 v178, v114, v178
    v_and_b32_sdwa v131, s67, v130 dst_sel:DWORD dst_unused:UNUSED_PAD src0_sel:DWORD src1_sel:WORD_1
    v_mul_f32 v179, v115, v179
    v_and_b32 v130, s67, v130
    v_cvt_pk_bf16_f32 v114, v114, v178
    v_cvt_pk_bf16_f32 v115, v115, v179
    ds_read_u16_d16_hi v131, v131 offset:40960
    ds_read_u16_d16_hi v130, v130 offset:40960
    buffer_load_dword v228, v52, s[36:39], 0 offen offset:128
    buffer_load_dword v229, v53, s[36:39], 0 offen offset:128
    buffer_load_dword v230, v54, s[36:39], 0 offen offset:128
    buffer_load_dword v231, v55, s[36:39], 0 offen offset:128
    ds_read_b128 v[52:55], v2 offset:1824
    s_waitcnt lgkmcnt(6)
    v_mfma_f32_32x32x16_bf16 v[144:159], v[44:47], v[8:11], 0
    v_cvt_pkrtz_f16_f32 v132, v132, v133
    v_mul_f32 v180, v116, v180
    v_and_b32_sdwa v133, s67, v132 dst_sel:DWORD dst_unused:UNUSED_PAD src0_sel:DWORD src1_sel:WORD_1
    v_mul_f32 v181, v117, v181
    v_and_b32 v132, s67, v132
    v_cvt_pk_bf16_f32 v116, v116, v180
    v_cvt_pk_bf16_f32 v117, v117, v181
    ds_read_u16_d16_hi v133, v133 offset:40960
    ds_read_u16_d16_hi v132, v132 offset:40960
    buffer_load_dword v232, v56, s[36:39], 0 offen offset:128
    buffer_load_dword v233, v57, s[36:39], 0 offen offset:128
    buffer_load_dword v234, v58, s[36:39], 0 offen offset:128
    buffer_load_dword v235, v59, s[36:39], 0 offen offset:128
    ds_read_b128 v[56:59], v2 offset:1856
    v_mfma_f32_32x32x16_bf16 v[144:159], v[36:39], v[16:19], v[144:159]
    v_cvt_pkrtz_f16_f32 v134, v134, v135
    v_mul_f32 v182, v118, v182
    v_and_b32_sdwa v135, s67, v134 dst_sel:DWORD dst_unused:UNUSED_PAD src0_sel:DWORD src1_sel:WORD_1
    v_mul_f32 v183, v119, v183
    v_and_b32 v134, s67, v134
    v_cvt_pk_bf16_f32 v118, v118, v182
    v_cvt_pk_bf16_f32 v119, v119, v183
    ds_read_u16_d16_hi v135, v135 offset:40960
    ds_read_u16_d16_hi v134, v134 offset:40960
    buffer_load_dword v236, v60, s[36:39], 0 offen offset:128
    buffer_load_dword v237, v61, s[36:39], 0 offen offset:128
    buffer_load_dword v238, v62, s[36:39], 0 offen offset:128
    buffer_load_dword v239, v63, s[36:39], 0 offen offset:128
    ds_read_b128 v[60:63], v2 offset:1888
    s_waitcnt lgkmcnt(10)
    v_mfma_f32_32x32x16_bf16 v[80:95], v[108:111], v[172:175], v[80:95]
    s_mov_b32 m0, s22
    v_and_or_b32 v5, v5, s60, v252
    buffer_load_dwordx4 v5, s[40:43], 0 offen  lds
    s_add_u32 s22, s22, 1024
    v_cvt_pkrtz_f16_f32 v136, v136, v137
    v_mul_f32 v184, v120, v184
    v_and_b32_sdwa v137, s67, v136 dst_sel:DWORD dst_unused:UNUSED_PAD src0_sel:DWORD src1_sel:WORD_1
    v_mul_f32 v185, v121, v185
    v_and_b32 v136, s67, v136
    v_cvt_pk_bf16_f32 v120, v120, v184
    v_cvt_pk_bf16_f32 v121, v121, v185
    ds_read_u16_d16_hi v137, v137 offset:40960
    ds_read_u16_d16_hi v136, v136 offset:40960
    v_mfma_f32_32x32x16_bf16 v[96:111], v[32:35], v[28:31], 0
    v_cvt_pkrtz_f16_f32 v138, v138, v139
    v_mul_f32 v186, v122, v186
    v_and_b32_sdwa v139, s67, v138 dst_sel:DWORD dst_unused:UNUSED_PAD src0_sel:DWORD src1_sel:WORD_1
    v_mul_f32 v187, v123, v187
    s_waitcnt vmcnt(17)
    v_mfma_f32_4x4x4_16b_bf16 v[144:147], v[24:25], v[208:209], v[144:147]
    v_and_b32 v138, s67, v138
    v_mfma_f32_4x4x4_16b_bf16 v[148:151], v[24:25], v[212:213], v[148:151]
    v_cvt_pk_bf16_f32 v122, v122, v186
    v_cvt_pk_bf16_f32 v123, v123, v187
    ds_read_u16_d16_hi v139, v139 offset:40960
    ds_read_u16_d16_hi v138, v138 offset:40960
    ds_read_b32 v5, v3 offset:8448
    s_waitcnt lgkmcnt(11)
    v_mfma_f32_4x4x4_16b_bf16 v[152:155], v[24:25], v[216:217], v[152:155]
    v_cvt_pkrtz_f16_f32 v140, v140, v141
    v_mfma_f32_4x4x4_16b_bf16 v[156:159], v[24:25], v[220:221], v[156:159]
    v_mul_f32 v188, v124, v188
    v_mfma_f32_4x4x4_16b_bf16 v[144:147], v[26:27], v[210:211], v[144:147]
    v_and_b32_sdwa v141, s67, v140 dst_sel:DWORD dst_unused:UNUSED_PAD src0_sel:DWORD src1_sel:WORD_1
    v_mfma_f32_4x4x4_16b_bf16 v[148:151], v[26:27], v[214:215], v[148:151]
    v_mul_f32 v189, v125, v189
    v_and_b32 v140, s67, v140
    v_cvt_pk_bf16_f32 v124, v124, v188
    v_cvt_pk_bf16_f32 v125, v125, v189
    ds_read_u16_d16_hi v141, v141 offset:40960
    ds_read_u16_d16_hi v140, v140 offset:40960
    v_mfma_f32_4x4x4_16b_bf16 v[152:155], v[26:27], v[218:219], v[152:155]
    v_cvt_pkrtz_f16_f32 v142, v142, v143
    v_mfma_f32_4x4x4_16b_bf16 v[156:159], v[26:27], v[222:223], v[156:159]
    v_mul_f32 v190, v126, v190
    v_and_b32_sdwa v143, s67, v142 dst_sel:DWORD dst_unused:UNUSED_PAD src0_sel:DWORD src1_sel:WORD_1
    v_mul_f32 v191, v127, v191
    v_and_b32 v142, s67, v142
    v_cvt_pk_bf16_f32 v126, v126, v190
    v_cvt_pk_bf16_f32 v127, v127, v191
    ds_read_u16_d16_hi v143, v143 offset:40960
    ds_read_u16_d16_hi v142, v142 offset:40960
K2_MIDF0P:
    s_waitcnt lgkmcnt(13)
    v_mfma_f32_32x32x16_bf16 v[64:79], v[96:99], v[112:115], v[64:79]
    v_exp_f32 v144, v144
    v_mul_f32 v192, v128, v192
    v_exp_f32 v145, v145
    v_mul_f32 v193, v129, v193
    v_add_f32 v144, 1.0, v144
    v_cvt_pk_bf16_f32 v128, v128, v192
    v_add_f32 v145, 1.0, v145
    v_cvt_pk_bf16_f32 v129, v129, v193
    v_rcp_f32 v144, v144
    v_rcp_f32 v145, v145
    buffer_load_dword v176, v48, s[36:39], 0 offen
    buffer_load_dword v177, v49, s[36:39], 0 offen
    buffer_load_dword v178, v50, s[36:39], 0 offen
    buffer_load_dword v179, v51, s[36:39], 0 offen
    v_mfma_f32_32x32x16_bf16 v[64:79], v[100:103], v[116:119], v[64:79]
    v_cvt_pkrtz_f16_f32 v146, v146, v147
    v_mul_f32 v194, v130, v194
    v_and_b32_sdwa v147, s67, v146 dst_sel:DWORD dst_unused:UNUSED_PAD src0_sel:DWORD src1_sel:WORD_1
    v_mul_f32 v195, v131, v195
    v_and_b32 v146, s67, v146
    v_cvt_pk_bf16_f32 v130, v130, v194
    v_cvt_pk_bf16_f32 v131, v131, v195
    ds_read_u16_d16_hi v147, v147 offset:40960
    ds_read_u16_d16_hi v146, v146 offset:40960
    buffer_load_dword v180, v52, s[36:39], 0 offen
    buffer_load_dword v181, v53, s[36:39], 0 offen
    buffer_load_dword v182, v54, s[36:39], 0 offen
    buffer_load_dword v183, v55, s[36:39], 0 offen
    s_waitcnt lgkmcnt(6)
    v_mfma_f32_32x32x16_bf16 v[160:175], v[44:47], v[12:15], 0
    v_cvt_pkrtz_f16_f32 v148, v148, v149
    v_mul_f32 v196, v132, v196
    v_and_b32_sdwa v149, s67, v148 dst_sel:DWORD dst_unused:UNUSED_PAD src0_sel:DWORD src1_sel:WORD_1
    v_mul_f32 v197, v133, v197
    v_and_b32 v148, s67, v148
    v_cvt_pk_bf16_f32 v132, v132, v196
    v_cvt_pk_bf16_f32 v133, v133, v197
    ds_read_u16_d16_hi v149, v149 offset:40960
    ds_read_u16_d16_hi v148, v148 offset:40960
    buffer_load_dword v184, v56, s[36:39], 0 offen
    buffer_load_dword v185, v57, s[36:39], 0 offen
    buffer_load_dword v186, v58, s[36:39], 0 offen
    buffer_load_dword v187, v59, s[36:39], 0 offen
    v_and_b32 v5, 30, v5
    v_lshl_add_u32 v5, v5, 3, v253
    ds_read_b128 v[32:35], v5 offset:1024
    v_mfma_f32_32x32x16_bf16 v[160:175], v[36:39], v[20:23], v[160:175]
    v_cvt_pkrtz_f16_f32 v150, v150, v151
    v_mul_f32 v198, v134, v198
    v_and_b32_sdwa v151, s67, v150 dst_sel:DWORD dst_unused:UNUSED_PAD src0_sel:DWORD src1_sel:WORD_1
    v_mul_f32 v199, v135, v199
    v_and_b32 v150, s67, v150
    v_cvt_pk_bf16_f32 v134, v134, v198
    v_cvt_pk_bf16_f32 v135, v135, v199
    ds_read_u16_d16_hi v151, v151 offset:40960
    ds_read_u16_d16_hi v150, v150 offset:40960
    buffer_load_dword v188, v60, s[36:39], 0 offen
    buffer_load_dword v189, v61, s[36:39], 0 offen
    buffer_load_dword v190, v62, s[36:39], 0 offen
    buffer_load_dword v191, v63, s[36:39], 0 offen
    ds_read_b32 v5, v7 offset:8576
    s_waitcnt lgkmcnt(11)
    s_setprio 0
    v_mfma_f32_32x32x16_bf16 v[64:79], v[104:107], v[120:123], v[64:79]
    v_cvt_pkrtz_f16_f32 v152, v152, v153
    v_mul_f32 v200, v136, v200
    v_and_b32_sdwa v153, s67, v152 dst_sel:DWORD dst_unused:UNUSED_PAD src0_sel:DWORD src1_sel:WORD_1
    v_mul_f32 v201, v137, v201
    v_and_b32 v152, s67, v152
    v_cvt_pk_bf16_f32 v136, v136, v200
    v_cvt_pk_bf16_f32 v137, v137, v201
    ds_read_u16_d16_hi v153, v153 offset:40960
    ds_read_u16_d16_hi v152, v152 offset:40960
    v_mfma_f32_32x32x16_bf16 v[64:79], v[108:111], v[124:127], v[64:79]
    v_cvt_pkrtz_f16_f32 v154, v154, v155
    v_mul_f32 v202, v138, v202
    v_and_b32_sdwa v155, s67, v154 dst_sel:DWORD dst_unused:UNUSED_PAD src0_sel:DWORD src1_sel:WORD_1
    v_mul_f32 v203, v139, v203
    s_waitcnt vmcnt(16)
    v_mfma_f32_4x4x4_16b_bf16 v[160:163], v[24:25], v[224:225], v[160:163]
    v_and_b32 v154, s67, v154
    v_mfma_f32_4x4x4_16b_bf16 v[164:167], v[24:25], v[228:229], v[164:167]
    v_cvt_pk_bf16_f32 v138, v138, v202
    v_cvt_pk_bf16_f32 v139, v139, v203
    ds_read_u16_d16_hi v155, v155 offset:40960
    ds_read_u16_d16_hi v154, v154 offset:40960
    s_waitcnt lgkmcnt(9)
    v_mfma_f32_4x4x4_16b_bf16 v[168:171], v[24:25], v[232:233], v[168:171]
    v_cvt_pkrtz_f16_f32 v156, v156, v157
    v_mfma_f32_4x4x4_16b_bf16 v[172:175], v[24:25], v[236:237], v[172:175]
    v_mul_f32 v204, v140, v204
    v_mfma_f32_4x4x4_16b_bf16 v[160:163], v[26:27], v[226:227], v[160:163]
    v_and_b32_sdwa v157, s67, v156 dst_sel:DWORD dst_unused:UNUSED_PAD src0_sel:DWORD src1_sel:WORD_1
    v_mfma_f32_4x4x4_16b_bf16 v[164:167], v[26:27], v[230:231], v[164:167]
    v_mul_f32 v205, v141, v205
    v_and_b32 v156, s67, v156
    v_cvt_pk_bf16_f32 v140, v140, v204
    v_cvt_pk_bf16_f32 v141, v141, v205
    ds_read_u16_d16_hi v157, v157 offset:40960
    ds_read_u16_d16_hi v156, v156 offset:40960
    s_add_u32 s23, s23, 1
    v_mov_b32 v4, s23
    ds_write_b32 v255, v4
    v_lshl_add_u32 v4, v3, 3, v254
    ds_read_b128 v[40:43], v4 offset:2048
    v_mfma_f32_4x4x4_16b_bf16 v[168:171], v[26:27], v[234:235], v[168:171]
    v_cvt_pkrtz_f16_f32 v158, v158, v159
    v_mfma_f32_4x4x4_16b_bf16 v[172:175], v[26:27], v[238:239], v[172:175]
    v_mul_f32 v206, v142, v206
    v_and_b32_sdwa v159, s67, v158 dst_sel:DWORD dst_unused:UNUSED_PAD src0_sel:DWORD src1_sel:WORD_1
    v_mul_f32 v207, v143, v207
    v_and_b32 v158, s67, v158
    v_cvt_pk_bf16_f32 v142, v142, v206
    v_cvt_pk_bf16_f32 v143, v143, v207
    ds_read_u16_d16_hi v159, v159 offset:40960
    ds_read_u16_d16_hi v158, v158 offset:40960
    s_sub_u32 s54, s54, 1
    s_cmp_eq_u32 s54, 2
    s_cbranch_scc1 K2_BODYP1P
K2_BODYF1P:
    s_waitcnt lgkmcnt(11)
    s_setprio 2
    v_mfma_f32_32x32x16_bf16 v[80:95], v[96:99], v[128:131], v[80:95]
    v_exp_f32 v160, v160
    v_mul_f32 v208, v144, v208
    v_exp_f32 v161, v161
    v_mul_f32 v209, v145, v209
    v_add_f32 v160, 1.0, v160
    v_cvt_pk_bf16_f32 v144, v144, v208
    v_mfma_f32_32x32x16_bf16 v[80:95], v[100:103], v[132:135], v[80:95]
    v_add_f32 v161, 1.0, v161
    v_cvt_pk_bf16_f32 v145, v145, v209
    v_rcp_f32 v160, v160
    v_rcp_f32 v161, v161
    buffer_load_dword v192, v48, s[36:39], 0 offen offset:128
    buffer_load_dword v193, v49, s[36:39], 0 offen offset:128
    buffer_load_dword v194, v50, s[36:39], 0 offen offset:128
    buffer_load_dword v195, v51, s[36:39], 0 offen offset:128
    ds_read_b128 v[48:51], v2 offset:1920
    v_mfma_f32_32x32x16_bf16 v[80:95], v[104:107], v[136:139], v[80:95]
    v_cvt_pkrtz_f16_f32 v162, v162, v163
    v_mul_f32 v210, v146, v210
    v_and_b32_sdwa v163, s67, v162 dst_sel:DWORD dst_unused:UNUSED_PAD src0_sel:DWORD src1_sel:WORD_1
    v_mul_f32 v211, v147, v211
    v_and_b32 v162, s67, v162
    v_cvt_pk_bf16_f32 v146, v146, v210
    v_cvt_pk_bf16_f32 v147, v147, v211
    ds_read_u16_d16_hi v163, v163 offset:40960
    ds_read_u16_d16_hi v162, v162 offset:40960
    buffer_load_dword v196, v52, s[36:39], 0 offen offset:128
    buffer_load_dword v197, v53, s[36:39], 0 offen offset:128
    buffer_load_dword v198, v54, s[36:39], 0 offen offset:128
    buffer_load_dword v199, v55, s[36:39], 0 offen offset:128
    ds_read_b128 v[52:55], v2 offset:1952
    s_waitcnt lgkmcnt(6)
    v_mfma_f32_32x32x16_bf16 v[112:127], v[40:43], v[8:11], 0
    v_cvt_pkrtz_f16_f32 v164, v164, v165
    v_mul_f32 v212, v148, v212
    v_and_b32_sdwa v165, s67, v164 dst_sel:DWORD dst_unused:UNUSED_PAD src0_sel:DWORD src1_sel:WORD_1
    v_mul_f32 v213, v149, v213
    v_and_b32 v164, s67, v164
    v_cvt_pk_bf16_f32 v148, v148, v212
    v_cvt_pk_bf16_f32 v149, v149, v213
    ds_read_u16_d16_hi v165, v165 offset:40960
    ds_read_u16_d16_hi v164, v164 offset:40960
    buffer_load_dword v200, v56, s[36:39], 0 offen offset:128
    buffer_load_dword v201, v57, s[36:39], 0 offen offset:128
    buffer_load_dword v202, v58, s[36:39], 0 offen offset:128
    buffer_load_dword v203, v59, s[36:39], 0 offen offset:128
    ds_read_b128 v[56:59], v2 offset:1984
    v_mfma_f32_32x32x16_bf16 v[112:127], v[32:35], v[16:19], v[112:127]
    v_cvt_pkrtz_f16_f32 v166, v166, v167
    v_mul_f32 v214, v150, v214
    v_and_b32_sdwa v167, s67, v166 dst_sel:DWORD dst_unused:UNUSED_PAD src0_sel:DWORD src1_sel:WORD_1
    v_mul_f32 v215, v151, v215
    v_and_b32 v166, s67, v166
    v_cvt_pk_bf16_f32 v150, v150, v214
    v_cvt_pk_bf16_f32 v151, v151, v215
    ds_read_u16_d16_hi v167, v167 offset:40960
    ds_read_u16_d16_hi v166, v166 offset:40960
    buffer_load_dword v204, v60, s[36:39], 0 offen offset:128
    buffer_load_dword v205, v61, s[36:39], 0 offen offset:128
    buffer_load_dword v206, v62, s[36:39], 0 offen offset:128
    buffer_load_dword v207, v63, s[36:39], 0 offen offset:128
    ds_read_b128 v[60:63], v2 offset:2016
    s_waitcnt lgkmcnt(10)
    v_mfma_f32_32x32x16_bf16 v[80:95], v[108:111], v[140:143], v[80:95]
    s_mov_b32 m0, s22
    v_and_or_b32 v5, v5, s60, v252
    buffer_load_dwordx4 v5, s[40:43], 0 offen  lds
    s_add_u32 s22, s22, 1024
    v_cvt_pkrtz_f16_f32 v168, v168, v169
    v_mul_f32 v216, v152, v216
    v_and_b32_sdwa v169, s67, v168 dst_sel:DWORD dst_unused:UNUSED_PAD src0_sel:DWORD src1_sel:WORD_1
    v_mul_f32 v217, v153, v217
    v_and_b32 v168, s67, v168
    v_cvt_pk_bf16_f32 v152, v152, v216
    v_cvt_pk_bf16_f32 v153, v153, v217
    ds_read_u16_d16_hi v169, v169 offset:40960
    ds_read_u16_d16_hi v168, v168 offset:40960
    v_mfma_f32_32x32x16_bf16 v[96:111], v[36:39], v[28:31], 0
    v_cvt_pkrtz_f16_f32 v170, v170, v171
    v_mul_f32 v218, v154, v218
    v_and_b32_sdwa v171, s67, v170 dst_sel:DWORD dst_unused:UNUSED_PAD src0_sel:DWORD src1_sel:WORD_1
    v_mul_f32 v219, v155, v219
    s_waitcnt vmcnt(17)
    v_mfma_f32_4x4x4_16b_bf16 v[112:115], v[24:25], v[176:177], v[112:115]
    v_and_b32 v170, s67, v170
    v_mfma_f32_4x4x4_16b_bf16 v[116:119], v[24:25], v[180:181], v[116:119]
    v_cvt_pk_bf16_f32 v154, v154, v218
    v_cvt_pk_bf16_f32 v155, v155, v219
    ds_read_u16_d16_hi v171, v171 offset:40960
    ds_read_u16_d16_hi v170, v170 offset:40960
    ds_read_b32 v5, v3 offset:8576
    s_waitcnt lgkmcnt(11)
    v_mfma_f32_4x4x4_16b_bf16 v[120:123], v[24:25], v[184:185], v[120:123]
    v_cvt_pkrtz_f16_f32 v172, v172, v173
    v_mfma_f32_4x4x4_16b_bf16 v[124:127], v[24:25], v[188:189], v[124:127]
    v_mul_f32 v220, v156, v220
    v_mfma_f32_4x4x4_16b_bf16 v[112:115], v[26:27], v[178:179], v[112:115]
    v_and_b32_sdwa v173, s67, v172 dst_sel:DWORD dst_unused:UNUSED_PAD src0_sel:DWORD src1_sel:WORD_1
    v_mfma_f32_4x4x4_16b_bf16 v[116:119], v[26:27], v[182:183], v[116:119]
    v_mul_f32 v221, v157, v221
    v_and_b32 v172, s67, v172
    v_cvt_pk_bf16_f32 v156, v156, v220
    v_cvt_pk_bf16_f32 v157, v157, v221
    ds_read_u16_d16_hi v173, v173 offset:40960
    ds_read_u16_d16_hi v172, v172 offset:40960
    v_mfma_f32_4x4x4_16b_bf16 v[120:123], v[26:27], v[186:187], v[120:123]
    v_cvt_pkrtz_f16_f32 v174, v174, v175
    v_mfma_f32_4x4x4_16b_bf16 v[124:127], v[26:27], v[190:191], v[124:127]
    v_mul_f32 v222, v158, v222
    v_and_b32_sdwa v175, s67, v174 dst_sel:DWORD dst_unused:UNUSED_PAD src0_sel:DWORD src1_sel:WORD_1
    v_mul_f32 v223, v159, v223
    v_and_b32 v174, s67, v174
    v_cvt_pk_bf16_f32 v158, v158, v222
    v_cvt_pk_bf16_f32 v159, v159, v223
    ds_read_u16_d16_hi v175, v175 offset:40960
    ds_read_u16_d16_hi v174, v174 offset:40960
K2_MIDF1P:
    s_waitcnt lgkmcnt(13)
    v_mfma_f32_32x32x16_bf16 v[64:79], v[96:99], v[144:147], v[64:79]
    v_exp_f32 v112, v112
    v_mul_f32 v224, v160, v224
    v_exp_f32 v113, v113
    v_mul_f32 v225, v161, v225
    v_add_f32 v112, 1.0, v112
    v_cvt_pk_bf16_f32 v160, v160, v224
    v_add_f32 v113, 1.0, v113
    v_cvt_pk_bf16_f32 v161, v161, v225
    v_rcp_f32 v112, v112
    v_rcp_f32 v113, v113
    buffer_load_dword v208, v48, s[36:39], 0 offen
    buffer_load_dword v209, v49, s[36:39], 0 offen
    buffer_load_dword v210, v50, s[36:39], 0 offen
    buffer_load_dword v211, v51, s[36:39], 0 offen
    v_mfma_f32_32x32x16_bf16 v[64:79], v[100:103], v[148:151], v[64:79]
    v_cvt_pkrtz_f16_f32 v114, v114, v115
    v_mul_f32 v226, v162, v226
    v_and_b32_sdwa v115, s67, v114 dst_sel:DWORD dst_unused:UNUSED_PAD src0_sel:DWORD src1_sel:WORD_1
    v_mul_f32 v227, v163, v227
    v_and_b32 v114, s67, v114
    v_cvt_pk_bf16_f32 v162, v162, v226
    v_cvt_pk_bf16_f32 v163, v163, v227
    ds_read_u16_d16_hi v115, v115 offset:40960
    ds_read_u16_d16_hi v114, v114 offset:40960
    buffer_load_dword v212, v52, s[36:39], 0 offen
    buffer_load_dword v213, v53, s[36:39], 0 offen
    buffer_load_dword v214, v54, s[36:39], 0 offen
    buffer_load_dword v215, v55, s[36:39], 0 offen
    s_waitcnt lgkmcnt(6)
    v_mfma_f32_32x32x16_bf16 v[128:143], v[40:43], v[12:15], 0
    v_cvt_pkrtz_f16_f32 v116, v116, v117
    v_mul_f32 v228, v164, v228
    v_and_b32_sdwa v117, s67, v116 dst_sel:DWORD dst_unused:UNUSED_PAD src0_sel:DWORD src1_sel:WORD_1
    v_mul_f32 v229, v165, v229
    v_and_b32 v116, s67, v116
    v_cvt_pk_bf16_f32 v164, v164, v228
    v_cvt_pk_bf16_f32 v165, v165, v229
    ds_read_u16_d16_hi v117, v117 offset:40960
    ds_read_u16_d16_hi v116, v116 offset:40960
    buffer_load_dword v216, v56, s[36:39], 0 offen
    buffer_load_dword v217, v57, s[36:39], 0 offen
    buffer_load_dword v218, v58, s[36:39], 0 offen
    buffer_load_dword v219, v59, s[36:39], 0 offen
    v_and_b32 v5, 30, v5
    v_lshl_add_u32 v5, v5, 3, v253
    ds_read_b128 v[36:39], v5 offset:1024
    v_mfma_f32_32x32x16_bf16 v[128:143], v[32:35], v[20:23], v[128:143]
    v_cvt_pkrtz_f16_f32 v118, v118, v119
    v_mul_f32 v230, v166, v230
    v_and_b32_sdwa v119, s67, v118 dst_sel:DWORD dst_unused:UNUSED_PAD src0_sel:DWORD src1_sel:WORD_1
    v_mul_f32 v231, v167, v231
    v_and_b32 v118, s67, v118
    v_cvt_pk_bf16_f32 v166, v166, v230
    v_cvt_pk_bf16_f32 v167, v167, v231
    ds_read_u16_d16_hi v119, v119 offset:40960
    ds_read_u16_d16_hi v118, v118 offset:40960
    buffer_load_dword v220, v60, s[36:39], 0 offen
    buffer_load_dword v221, v61, s[36:39], 0 offen
    buffer_load_dword v222, v62, s[36:39], 0 offen
    buffer_load_dword v223, v63, s[36:39], 0 offen
    ds_read_b32 v5, v7 offset:8704
    s_waitcnt lgkmcnt(11)
    s_setprio 0
    v_mfma_f32_32x32x16_bf16 v[64:79], v[104:107], v[152:155], v[64:79]
    v_cvt_pkrtz_f16_f32 v120, v120, v121
    v_mul_f32 v232, v168, v232
    v_and_b32_sdwa v121, s67, v120 dst_sel:DWORD dst_unused:UNUSED_PAD src0_sel:DWORD src1_sel:WORD_1
    v_mul_f32 v233, v169, v233
    v_and_b32 v120, s67, v120
    v_cvt_pk_bf16_f32 v168, v168, v232
    v_cvt_pk_bf16_f32 v169, v169, v233
    ds_read_u16_d16_hi v121, v121 offset:40960
    ds_read_u16_d16_hi v120, v120 offset:40960
    v_mfma_f32_32x32x16_bf16 v[64:79], v[108:111], v[156:159], v[64:79]
    v_cvt_pkrtz_f16_f32 v122, v122, v123
    v_mul_f32 v234, v170, v234
    v_and_b32_sdwa v123, s67, v122 dst_sel:DWORD dst_unused:UNUSED_PAD src0_sel:DWORD src1_sel:WORD_1
    v_mul_f32 v235, v171, v235
    s_waitcnt vmcnt(16)
    v_mfma_f32_4x4x4_16b_bf16 v[128:131], v[24:25], v[192:193], v[128:131]
    v_and_b32 v122, s67, v122
    v_mfma_f32_4x4x4_16b_bf16 v[132:135], v[24:25], v[196:197], v[132:135]
    v_cvt_pk_bf16_f32 v170, v170, v234
    v_cvt_pk_bf16_f32 v171, v171, v235
    ds_read_u16_d16_hi v123, v123 offset:40960
    ds_read_u16_d16_hi v122, v122 offset:40960
    s_waitcnt lgkmcnt(9)
    v_mfma_f32_4x4x4_16b_bf16 v[136:139], v[24:25], v[200:201], v[136:139]
    v_cvt_pkrtz_f16_f32 v124, v124, v125
    v_mfma_f32_4x4x4_16b_bf16 v[140:143], v[24:25], v[204:205], v[140:143]
    v_mul_f32 v236, v172, v236
    v_mfma_f32_4x4x4_16b_bf16 v[128:131], v[26:27], v[194:195], v[128:131]
    v_and_b32_sdwa v125, s67, v124 dst_sel:DWORD dst_unused:UNUSED_PAD src0_sel:DWORD src1_sel:WORD_1
    v_mfma_f32_4x4x4_16b_bf16 v[132:135], v[26:27], v[198:199], v[132:135]
    v_mul_f32 v237, v173, v237
    v_and_b32 v124, s67, v124
    v_cvt_pk_bf16_f32 v172, v172, v236
    v_cvt_pk_bf16_f32 v173, v173, v237
    ds_read_u16_d16_hi v125, v125 offset:40960
    ds_read_u16_d16_hi v124, v124 offset:40960
    s_add_u32 s23, s23, 1
    v_mov_b32 v4, s23
    ds_write_b32 v255, v4
    v_lshl_add_u32 v4, v3, 3, v254
    ds_read_b128 v[44:47], v4 offset:3072
    v_mfma_f32_4x4x4_16b_bf16 v[136:139], v[26:27], v[202:203], v[136:139]
    v_cvt_pkrtz_f16_f32 v126, v126, v127
    v_mfma_f32_4x4x4_16b_bf16 v[140:143], v[26:27], v[206:207], v[140:143]
    v_mul_f32 v238, v174, v238
    v_and_b32_sdwa v127, s67, v126 dst_sel:DWORD dst_unused:UNUSED_PAD src0_sel:DWORD src1_sel:WORD_1
    v_mul_f32 v239, v175, v239
    v_and_b32 v126, s67, v126
    v_cvt_pk_bf16_f32 v174, v174, v238
    v_cvt_pk_bf16_f32 v175, v175, v239
    ds_read_u16_d16_hi v127, v127 offset:40960
    ds_read_u16_d16_hi v126, v126 offset:40960
    v_add_u32 v2, 256, v2
    v_add_u32 v3, 256, v3
    v_add_u32 v7, 256, v7
    s_sub_u32 s54, s54, 1
    s_cmp_eq_u32 s54, 2
    s_cbranch_scc1 K2_BODYP0P
    s_branch K2_BODYF0P
K2_MIDL0P:
    buffer_load_dword v240, v6, s[28:31], 0 offen offset:0
    buffer_load_dword v241, v6, s[28:31], 0 offen offset:256
    buffer_load_dword v242, v6, s[28:31], 0 offen offset:512
    buffer_load_dword v243, v6, s[28:31], 0 offen offset:768
    buffer_load_dword v244, v6, s[28:31], 0 offen offset:2048
    buffer_load_dword v245, v6, s[28:31], 0 offen offset:2304
    s_waitcnt lgkmcnt(12)
    v_mfma_f32_32x32x16_bf16 v[64:79], v[96:99], v[112:115], v[64:79]
    v_mul_f32 v192, v128, v192
    v_mul_f32 v193, v129, v193
    v_cvt_pk_bf16_f32 v128, v128, v192
    v_cvt_pk_bf16_f32 v129, v129, v193
    v_mfma_f32_32x32x16_bf16 v[64:79], v[100:103], v[116:119], v[64:79]
    v_mul_f32 v194, v130, v194
    v_mul_f32 v195, v131, v195
    v_cvt_pk_bf16_f32 v130, v130, v194
    v_cvt_pk_bf16_f32 v131, v131, v195
    s_waitcnt lgkmcnt(8)
    v_mfma_f32_32x32x16_bf16 v[64:79], v[104:107], v[120:123], v[64:79]
    v_mul_f32 v196, v132, v196
    v_mul_f32 v197, v133, v197
    v_cvt_pk_bf16_f32 v132, v132, v196
    v_cvt_pk_bf16_f32 v133, v133, v197
    v_mfma_f32_32x32x16_bf16 v[64:79], v[108:111], v[124:127], v[64:79]
    v_mul_f32 v198, v134, v198
    v_mul_f32 v199, v135, v199
    v_cvt_pk_bf16_f32 v134, v134, v198
    v_cvt_pk_bf16_f32 v135, v135, v199
    s_waitcnt lgkmcnt(4)
    v_mul_f32 v200, v136, v200
    v_mul_f32 v201, v137, v201
    v_cvt_pk_bf16_f32 v136, v136, v200
    v_cvt_pk_bf16_f32 v137, v137, v201
    v_mul_f32 v202, v138, v202
    v_mul_f32 v203, v139, v203
    v_cvt_pk_bf16_f32 v138, v138, v202
    v_cvt_pk_bf16_f32 v139, v139, v203
    s_waitcnt lgkmcnt(0)
    v_mul_f32 v204, v140, v204
    v_mul_f32 v205, v141, v205
    v_cvt_pk_bf16_f32 v140, v140, v204
    v_cvt_pk_bf16_f32 v141, v141, v205
    v_mul_f32 v206, v142, v206
    v_mul_f32 v207, v143, v207
    v_cvt_pk_bf16_f32 v142, v142, v206
    v_cvt_pk_bf16_f32 v143, v143, v207
    s_nop 1
    v_mfma_f32_32x32x16_bf16 v[80:95], v[96:99], v[128:131], v[80:95]
    v_mfma_f32_32x32x16_bf16 v[80:95], v[100:103], v[132:135], v[80:95]
    v_mfma_f32_32x32x16_bf16 v[80:95], v[104:107], v[136:139], v[80:95]
    v_mfma_f32_32x32x16_bf16 v[80:95], v[108:111], v[140:143], v[80:95]
    s_branch K2_DONE
K2_LAST0P2:
    s_waitcnt lgkmcnt(12)
    v_mfma_f32_32x32x16_bf16 v[80:95], v[96:99], v[160:163], v[80:95]
    v_exp_f32 v128, v128
    v_mul_f32 v176, v112, v176
    v_exp_f32 v129, v129
    v_mul_f32 v177, v113, v177
    v_add_f32 v128, 1.0, v128
    v_cvt_pk_bf16_f32 v112, v112, v176
    v_add_f32 v129, 1.0, v129
    v_cvt_pk_bf16_f32 v113, v113, v177
    v_rcp_f32 v128, v128
    v_rcp_f32 v129, v129
    v_mfma_f32_32x32x16_bf16 v[80:95], v[100:103], v[164:167], v[80:95]
    v_cvt_pkrtz_f16_f32 v130, v130, v131
    v_mul_f32 v178, v114, v178
    v_and_b32_sdwa v131, s67, v130 dst_sel:DWORD dst_unused:UNUSED_PAD src0_sel:DWORD src1_sel:WORD_1
    v_mul_f32 v179, v115, v179
    v_and_b32 v130, s67, v130
    v_cvt_pk_bf16_f32 v114, v114, v178
    v_cvt_pk_bf16_f32 v115, v115, v179
    ds_read_u16_d16_hi v131, v131 offset:40960
    ds_read_u16_d16_hi v130, v130 offset:40960
    v_mfma_f32_32x32x16_bf16 v[80:95], v[104:107], v[168:171], v[80:95]
    v_mfma_f32_32x32x16_bf16 v[80:95], v[108:111], v[172:175], v[80:95]
    v_mfma_f32_32x32x16_bf16 v[96:111], v[32:35], v[28:31], 0
    s_nop 11
    s_waitcnt lgkmcnt(0)
    v_mfma_f32_32x32x16_bf16 v[64:79], v[96:99], v[112:115], v[64:79]
    v_mul_f32 v192, v128, v192
    v_mul_f32 v193, v129, v193
    v_cvt_pk_bf16_f32 v128, v128, v192
    v_cvt_pk_bf16_f32 v129, v129, v193
    v_mul_f32 v194, v130, v194
    v_mul_f32 v195, v131, v195
    v_cvt_pk_bf16_f32 v130, v130, v194
    v_cvt_pk_bf16_f32 v131, v131, v195
    s_nop 1
    v_mfma_f32_32x32x16_bf16 v[80:95], v[96:99], v[128:131], v[80:95]
    s_branch K2_DONE
K2_LAST0P4:
    s_waitcnt lgkmcnt(12)
    v_mfma_f32_32x32x16_bf16 v[80:95], v[96:99], v[160:163], v[80:95]
    v_exp_f32 v128, v128
    v_mul_f32 v176, v112, v176
    v_exp_f32 v129, v129
    v_mul_f32 v177, v113, v177
    v_add_f32 v128, 1.0, v128
    v_cvt_pk_bf16_f32 v112, v112, v176
    v_add_f32 v129, 1.0, v129
    v_cvt_pk_bf16_f32 v113, v113, v177
    v_rcp_f32 v128, v128
    v_rcp_f32 v129, v129
    v_mfma_f32_32x32x16_bf16 v[80:95], v[100:103], v[164:167], v[80:95]
    v_cvt_pkrtz_f16_f32 v130, v130, v131
    v_mul_f32 v178, v114, v178
    v_and_b32_sdwa v131, s67, v130 dst_sel:DWORD dst_unused:UNUSED_PAD src0_sel:DWORD src1_sel:WORD_1
    v_mul_f32 v179, v115, v179
    v_and_b32 v130, s67, v130
    v_cvt_pk_bf16_f32 v114, v114, v178
    v_cvt_pk_bf16_f32 v115, v115, v179
    ds_read_u16_d16_hi v131, v131 offset:40960
    ds_read_u16_d16_hi v130, v130 offset:40960
    s_waitcnt lgkmcnt(10)
    v_mfma_f32_32x32x16_bf16 v[80:95], v[104:107], v[168:171], v[80:95]
    v_cvt_pkrtz_f16_f32 v132, v132, v133
    v_mul_f32 v180, v116, v180
    v_and_b32_sdwa v133, s67, v132 dst_sel:DWORD dst_unused:UNUSED_PAD src0_sel:DWORD src1_sel:WORD_1
    v_mul_f32 v181, v117, v181
    v_and_b32 v132, s67, v132
    v_cvt_pk_bf16_f32 v116, v116, v180
    v_cvt_pk_bf16_f32 v117, v117, v181
    ds_read_u16_d16_hi v133, v133 offset:40960
    ds_read_u16_d16_hi v132, v132 offset:40960
    v_mfma_f32_32x32x16_bf16 v[80:95], v[108:111], v[172:175], v[80:95]
    v_cvt_pkrtz_f16_f32 v134, v134, v135
    v_mul_f32 v182, v118, v182
    v_and_b32_sdwa v135, s67, v134 dst_sel:DWORD dst_unused:UNUSED_PAD src0_sel:DWORD src1_sel:WORD_1
    v_mul_f32 v183, v119, v183
    v_and_b32 v134, s67, v134
    v_cvt_pk_bf16_f32 v118, v118, v182
    v_cvt_pk_bf16_f32 v119, v119, v183
    ds_read_u16_d16_hi v135, v135 offset:40960
    ds_read_u16_d16_hi v134, v134 offset:40960
    v_mfma_f32_32x32x16_bf16 v[96:111], v[32:35], v[28:31], 0
    s_nop 11
    s_waitcnt lgkmcnt(4)
    v_mfma_f32_32x32x16_bf16 v[64:79], v[96:99], v[112:115], v[64:79]
    v_mul_f32 v192, v128, v192
    v_mul_f32 v193, v129, v193
    v_cvt_pk_bf16_f32 v128, v128, v192
    v_cvt_pk_bf16_f32 v129, v129, v193
    v_mfma_f32_32x32x16_bf16 v[64:79], v[100:103], v[116:119], v[64:79]
    v_mul_f32 v194, v130, v194
    v_mul_f32 v195, v131, v195
    v_cvt_pk_bf16_f32 v130, v130, v194
    v_cvt_pk_bf16_f32 v131, v131, v195
    s_waitcnt lgkmcnt(0)
    v_mul_f32 v196, v132, v196
    v_mul_f32 v197, v133, v197
    v_cvt_pk_bf16_f32 v132, v132, v196
    v_cvt_pk_bf16_f32 v133, v133, v197
    v_mul_f32 v198, v134, v198
    v_mul_f32 v199, v135, v199
    v_cvt_pk_bf16_f32 v134, v134, v198
    v_cvt_pk_bf16_f32 v135, v135, v199
    s_nop 1
    v_mfma_f32_32x32x16_bf16 v[80:95], v[96:99], v[128:131], v[80:95]
    v_mfma_f32_32x32x16_bf16 v[80:95], v[100:103], v[132:135], v[80:95]
    s_branch K2_DONE
K2_LAST0P6:
    s_waitcnt lgkmcnt(12)
    v_mfma_f32_32x32x16_bf16 v[80:95], v[96:99], v[160:163], v[80:95]
    v_exp_f32 v128, v128
    v_mul_f32 v176, v112, v176
    v_exp_f32 v129, v129
    v_mul_f32 v177, v113, v177
    v_add_f32 v128, 1.0, v128
    v_cvt_pk_bf16_f32 v112, v112, v176
    v_add_f32 v129, 1.0, v129
    v_cvt_pk_bf16_f32 v113, v113, v177
    v_rcp_f32 v128, v128
    v_rcp_f32 v129, v129
    v_mfma_f32_32x32x16_bf16 v[80:95], v[100:103], v[164:167], v[80:95]
    v_cvt_pkrtz_f16_f32 v130, v130, v131
    v_mul_f32 v178, v114, v178
    v_and_b32_sdwa v131, s67, v130 dst_sel:DWORD dst_unused:UNUSED_PAD src0_sel:DWORD src1_sel:WORD_1
    v_mul_f32 v179, v115, v179
    v_and_b32 v130, s67, v130
    v_cvt_pk_bf16_f32 v114, v114, v178
    v_cvt_pk_bf16_f32 v115, v115, v179
    ds_read_u16_d16_hi v131, v131 offset:40960
    ds_read_u16_d16_hi v130, v130 offset:40960
    s_waitcnt lgkmcnt(10)
    v_mfma_f32_32x32x16_bf16 v[80:95], v[104:107], v[168:171], v[80:95]
    v_cvt_pkrtz_f16_f32 v132, v132, v133
    v_mul_f32 v180, v116, v180
    v_and_b32_sdwa v133, s67, v132 dst_sel:DWORD dst_unused:UNUSED_PAD src0_sel:DWORD src1_sel:WORD_1
    v_mul_f32 v181, v117, v181
    v_and_b32 v132, s67, v132
    v_cvt_pk_bf16_f32 v116, v116, v180
    v_cvt_pk_bf16_f32 v117, v117, v181
    ds_read_u16_d16_hi v133, v133 offset:40960
    ds_read_u16_d16_hi v132, v132 offset:40960
    v_mfma_f32_32x32x16_bf16 v[80:95], v[108:111], v[172:175], v[80:95]
    v_cvt_pkrtz_f16_f32 v134, v134, v135
    v_mul_f32 v182, v118, v182
    v_and_b32_sdwa v135, s67, v134 dst_sel:DWORD dst_unused:UNUSED_PAD src0_sel:DWORD src1_sel:WORD_1
    v_mul_f32 v183, v119, v183
    v_and_b32 v134, s67, v134
    v_cvt_pk_bf16_f32 v118, v118, v182
    v_cvt_pk_bf16_f32 v119, v119, v183
    ds_read_u16_d16_hi v135, v135 offset:40960
    ds_read_u16_d16_hi v134, v134 offset:40960
    s_waitcnt lgkmcnt(10)
    v_mfma_f32_32x32x16_bf16 v[96:111], v[32:35], v[28:31], 0
    v_cvt_pkrtz_f16_f32 v136, v136, v137
    v_mul_f32 v184, v120, v184
    v_and_b32_sdwa v137, s67, v136 dst_sel:DWORD dst_unused:UNUSED_PAD src0_sel:DWORD src1_sel:WORD_1
    v_mul_f32 v185, v121, v185
    v_and_b32 v136, s67, v136
    v_cvt_pk_bf16_f32 v120, v120, v184
    v_cvt_pk_bf16_f32 v121, v121, v185
    ds_read_u16_d16_hi v137, v137 offset:40960
    ds_read_u16_d16_hi v136, v136 offset:40960
    v_cvt_pkrtz_f16_f32 v138, v138, v139
    v_mul_f32 v186, v122, v186
    v_and_b32_sdwa v139, s67, v138 dst_sel:DWORD dst_unused:UNUSED_PAD src0_sel:DWORD src1_sel:WORD_1
    v_mul_f32 v187, v123, v187
    v_and_b32 v138, s67, v138
    v_cvt_pk_bf16_f32 v122, v122, v186
    v_cvt_pk_bf16_f32 v123, v123, v187
    ds_read_u16_d16_hi v139, v139 offset:40960
    ds_read_u16_d16_hi v138, v138 offset:40960
    s_waitcnt lgkmcnt(8)
    v_mfma_f32_32x32x16_bf16 v[64:79], v[96:99], v[112:115], v[64:79]
    v_mul_f32 v192, v128, v192
    v_mul_f32 v193, v129, v193
    v_cvt_pk_bf16_f32 v128, v128, v192
    v_cvt_pk_bf16_f32 v129, v129, v193
    v_mfma_f32_32x32x16_bf16 v[64:79], v[100:103], v[116:119], v[64:79]
    v_mul_f32 v194, v130, v194
    v_mul_f32 v195, v131, v195
    v_cvt_pk_bf16_f32 v130, v130, v194
    v_cvt_pk_bf16_f32 v131, v131, v195
    s_waitcnt lgkmcnt(4)
    v_mfma_f32_32x32x16_bf16 v[64:79], v[104:107], v[120:123], v[64:79]
    v_mul_f32 v196, v132, v196
    v_mul_f32 v197, v133, v197
    v_cvt_pk_bf16_f32 v132, v132, v196
    v_cvt_pk_bf16_f32 v133, v133, v197
    v_mul_f32 v198, v134, v198
    v_mul_f32 v199, v135, v199
    v_cvt_pk_bf16_f32 v134, v134, v198
    v_cvt_pk_bf16_f32 v135, v135, v199
    s_waitcnt lgkmcnt(0)
    v_mul_f32 v200, v136, v200
    v_mul_f32 v201, v137, v201
    v_cvt_pk_bf16_f32 v136, v136, v200
    v_cvt_pk_bf16_f32 v137, v137, v201
    v_mul_f32 v202, v138, v202
    v_mul_f32 v203, v139, v203
    v_cvt_pk_bf16_f32 v138, v138, v202
    v_cvt_pk_bf16_f32 v139, v139, v203
    s_nop 1
    v_mfma_f32_32x32x16_bf16 v[80:95], v[96:99], v[128:131], v[80:95]
    v_mfma_f32_32x32x16_bf16 v[80:95], v[100:103], v[132:135], v[80:95]
    v_mfma_f32_32x32x16_bf16 v[80:95], v[104:107], v[136:139], v[80:95]
    s_branch K2_DONE
K2_LAST1P2:
    s_waitcnt lgkmcnt(12)
    v_mfma_f32_32x32x16_bf16 v[80:95], v[96:99], v[128:131], v[80:95]
    v_exp_f32 v160, v160
    v_mul_f32 v208, v144, v208
    v_exp_f32 v161, v161
    v_mul_f32 v209, v145, v209
    v_add_f32 v160, 1.0, v160
    v_cvt_pk_bf16_f32 v144, v144, v208
    v_add_f32 v161, 1.0, v161
    v_cvt_pk_bf16_f32 v145, v145, v209
    v_rcp_f32 v160, v160
    v_rcp_f32 v161, v161
    v_mfma_f32_32x32x16_bf16 v[80:95], v[100:103], v[132:135], v[80:95]
    v_cvt_pkrtz_f16_f32 v162, v162, v163
    v_mul_f32 v210, v146, v210
    v_and_b32_sdwa v163, s67, v162 dst_sel:DWORD dst_unused:UNUSED_PAD src0_sel:DWORD src1_sel:WORD_1
    v_mul_f32 v211, v147, v211
    v_and_b32 v162, s67, v162
    v_cvt_pk_bf16_f32 v146, v146, v210
    v_cvt_pk_bf16_f32 v147, v147, v211
    ds_read_u16_d16_hi v163, v163 offset:40960
    ds_read_u16_d16_hi v162, v162 offset:40960
    v_mfma_f32_32x32x16_bf16 v[80:95], v[104:107], v[136:139], v[80:95]
    v_mfma_f32_32x32x16_bf16 v[80:95], v[108:111], v[140:143], v[80:95]
    v_mfma_f32_32x32x16_bf16 v[96:111], v[36:39], v[28:31], 0
    s_nop 11
    s_waitcnt lgkmcnt(0)
    v_mfma_f32_32x32x16_bf16 v[64:79], v[96:99], v[144:147], v[64:79]
    v_mul_f32 v224, v160, v224
    v_mul_f32 v225, v161, v225
    v_cvt_pk_bf16_f32 v160, v160, v224
    v_cvt_pk_bf16_f32 v161, v161, v225
    v_mul_f32 v226, v162, v226
    v_mul_f32 v227, v163, v227
    v_cvt_pk_bf16_f32 v162, v162, v226
    v_cvt_pk_bf16_f32 v163, v163, v227
    s_nop 1
    v_mfma_f32_32x32x16_bf16 v[80:95], v[96:99], v[160:163], v[80:95]
    s_branch K2_DONE
K2_LAST1P4:
    s_waitcnt lgkmcnt(12)
    v_mfma_f32_32x32x16_bf16 v[80:95], v[96:99], v[128:131], v[80:95]
    v_exp_f32 v160, v160
    v_mul_f32 v208, v144, v208
    v_exp_f32 v161, v161
    v_mul_f32 v209, v145, v209
    v_add_f32 v160, 1.0, v160
    v_cvt_pk_bf16_f32 v144, v144, v208
    v_add_f32 v161, 1.0, v161
    v_cvt_pk_bf16_f32 v145, v145, v209
    v_rcp_f32 v160, v160
    v_rcp_f32 v161, v161
    v_mfma_f32_32x32x16_bf16 v[80:95], v[100:103], v[132:135], v[80:95]
    v_cvt_pkrtz_f16_f32 v162, v162, v163
    v_mul_f32 v210, v146, v210
    v_and_b32_sdwa v163, s67, v162 dst_sel:DWORD dst_unused:UNUSED_PAD src0_sel:DWORD src1_sel:WORD_1
    v_mul_f32 v211, v147, v211
    v_and_b32 v162, s67, v162
    v_cvt_pk_bf16_f32 v146, v146, v210
    v_cvt_pk_bf16_f32 v147, v147, v211
    ds_read_u16_d16_hi v163, v163 offset:40960
    ds_read_u16_d16_hi v162, v162 offset:40960
    s_waitcnt lgkmcnt(10)
    v_mfma_f32_32x32x16_bf16 v[80:95], v[104:107], v[136:139], v[80:95]
    v_cvt_pkrtz_f16_f32 v164, v164, v165
    v_mul_f32 v212, v148, v212
    v_and_b32_sdwa v165, s67, v164 dst_sel:DWORD dst_unused:UNUSED_PAD src0_sel:DWORD src1_sel:WORD_1
    v_mul_f32 v213, v149, v213
    v_and_b32 v164, s67, v164
    v_cvt_pk_bf16_f32 v148, v148, v212
    v_cvt_pk_bf16_f32 v149, v149, v213
    ds_read_u16_d16_hi v165, v165 offset:40960
    ds_read_u16_d16_hi v164, v164 offset:40960
    v_mfma_f32_32x32x16_bf16 v[80:95], v[108:111], v[140:143], v[80:95]
    v_cvt_pkrtz_f16_f32 v166, v166, v167
    v_mul_f32 v214, v150, v214
    v_and_b32_sdwa v167, s67, v166 dst_sel:DWORD dst_unused:UNUSED_PAD src0_sel:DWORD src1_sel:WORD_1
    v_mul_f32 v215, v151, v215
    v_and_b32 v166, s67, v166
    v_cvt_pk_bf16_f32 v150, v150, v214
    v_cvt_pk_bf16_f32 v151, v151, v215
    ds_read_u16_d16_hi v167, v167 offset:40960
    ds_read_u16_d16_hi v166, v166 offset:40960
    v_mfma_f32_32x32x16_bf16 v[96:111], v[36:39], v[28:31], 0
    s_nop 11
    s_waitcnt lgkmcnt(4)
    v_mfma_f32_32x32x16_bf16 v[64:79], v[96:99], v[144:147], v[64:79]
    v_mul_f32 v224, v160, v224
    v_mul_f32 v225, v161, v225
    v_cvt_pk_bf16_f32 v160, v160, v224
    v_cvt_pk_bf16_f32 v161, v161, v225
    v_mfma_f32_32x32x16_bf16 v[64:79], v[100:103], v[148:151], v[64:79]
    v_mul_f32 v226, v162, v226
    v_mul_f32 v227, v163, v227
    v_cvt_pk_bf16_f32 v162, v162, v226
    v_cvt_pk_bf16_f32 v163, v163, v227
    s_waitcnt lgkmcnt(0)
    v_mul_f32 v228, v164, v228
    v_mul_f32 v229, v165, v229
    v_cvt_pk_bf16_f32 v164, v164, v228
    v_cvt_pk_bf16_f32 v165, v165, v229
    v_mul_f32 v230, v166, v230
    v_mul_f32 v231, v167, v231
    v_cvt_pk_bf16_f32 v166, v166, v230
    v_cvt_pk_bf16_f32 v167, v167, v231
    s_nop 1
    v_mfma_f32_32x32x16_bf16 v[80:95], v[96:99], v[160:163], v[80:95]
    v_mfma_f32_32x32x16_bf16 v[80:95], v[100:103], v[164:167], v[80:95]
    s_branch K2_DONE
K2_LAST1P6:
    s_waitcnt lgkmcnt(12)
    v_mfma_f32_32x32x16_bf16 v[80:95], v[96:99], v[128:131], v[80:95]
    v_exp_f32 v160, v160
    v_mul_f32 v208, v144, v208
    v_exp_f32 v161, v161
    v_mul_f32 v209, v145, v209
    v_add_f32 v160, 1.0, v160
    v_cvt_pk_bf16_f32 v144, v144, v208
    v_add_f32 v161, 1.0, v161
    v_cvt_pk_bf16_f32 v145, v145, v209
    v_rcp_f32 v160, v160
    v_rcp_f32 v161, v161
    v_mfma_f32_32x32x16_bf16 v[80:95], v[100:103], v[132:135], v[80:95]
    v_cvt_pkrtz_f16_f32 v162, v162, v163
    v_mul_f32 v210, v146, v210
    v_and_b32_sdwa v163, s67, v162 dst_sel:DWORD dst_unused:UNUSED_PAD src0_sel:DWORD src1_sel:WORD_1
    v_mul_f32 v211, v147, v211
    v_and_b32 v162, s67, v162
    v_cvt_pk_bf16_f32 v146, v146, v210
    v_cvt_pk_bf16_f32 v147, v147, v211
    ds_read_u16_d16_hi v163, v163 offset:40960
    ds_read_u16_d16_hi v162, v162 offset:40960
    s_waitcnt lgkmcnt(10)
    v_mfma_f32_32x32x16_bf16 v[80:95], v[104:107], v[136:139], v[80:95]
    v_cvt_pkrtz_f16_f32 v164, v164, v165
    v_mul_f32 v212, v148, v212
    v_and_b32_sdwa v165, s67, v164 dst_sel:DWORD dst_unused:UNUSED_PAD src0_sel:DWORD src1_sel:WORD_1
    v_mul_f32 v213, v149, v213
    v_and_b32 v164, s67, v164
    v_cvt_pk_bf16_f32 v148, v148, v212
    v_cvt_pk_bf16_f32 v149, v149, v213
    ds_read_u16_d16_hi v165, v165 offset:40960
    ds_read_u16_d16_hi v164, v164 offset:40960
    v_mfma_f32_32x32x16_bf16 v[80:95], v[108:111], v[140:143], v[80:95]
    v_cvt_pkrtz_f16_f32 v166, v166, v167
    v_mul_f32 v214, v150, v214
    v_and_b32_sdwa v167, s67, v166 dst_sel:DWORD dst_unused:UNUSED_PAD src0_sel:DWORD src1_sel:WORD_1
    v_mul_f32 v215, v151, v215
    v_and_b32 v166, s67, v166
    v_cvt_pk_bf16_f32 v150, v150, v214
    v_cvt_pk_bf16_f32 v151, v151, v215
    ds_read_u16_d16_hi v167, v167 offset:40960
    ds_read_u16_d16_hi v166, v166 offset:40960
    s_waitcnt lgkmcnt(10)
    v_mfma_f32_32x32x16_bf16 v[96:111], v[36:39], v[28:31], 0
    v_cvt_pkrtz_f16_f32 v168, v168, v169
    v_mul_f32 v216, v152, v216
    v_and_b32_sdwa v169, s67, v168 dst_sel:DWORD dst_unused:UNUSED_PAD src0_sel:DWORD src1_sel:WORD_1
    v_mul_f32 v217, v153, v217
    v_and_b32 v168, s67, v168
    v_cvt_pk_bf16_f32 v152, v152, v216
    v_cvt_pk_bf16_f32 v153, v153, v217
    ds_read_u16_d16_hi v169, v169 offset:40960
    ds_read_u16_d16_hi v168, v168 offset:40960
    v_cvt_pkrtz_f16_f32 v170, v170, v171
    v_mul_f32 v218, v154, v218
    v_and_b32_sdwa v171, s67, v170 dst_sel:DWORD dst_unused:UNUSED_PAD src0_sel:DWORD src1_sel:WORD_1
    v_mul_f32 v219, v155, v219
    v_and_b32 v170, s67, v170
    v_cvt_pk_bf16_f32 v154, v154, v218
    v_cvt_pk_bf16_f32 v155, v155, v219
    ds_read_u16_d16_hi v171, v171 offset:40960
    ds_read_u16_d16_hi v170, v170 offset:40960
    s_waitcnt lgkmcnt(8)
    v_mfma_f32_32x32x16_bf16 v[64:79], v[96:99], v[144:147], v[64:79]
    v_mul_f32 v224, v160, v224
    v_mul_f32 v225, v161, v225
    v_cvt_pk_bf16_f32 v160, v160, v224
    v_cvt_pk_bf16_f32 v161, v161, v225
    v_mfma_f32_32x32x16_bf16 v[64:79], v[100:103], v[148:151], v[64:79]
    v_mul_f32 v226, v162, v226
    v_mul_f32 v227, v163, v227
    v_cvt_pk_bf16_f32 v162, v162, v226
    v_cvt_pk_bf16_f32 v163, v163, v227
    s_waitcnt lgkmcnt(4)
    v_mfma_f32_32x32x16_bf16 v[64:79], v[104:107], v[152:155], v[64:79]
    v_mul_f32 v228, v164, v228
    v_mul_f32 v229, v165, v229
    v_cvt_pk_bf16_f32 v164, v164, v228
    v_cvt_pk_bf16_f32 v165, v165, v229
    v_mul_f32 v230, v166, v230
    v_mul_f32 v231, v167, v231
    v_cvt_pk_bf16_f32 v166, v166, v230
    v_cvt_pk_bf16_f32 v167, v167, v231
    s_waitcnt lgkmcnt(0)
    v_mul_f32 v232, v168, v232
    v_mul_f32 v233, v169, v233
    v_cvt_pk_bf16_f32 v168, v168, v232
    v_cvt_pk_bf16_f32 v169, v169, v233
    v_mul_f32 v234, v170, v234
    v_mul_f32 v235, v171, v235
    v_cvt_pk_bf16_f32 v170, v170, v234
    v_cvt_pk_bf16_f32 v171, v171, v235
    s_nop 1
    v_mfma_f32_32x32x16_bf16 v[80:95], v[96:99], v[160:163], v[80:95]
    v_mfma_f32_32x32x16_bf16 v[80:95], v[100:103], v[164:167], v[80:95]
    v_mfma_f32_32x32x16_bf16 v[80:95], v[104:107], v[168:171], v[80:95]
    s_branch K2_DONE
K2_BODYP0P:
    s_waitcnt lgkmcnt(13)
    s_setprio 2
    v_mfma_f32_32x32x16_bf16 v[80:95], v[96:99], v[160:163], v[80:95]
    v_exp_f32 v128, v128
    v_mul_f32 v176, v112, v176
    v_exp_f32 v129, v129
    v_mul_f32 v177, v113, v177
    v_add_f32 v128, 1.0, v128
    v_cvt_pk_bf16_f32 v112, v112, v176
    v_mfma_f32_32x32x16_bf16 v[80:95], v[100:103], v[164:167], v[80:95]
    v_add_f32 v129, 1.0, v129
    v_cvt_pk_bf16_f32 v113, v113, v177
    v_rcp_f32 v128, v128
    v_rcp_f32 v129, v129
    buffer_load_dword v224, v48, s[36:39], 0 offen offset:128
    buffer_load_dword v225, v49, s[36:39], 0 offen offset:128
    buffer_load_dword v226, v50, s[36:39], 0 offen offset:128
    buffer_load_dword v227, v51, s[36:39], 0 offen offset:128
    v_mfma_f32_32x32x16_bf16 v[80:95], v[104:107], v[168:171], v[80:95]
    v_cvt_pkrtz_f16_f32 v130, v130, v131
    v_mul_f32 v178, v114, v178
    v_and_b32_sdwa v131, s67, v130 dst_sel:DWORD dst_unused:UNUSED_PAD src0_sel:DWORD src1_sel:WORD_1
    v_mul_f32 v179, v115, v179
    v_and_b32 v130, s67, v130
    v_cvt_pk_bf16_f32 v114, v114, v178
    v_cvt_pk_bf16_f32 v115, v115, v179
    ds_read_u16_d16_hi v131, v131 offset:40960
    ds_read_u16_d16_hi v130, v130 offset:40960
    buffer_load_dword v228, v52, s[36:39], 0 offen offset:128
    buffer_load_dword v229, v53, s[36:39], 0 offen offset:128
    buffer_load_dword v230, v54, s[36:39], 0 offen offset:128
    buffer_load_dword v231, v55, s[36:39], 0 offen offset:128
    s_waitcnt lgkmcnt(4)
    v_mfma_f32_32x32x16_bf16 v[144:159], v[44:47], v[8:11], 0
    v_cvt_pkrtz_f16_f32 v132, v132, v133
    v_mul_f32 v180, v116, v180
    v_and_b32_sdwa v133, s67, v132 dst_sel:DWORD dst_unused:UNUSED_PAD src0_sel:DWORD src1_sel:WORD_1
    v_mul_f32 v181, v117, v181
    v_and_b32 v132, s67, v132
    v_cvt_pk_bf16_f32 v116, v116, v180
    v_cvt_pk_bf16_f32 v117, v117, v181
    ds_read_u16_d16_hi v133, v133 offset:40960
    ds_read_u16_d16_hi v132, v132 offset:40960
    buffer_load_dword v232, v56, s[36:39], 0 offen offset:128
    buffer_load_dword v233, v57, s[36:39], 0 offen offset:128
    buffer_load_dword v234, v58, s[36:39], 0 offen offset:128
    buffer_load_dword v235, v59, s[36:39], 0 offen offset:128
    v_mfma_f32_32x32x16_bf16 v[144:159], v[36:39], v[16:19], v[144:159]
    v_cvt_pkrtz_f16_f32 v134, v134, v135
    v_mul_f32 v182, v118, v182
    v_and_b32_sdwa v135, s67, v134 dst_sel:DWORD dst_unused:UNUSED_PAD src0_sel:DWORD src1_sel:WORD_1
    v_mul_f32 v183, v119, v183
    v_and_b32 v134, s67, v134
    v_cvt_pk_bf16_f32 v118, v118, v182
    v_cvt_pk_bf16_f32 v119, v119, v183
    ds_read_u16_d16_hi v135, v135 offset:40960
    ds_read_u16_d16_hi v134, v134 offset:40960
    buffer_load_dword v236, v60, s[36:39], 0 offen offset:128
    buffer_load_dword v237, v61, s[36:39], 0 offen offset:128
    buffer_load_dword v238, v62, s[36:39], 0 offen offset:128
    buffer_load_dword v239, v63, s[36:39], 0 offen offset:128
    s_waitcnt lgkmcnt(11)
    v_mfma_f32_32x32x16_bf16 v[80:95], v[108:111], v[172:175], v[80:95]
    v_cvt_pkrtz_f16_f32 v136, v136, v137
    v_mul_f32 v184, v120, v184
    v_and_b32_sdwa v137, s67, v136 dst_sel:DWORD dst_unused:UNUSED_PAD src0_sel:DWORD src1_sel:WORD_1
    v_mul_f32 v185, v121, v185
    v_and_b32 v136, s67, v136
    v_cvt_pk_bf16_f32 v120, v120, v184
    v_cvt_pk_bf16_f32 v121, v121, v185
    ds_read_u16_d16_hi v137, v137 offset:40960
    ds_read_u16_d16_hi v136, v136 offset:40960
    buffer_load_dword v240, v6, s[28:31], 0 offen offset:0
    buffer_load_dword v241, v6, s[28:31], 0 offen offset:256
    buffer_load_dword v242, v6, s[28:31], 0 offen offset:512
    buffer_load_dword v243, v6, s[28:31], 0 offen offset:768
    buffer_load_dword v244, v6, s[28:31], 0 offen offset:2048
    buffer_load_dword v245, v6, s[28:31], 0 offen offset:2304
    v_mfma_f32_32x32x16_bf16 v[96:111], v[32:35], v[28:31], 0
    v_cvt_pkrtz_f16_f32 v138, v138, v139
    v_mul_f32 v186, v122, v186
    v_and_b32_sdwa v139, s67, v138 dst_sel:DWORD dst_unused:UNUSED_PAD src0_sel:DWORD src1_sel:WORD_1
    v_mul_f32 v187, v123, v187
    s_waitcnt vmcnt(22)
    v_mfma_f32_4x4x4_16b_bf16 v[144:147], v[24:25], v[208:209], v[144:147]
    v_and_b32 v138, s67, v138
    v_mfma_f32_4x4x4_16b_bf16 v[148:151], v[24:25], v[212:213], v[148:151]
    v_cvt_pk_bf16_f32 v122, v122, v186
    v_cvt_pk_bf16_f32 v123, v123, v187
    ds_read_u16_d16_hi v139, v139 offset:40960
    ds_read_u16_d16_hi v138, v138 offset:40960
    s_waitcnt lgkmcnt(10)
    v_mfma_f32_4x4x4_16b_bf16 v[152:155], v[24:25], v[216:217], v[152:155]
    v_cvt_pkrtz_f16_f32 v140, v140, v141
    v_mfma_f32_4x4x4_16b_bf16 v[156:159], v[24:25], v[220:221], v[156:159]
    v_mul_f32 v188, v124, v188
    v_mfma_f32_4x4x4_16b_bf16 v[144:147], v[26:27], v[210:211], v[144:147]
    v_and_b32_sdwa v141, s67, v140 dst_sel:DWORD dst_unused:UNUSED_PAD src0_sel:DWORD src1_sel:WORD_1
    v_mfma_f32_4x4x4_16b_bf16 v[148:151], v[26:27], v[214:215], v[148:151]
    v_mul_f32 v189, v125, v189
    v_and_b32 v140, s67, v140
    v_cvt_pk_bf16_f32 v124, v124, v188
    v_cvt_pk_bf16_f32 v125, v125, v189
    ds_read_u16_d16_hi v141, v141 offset:40960
    ds_read_u16_d16_hi v140, v140 offset:40960
    v_mfma_f32_4x4x4_16b_bf16 v[152:155], v[26:27], v[218:219], v[152:155]
    v_cvt_pkrtz_f16_f32 v142, v142, v143
    v_mfma_f32_4x4x4_16b_bf16 v[156:159], v[26:27], v[222:223], v[156:159]
    v_mul_f32 v190, v126, v190
    v_and_b32_sdwa v143, s67, v142 dst_sel:DWORD dst_unused:UNUSED_PAD src0_sel:DWORD src1_sel:WORD_1
    v_mul_f32 v191, v127, v191
    v_and_b32 v142, s67, v142
    v_cvt_pk_bf16_f32 v126, v126, v190
    v_cvt_pk_bf16_f32 v127, v127, v191
    ds_read_u16_d16_hi v143, v143 offset:40960
    ds_read_u16_d16_hi v142, v142 offset:40960
K2_MIDP0P:
    s_waitcnt lgkmcnt(12)
    v_mfma_f32_32x32x16_bf16 v[64:79], v[96:99], v[112:115], v[64:79]
    v_exp_f32 v144, v144
    v_mul_f32 v192, v128, v192
    v_exp_f32 v145, v145
    v_mul_f32 v193, v129, v193
    v_add_f32 v144, 1.0, v144
    v_cvt_pk_bf16_f32 v128, v128, v192
    v_add_f32 v145, 1.0, v145
    v_cvt_pk_bf16_f32 v129, v129, v193
    v_rcp_f32 v144, v144
    v_rcp_f32 v145, v145
    v_mfma_f32_32x32x16_bf16 v[64:79], v[100:103], v[116:119], v[64:79]
    v_cvt_pkrtz_f16_f32 v146, v146, v147
    v_mul_f32 v194, v130, v194
    v_and_b32_sdwa v147, s67, v146 dst_sel:DWORD dst_unused:UNUSED_PAD src0_sel:DWORD src1_sel:WORD_1
    v_mul_f32 v195, v131, v195
    v_and_b32 v146, s67, v146
    v_cvt_pk_bf16_f32 v130, v130, v194
    v_cvt_pk_bf16_f32 v131, v131, v195
    ds_read_u16_d16_hi v147, v147 offset:40960
    ds_read_u16_d16_hi v146, v146 offset:40960
    s_waitcnt lgkmcnt(10)
    v_mfma_f32_32x32x16_bf16 v[160:175], v[44:47], v[12:15], 0
    v_cvt_pkrtz_f16_f32 v148, v148, v149
    v_mul_f32 v196, v132, v196
    v_and_b32_sdwa v149, s67, v148 dst_sel:DWORD dst_unused:UNUSED_PAD src0_sel:DWORD src1_sel:WORD_1
    v_mul_f32 v197, v133, v197
    v_and_b32 v148, s67, v148
    v_cvt_pk_bf16_f32 v132, v132, v196
    v_cvt_pk_bf16_f32 v133, v133, v197
    ds_read_u16_d16_hi v149, v149 offset:40960
    ds_read_u16_d16_hi v148, v148 offset:40960
    v_mfma_f32_32x32x16_bf16 v[160:175], v[36:39], v[20:23], v[160:175]
    v_cvt_pkrtz_f16_f32 v150, v150, v151
    v_mul_f32 v198, v134, v198
    v_and_b32_sdwa v151, s67, v150 dst_sel:DWORD dst_unused:UNUSED_PAD src0_sel:DWORD src1_sel:WORD_1
    v_mul_f32 v199, v135, v199
    v_and_b32 v150, s67, v150
    v_cvt_pk_bf16_f32 v134, v134, v198
    v_cvt_pk_bf16_f32 v135, v135, v199
    ds_read_u16_d16_hi v151, v151 offset:40960
    ds_read_u16_d16_hi v150, v150 offset:40960
    s_waitcnt lgkmcnt(10)
    s_setprio 0
    v_mfma_f32_32x32x16_bf16 v[64:79], v[104:107], v[120:123], v[64:79]
    v_cvt_pkrtz_f16_f32 v152, v152, v153
    v_mul_f32 v200, v136, v200
    v_and_b32_sdwa v153, s67, v152 dst_sel:DWORD dst_unused:UNUSED_PAD src0_sel:DWORD src1_sel:WORD_1
    v_mul_f32 v201, v137, v201
    v_and_b32 v152, s67, v152
    v_cvt_pk_bf16_f32 v136, v136, v200
    v_cvt_pk_bf16_f32 v137, v137, v201
    ds_read_u16_d16_hi v153, v153 offset:40960
    ds_read_u16_d16_hi v152, v152 offset:40960
    v_mfma_f32_32x32x16_bf16 v[64:79], v[108:111], v[124:127], v[64:79]
    v_cvt_pkrtz_f16_f32 v154, v154, v155
    v_mul_f32 v202, v138, v202
    v_and_b32_sdwa v155, s67, v154 dst_sel:DWORD dst_unused:UNUSED_PAD src0_sel:DWORD src1_sel:WORD_1
    v_mul_f32 v203, v139, v203
    s_waitcnt vmcnt(6)
    v_mfma_f32_4x4x4_16b_bf16 v[160:163], v[24:25], v[224:225], v[160:163]
    v_and_b32 v154, s67, v154
    v_mfma_f32_4x4x4_16b_bf16 v[164:167], v[24:25], v[228:229], v[164:167]
    v_cvt_pk_bf16_f32 v138, v138, v202
    v_cvt_pk_bf16_f32 v139, v139, v203
    ds_read_u16_d16_hi v155, v155 offset:40960
    ds_read_u16_d16_hi v154, v154 offset:40960
    s_waitcnt lgkmcnt(10)
    v_mfma_f32_4x4x4_16b_bf16 v[168:171], v[24:25], v[232:233], v[168:171]
    v_cvt_pkrtz_f16_f32 v156, v156, v157
    v_mfma_f32_4x4x4_16b_bf16 v[172:175], v[24:25], v[236:237], v[172:175]
    v_mul_f32 v204, v140, v204
    v_mfma_f32_4x4x4_16b_bf16 v[160:163], v[26:27], v[226:227], v[160:163]
    v_and_b32_sdwa v157, s67, v156 dst_sel:DWORD dst_unused:UNUSED_PAD src0_sel:DWORD src1_sel:WORD_1
    v_mfma_f32_4x4x4_16b_bf16 v[164:167], v[26:27], v[230:231], v[164:167]
    v_mul_f32 v205, v141, v205
    v_and_b32 v156, s67, v156
    v_cvt_pk_bf16_f32 v140, v140, v204
    v_cvt_pk_bf16_f32 v141, v141, v205
    ds_read_u16_d16_hi v157, v157 offset:40960
    ds_read_u16_d16_hi v156, v156 offset:40960
    v_mfma_f32_4x4x4_16b_bf16 v[168:171], v[26:27], v[234:235], v[168:171]
    v_cvt_pkrtz_f16_f32 v158, v158, v159
    v_mfma_f32_4x4x4_16b_bf16 v[172:175], v[26:27], v[238:239], v[172:175]
    v_mul_f32 v206, v142, v206
    v_and_b32_sdwa v159, s67, v158 dst_sel:DWORD dst_unused:UNUSED_PAD src0_sel:DWORD src1_sel:WORD_1
    v_mul_f32 v207, v143, v207
    v_and_b32 v158, s67, v158
    v_cvt_pk_bf16_f32 v142, v142, v206
    v_cvt_pk_bf16_f32 v143, v143, v207
    ds_read_u16_d16_hi v159, v159 offset:40960
    ds_read_u16_d16_hi v158, v158 offset:40960
    s_cmp_eq_u32 s20, 2
    s_cbranch_scc1 K2_LAST1P2
    s_cmp_eq_u32 s20, 4
    s_cbranch_scc1 K2_LAST1P4
    s_cmp_eq_u32 s20, 6
    s_cbranch_scc1 K2_LAST1P6
K2_LAST1P8:
    s_waitcnt lgkmcnt(12)
    v_mfma_f32_32x32x16_bf16 v[80:95], v[96:99], v[128:131], v[80:95]
    v_exp_f32 v160, v160
    v_mul_f32 v208, v144, v208
    v_exp_f32 v161, v161
    v_mul_f32 v209, v145, v209
    v_add_f32 v160, 1.0, v160
    v_cvt_pk_bf16_f32 v144, v144, v208
    v_add_f32 v161, 1.0, v161
    v_cvt_pk_bf16_f32 v145, v145, v209
    v_rcp_f32 v160, v160
    v_rcp_f32 v161, v161
    v_mfma_f32_32x32x16_bf16 v[80:95], v[100:103], v[132:135], v[80:95]
    v_cvt_pkrtz_f16_f32 v162, v162, v163
    v_mul_f32 v210, v146, v210
    v_and_b32_sdwa v163, s67, v162 dst_sel:DWORD dst_unused:UNUSED_PAD src0_sel:DWORD src1_sel:WORD_1
    v_mul_f32 v211, v147, v211
    v_and_b32 v162, s67, v162
    v_cvt_pk_bf16_f32 v146, v146, v210
    v_cvt_pk_bf16_f32 v147, v147, v211
    ds_read_u16_d16_hi v163, v163 offset:40960
    ds_read_u16_d16_hi v162, v162 offset:40960
    s_waitcnt lgkmcnt(10)
    v_mfma_f32_32x32x16_bf16 v[80:95], v[104:107], v[136:139], v[80:95]
    v_cvt_pkrtz_f16_f32 v164, v164, v165
    v_mul_f32 v212, v148, v212
    v_and_b32_sdwa v165, s67, v164 dst_sel:DWORD dst_unused:UNUSED_PAD src0_sel:DWORD src1_sel:WORD_1
    v_mul_f32 v213, v149, v213
    v_and_b32 v164, s67, v164
    v_cvt_pk_bf16_f32 v148, v148, v212
    v_cvt_pk_bf16_f32 v149, v149, v213
    ds_read_u16_d16_hi v165, v165 offset:40960
    ds_read_u16_d16_hi v164, v164 offset:40960
    v_mfma_f32_32x32x16_bf16 v[80:95], v[108:111], v[140:143], v[80:95]
    v_cvt_pkrtz_f16_f32 v166, v166, v167
    v_mul_f32 v214, v150, v214
    v_and_b32_sdwa v167, s67, v166 dst_sel:DWORD dst_unused:UNUSED_PAD src0_sel:DWORD src1_sel:WORD_1
    v_mul_f32 v215, v151, v215
    v_and_b32 v166, s67, v166
    v_cvt_pk_bf16_f32 v150, v150, v214
    v_cvt_pk_bf16_f32 v151, v151, v215
    ds_read_u16_d16_hi v167, v167 offset:40960
    ds_read_u16_d16_hi v166, v166 offset:40960
    s_waitcnt lgkmcnt(10)
    v_mfma_f32_32x32x16_bf16 v[96:111], v[36:39], v[28:31], 0
    v_cvt_pkrtz_f16_f32 v168, v168, v169
    v_mul_f32 v216, v152, v216
    v_and_b32_sdwa v169, s67, v168 dst_sel:DWORD dst_unused:UNUSED_PAD src0_sel:DWORD src1_sel:WORD_1
    v_mul_f32 v217, v153, v217
    v_and_b32 v168, s67, v168
    v_cvt_pk_bf16_f32 v152, v152, v216
    v_cvt_pk_bf16_f32 v153, v153, v217
    ds_read_u16_d16_hi v169, v169 offset:40960
    ds_read_u16_d16_hi v168, v168 offset:40960
    v_cvt_pkrtz_f16_f32 v170, v170, v171
    v_mul_f32 v218, v154, v218
    v_and_b32_sdwa v171, s67, v170 dst_sel:DWORD dst_unused:UNUSED_PAD src0_sel:DWORD src1_sel:WORD_1
    v_mul_f32 v219, v155, v219
    v_and_b32 v170, s67, v170
    v_cvt_pk_bf16_f32 v154, v154, v218
    v_cvt_pk_bf16_f32 v155, v155, v219
    ds_read_u16_d16_hi v171, v171 offset:40960
    ds_read_u16_d16_hi v170, v170 offset:40960
    s_waitcnt lgkmcnt(10)
    v_cvt_pkrtz_f16_f32 v172, v172, v173
    v_mul_f32 v220, v156, v220
    v_and_b32_sdwa v173, s67, v172 dst_sel:DWORD dst_unused:UNUSED_PAD src0_sel:DWORD src1_sel:WORD_1
    v_mul_f32 v221, v157, v221
    v_and_b32 v172, s67, v172
    v_cvt_pk_bf16_f32 v156, v156, v220
    v_cvt_pk_bf16_f32 v157, v157, v221
    ds_read_u16_d16_hi v173, v173 offset:40960
    ds_read_u16_d16_hi v172, v172 offset:40960
    v_cvt_pkrtz_f16_f32 v174, v174, v175
    v_mul_f32 v222, v158, v222
    v_and_b32_sdwa v175, s67, v174 dst_sel:DWORD dst_unused:UNUSED_PAD src0_sel:DWORD src1_sel:WORD_1
    v_mul_f32 v223, v159, v223
    v_and_b32 v174, s67, v174
    v_cvt_pk_bf16_f32 v158, v158, v222
    v_cvt_pk_bf16_f32 v159, v159, v223
    ds_read_u16_d16_hi v175, v175 offset:40960
    ds_read_u16_d16_hi v174, v174 offset:40960
    s_waitcnt lgkmcnt(12)
    v_mfma_f32_32x32x16_bf16 v[64:79], v[96:99], v[144:147], v[64:79]
    v_mul_f32 v224, v160, v224
    v_mul_f32 v225, v161, v225
    v_cvt_pk_bf16_f32 v160, v160, v224
    v_cvt_pk_bf16_f32 v161, v161, v225
    v_mfma_f32_32x32x16_bf16 v[64:79], v[100:103], v[148:151], v[64:79]
    v_mul_f32 v226, v162, v226
    v_mul_f32 v227, v163, v227
    v_cvt_pk_bf16_f32 v162, v162, v226
    v_cvt_pk_bf16_f32 v163, v163, v227
    s_waitcnt lgkmcnt(8)
    v_mfma_f32_32x32x16_bf16 v[64:79], v[104:107], v[152:155], v[64:79]
    v_mul_f32 v228, v164, v228
    v_mul_f32 v229, v165, v229
    v_cvt_pk_bf16_f32 v164, v164, v228
    v_cvt_pk_bf16_f32 v165, v165, v229
    v_mfma_f32_32x32x16_bf16 v[64:79], v[108:111], v[156:159], v[64:79]
    v_mul_f32 v230, v166, v230
    v_mul_f32 v231, v167, v231
    v_cvt_pk_bf16_f32 v166, v166, v230
    v_cvt_pk_bf16_f32 v167, v167, v231
    s_waitcnt lgkmcnt(4)
    v_mul_f32 v232, v168, v232
    v_mul_f32 v233, v169, v233
    v_cvt_pk_bf16_f32 v168, v168, v232
    v_cvt_pk_bf16_f32 v169, v169, v233
    v_mul_f32 v234, v170, v234
    v_mul_f32 v235, v171, v235
    v_cvt_pk_bf16_f32 v170, v170, v234
    v_cvt_pk_bf16_f32 v171, v171, v235
    s_waitcnt lgkmcnt(0)
    v_mul_f32 v236, v172, v236
    v_mul_f32 v237, v173, v237
    v_cvt_pk_bf16_f32 v172, v172, v236
    v_cvt_pk_bf16_f32 v173, v173, v237
    v_mul_f32 v238, v174, v238
    v_mul_f32 v239, v175, v239
    v_cvt_pk_bf16_f32 v174, v174, v238
    v_cvt_pk_bf16_f32 v175, v175, v239
    s_nop 1
    v_mfma_f32_32x32x16_bf16 v[80:95], v[96:99], v[160:163], v[80:95]
    v_mfma_f32_32x32x16_bf16 v[80:95], v[100:103], v[164:167], v[80:95]
    v_mfma_f32_32x32x16_bf16 v[80:95], v[104:107], v[168:171], v[80:95]
    v_mfma_f32_32x32x16_bf16 v[80:95], v[108:111], v[172:175], v[80:95]
    s_branch K2_DONE
K2_BODYP1P:
    s_waitcnt lgkmcnt(13)
    s_setprio 2
    v_mfma_f32_32x32x16_bf16 v[80:95], v[96:99], v[128:131], v[80:95]
    v_exp_f32 v160, v160
    v_mul_f32 v208, v144, v208
    v_exp_f32 v161, v161
    v_mul_f32 v209, v145, v209
    v_add_f32 v160, 1.0, v160
    v_cvt_pk_bf16_f32 v144, v144, v208
    v_mfma_f32_32x32x16_bf16 v[80:95], v[100:103], v[132:135], v[80:95]
    v_add_f32 v161, 1.0, v161
    v_cvt_pk_bf16_f32 v145, v145, v209
    v_rcp_f32 v160, v160
    v_rcp_f32 v161, v161
    buffer_load_dword v192, v48, s[36:39], 0 offen offset:128
    buffer_load_dword v193, v49, s[36:39], 0 offen offset:128
    buffer_load_dword v194, v50, s[36:39], 0 offen offset:128
    buffer_load_dword v195, v51, s[36:39], 0 offen offset:128
    v_mfma_f32_32x32x16_bf16 v[80:95], v[104:107], v[136:139], v[80:95]
    v_cvt_pkrtz_f16_f32 v162, v162, v163
    v_mul_f32 v210, v146, v210
    v_and_b32_sdwa v163, s67, v162 dst_sel:DWORD dst_unused:UNUSED_PAD src0_sel:DWORD src1_sel:WORD_1
    v_mul_f32 v211, v147, v211
    v_and_b32 v162, s67, v162
    v_cvt_pk_bf16_f32 v146, v146, v210
    v_cvt_pk_bf16_f32 v147, v147, v211
    ds_read_u16_d16_hi v163, v163 offset:40960
    ds_read_u16_d16_hi v162, v162 offset:40960
    buffer_load_dword v196, v52, s[36:39], 0 offen offset:128
    buffer_load_dword v197, v53, s[36:39], 0 offen offset:128
    buffer_load_dword v198, v54, s[36:39], 0 offen offset:128
    buffer_load_dword v199, v55, s[36:39], 0 offen offset:128
    s_waitcnt lgkmcnt(4)
    v_mfma_f32_32x32x16_bf16 v[112:127], v[40:43], v[8:11], 0
    v_cvt_pkrtz_f16_f32 v164, v164, v165
    v_mul_f32 v212, v148, v212
    v_and_b32_sdwa v165, s67, v164 dst_sel:DWORD dst_unused:UNUSED_PAD src0_sel:DWORD src1_sel:WORD_1
    v_mul_f32 v213, v149, v213
    v_and_b32 v164, s67, v164
    v_cvt_pk_bf16_f32 v148, v148, v212
    v_cvt_pk_bf16_f32 v149, v149, v213
    ds_read_u16_d16_hi v165, v165 offset:40960
    ds_read_u16_d16_hi v164, v164 offset:40960
    buffer_load_dword v200, v56, s[36:39], 0 offen offset:128
    buffer_load_dword v201, v57, s[36:39], 0 offen offset:128
    buffer_load_dword v202, v58, s[36:39], 0 offen offset:128
    buffer_load_dword v203, v59, s[36:39], 0 offen offset:128
    v_mfma_f32_32x32x16_bf16 v[112:127], v[32:35], v[16:19], v[112:127]
    v_cvt_pkrtz_f16_f32 v166, v166, v167
    v_mul_f32 v214, v150, v214
    v_and_b32_sdwa v167, s67, v166 dst_sel:DWORD dst_unused:UNUSED_PAD src0_sel:DWORD src1_sel:WORD_1
    v_mul_f32 v215, v151, v215
    v_and_b32 v166, s67, v166
    v_cvt_pk_bf16_f32 v150, v150, v214
    v_cvt_pk_bf16_f32 v151, v151, v215
    ds_read_u16_d16_hi v167, v167 offset:40960
    ds_read_u16_d16_hi v166, v166 offset:40960
    buffer_load_dword v204, v60, s[36:39], 0 offen offset:128
    buffer_load_dword v205, v61, s[36:39], 0 offen offset:128
    buffer_load_dword v206, v62, s[36:39], 0 offen offset:128
    buffer_load_dword v207, v63, s[36:39], 0 offen offset:128
    s_waitcnt lgkmcnt(11)
    v_mfma_f32_32x32x16_bf16 v[80:95], v[108:111], v[140:143], v[80:95]
    v_cvt_pkrtz_f16_f32 v168, v168, v169
    v_mul_f32 v216, v152, v216
    v_and_b32_sdwa v169, s67, v168 dst_sel:DWORD dst_unused:UNUSED_PAD src0_sel:DWORD src1_sel:WORD_1
    v_mul_f32 v217, v153, v217
    v_and_b32 v168, s67, v168
    v_cvt_pk_bf16_f32 v152, v152, v216
    v_cvt_pk_bf16_f32 v153, v153, v217
    ds_read_u16_d16_hi v169, v169 offset:40960
    ds_read_u16_d16_hi v168, v168 offset:40960
    buffer_load_dword v240, v6, s[28:31], 0 offen offset:0
    buffer_load_dword v241, v6, s[28:31], 0 offen offset:256
    buffer_load_dword v242, v6, s[28:31], 0 offen offset:512
    buffer_load_dword v243, v6, s[28:31], 0 offen offset:768
    buffer_load_dword v244, v6, s[28:31], 0 offen offset:2048
    buffer_load_dword v245, v6, s[28:31], 0 offen offset:2304
    v_mfma_f32_32x32x16_bf16 v[96:111], v[36:39], v[28:31], 0
    v_cvt_pkrtz_f16_f32 v170, v170, v171
    v_mul_f32 v218, v154, v218
    v_and_b32_sdwa v171, s67, v170 dst_sel:DWORD dst_unused:UNUSED_PAD src0_sel:DWORD src1_sel:WORD_1
    v_mul_f32 v219, v155, v219
    s_waitcnt vmcnt(22)
    v_mfma_f32_4x4x4_16b_bf16 v[112:115], v[24:25], v[176:177], v[112:115]
    v_and_b32 v170, s67, v170
    v_mfma_f32_4x4x4_16b_bf16 v[116:119], v[24:25], v[180:181], v[116:119]
    v_cvt_pk_bf16_f32 v154, v154, v218
    v_cvt_pk_bf16_f32 v155, v155, v219
    ds_read_u16_d16_hi v171, v171 offset:40960
    ds_read_u16_d16_hi v170, v170 offset:40960
    s_waitcnt lgkmcnt(10)
    v_mfma_f32_4x4x4_16b_bf16 v[120:123], v[24:25], v[184:185], v[120:123]
    v_cvt_pkrtz_f16_f32 v172, v172, v173
    v_mfma_f32_4x4x4_16b_bf16 v[124:127], v[24:25], v[188:189], v[124:127]
    v_mul_f32 v220, v156, v220
    v_mfma_f32_4x4x4_16b_bf16 v[112:115], v[26:27], v[178:179], v[112:115]
    v_and_b32_sdwa v173, s67, v172 dst_sel:DWORD dst_unused:UNUSED_PAD src0_sel:DWORD src1_sel:WORD_1
    v_mfma_f32_4x4x4_16b_bf16 v[116:119], v[26:27], v[182:183], v[116:119]
    v_mul_f32 v221, v157, v221
    v_and_b32 v172, s67, v172
    v_cvt_pk_bf16_f32 v156, v156, v220
    v_cvt_pk_bf16_f32 v157, v157, v221
    ds_read_u16_d16_hi v173, v173 offset:40960
    ds_read_u16_d16_hi v172, v172 offset:40960
    v_mfma_f32_4x4x4_16b_bf16 v[120:123], v[26:27], v[186:187], v[120:123]
    v_cvt_pkrtz_f16_f32 v174, v174, v175
    v_mfma_f32_4x4x4_16b_bf16 v[124:127], v[26:27], v[190:191], v[124:127]
    v_mul_f32 v222, v158, v222
    v_and_b32_sdwa v175, s67, v174 dst_sel:DWORD dst_unused:UNUSED_PAD src0_sel:DWORD src1_sel:WORD_1
    v_mul_f32 v223, v159, v223
    v_and_b32 v174, s67, v174
    v_cvt_pk_bf16_f32 v158, v158, v222
    v_cvt_pk_bf16_f32 v159, v159, v223
    ds_read_u16_d16_hi v175, v175 offset:40960
    ds_read_u16_d16_hi v174, v174 offset:40960
K2_MIDP1P:
    s_waitcnt lgkmcnt(12)
    v_mfma_f32_32x32x16_bf16 v[64:79], v[96:99], v[144:147], v[64:79]
    v_exp_f32 v112, v112
    v_mul_f32 v224, v160, v224
    v_exp_f32 v113, v113
    v_mul_f32 v225, v161, v225
    v_add_f32 v112, 1.0, v112
    v_cvt_pk_bf16_f32 v160, v160, v224
    v_add_f32 v113, 1.0, v113
    v_cvt_pk_bf16_f32 v161, v161, v225
    v_rcp_f32 v112, v112
    v_rcp_f32 v113, v113
    v_mfma_f32_32x32x16_bf16 v[64:79], v[100:103], v[148:151], v[64:79]
    v_cvt_pkrtz_f16_f32 v114, v114, v115
    v_mul_f32 v226, v162, v226
    v_and_b32_sdwa v115, s67, v114 dst_sel:DWORD dst_unused:UNUSED_PAD src0_sel:DWORD src1_sel:WORD_1
    v_mul_f32 v227, v163, v227
    v_and_b32 v114, s67, v114
    v_cvt_pk_bf16_f32 v162, v162, v226
    v_cvt_pk_bf16_f32 v163, v163, v227
    ds_read_u16_d16_hi v115, v115 offset:40960
    ds_read_u16_d16_hi v114, v114 offset:40960
    s_waitcnt lgkmcnt(10)
    v_mfma_f32_32x32x16_bf16 v[128:143], v[40:43], v[12:15], 0
    v_cvt_pkrtz_f16_f32 v116, v116, v117
    v_mul_f32 v228, v164, v228
    v_and_b32_sdwa v117, s67, v116 dst_sel:DWORD dst_unused:UNUSED_PAD src0_sel:DWORD src1_sel:WORD_1
    v_mul_f32 v229, v165, v229
    v_and_b32 v116, s67, v116
    v_cvt_pk_bf16_f32 v164, v164, v228
    v_cvt_pk_bf16_f32 v165, v165, v229
    ds_read_u16_d16_hi v117, v117 offset:40960
    ds_read_u16_d16_hi v116, v116 offset:40960
    v_mfma_f32_32x32x16_bf16 v[128:143], v[32:35], v[20:23], v[128:143]
    v_cvt_pkrtz_f16_f32 v118, v118, v119
    v_mul_f32 v230, v166, v230
    v_and_b32_sdwa v119, s67, v118 dst_sel:DWORD dst_unused:UNUSED_PAD src0_sel:DWORD src1_sel:WORD_1
    v_mul_f32 v231, v167, v231
    v_and_b32 v118, s67, v118
    v_cvt_pk_bf16_f32 v166, v166, v230
    v_cvt_pk_bf16_f32 v167, v167, v231
    ds_read_u16_d16_hi v119, v119 offset:40960
    ds_read_u16_d16_hi v118, v118 offset:40960
    s_waitcnt lgkmcnt(10)
    s_setprio 0
    v_mfma_f32_32x32x16_bf16 v[64:79], v[104:107], v[152:155], v[64:79]
    v_cvt_pkrtz_f16_f32 v120, v120, v121
    v_mul_f32 v232, v168, v232
    v_and_b32_sdwa v121, s67, v120 dst_sel:DWORD dst_unused:UNUSED_PAD src0_sel:DWORD src1_sel:WORD_1
    v_mul_f32 v233, v169, v233
    v_and_b32 v120, s67, v120
    v_cvt_pk_bf16_f32 v168, v168, v232
    v_cvt_pk_bf16_f32 v169, v169, v233
    ds_read_u16_d16_hi v121, v121 offset:40960
    ds_read_u16_d16_hi v120, v120 offset:40960
    v_mfma_f32_32x32x16_bf16 v[64:79], v[108:111], v[156:159], v[64:79]
    v_cvt_pkrtz_f16_f32 v122, v122, v123
    v_mul_f32 v234, v170, v234
    v_and_b32_sdwa v123, s67, v122 dst_sel:DWORD dst_unused:UNUSED_PAD src0_sel:DWORD src1_sel:WORD_1
    v_mul_f32 v235, v171, v235
    s_waitcnt vmcnt(6)
    v_mfma_f32_4x4x4_16b_bf16 v[128:131], v[24:25], v[192:193], v[128:131]
    v_and_b32 v122, s67, v122
    v_mfma_f32_4x4x4_16b_bf16 v[132:135], v[24:25], v[196:197], v[132:135]
    v_cvt_pk_bf16_f32 v170, v170, v234
    v_cvt_pk_bf16_f32 v171, v171, v235
    ds_read_u16_d16_hi v123, v123 offset:40960
    ds_read_u16_d16_hi v122, v122 offset:40960
    s_waitcnt lgkmcnt(10)
    v_mfma_f32_4x4x4_16b_bf16 v[136:139], v[24:25], v[200:201], v[136:139]
    v_cvt_pkrtz_f16_f32 v124, v124, v125
    v_mfma_f32_4x4x4_16b_bf16 v[140:143], v[24:25], v[204:205], v[140:143]
    v_mul_f32 v236, v172, v236
    v_mfma_f32_4x4x4_16b_bf16 v[128:131], v[26:27], v[194:195], v[128:131]
    v_and_b32_sdwa v125, s67, v124 dst_sel:DWORD dst_unused:UNUSED_PAD src0_sel:DWORD src1_sel:WORD_1
    v_mfma_f32_4x4x4_16b_bf16 v[132:135], v[26:27], v[198:199], v[132:135]
    v_mul_f32 v237, v173, v237
    v_and_b32 v124, s67, v124
    v_cvt_pk_bf16_f32 v172, v172, v236
    v_cvt_pk_bf16_f32 v173, v173, v237
    ds_read_u16_d16_hi v125, v125 offset:40960
    ds_read_u16_d16_hi v124, v124 offset:40960
    v_mfma_f32_4x4x4_16b_bf16 v[136:139], v[26:27], v[202:203], v[136:139]
    v_cvt_pkrtz_f16_f32 v126, v126, v127
    v_mfma_f32_4x4x4_16b_bf16 v[140:143], v[26:27], v[206:207], v[140:143]
    v_mul_f32 v238, v174, v238
    v_and_b32_sdwa v127, s67, v126 dst_sel:DWORD dst_unused:UNUSED_PAD src0_sel:DWORD src1_sel:WORD_1
    v_mul_f32 v239, v175, v239
    v_and_b32 v126, s67, v126
    v_cvt_pk_bf16_f32 v174, v174, v238
    v_cvt_pk_bf16_f32 v175, v175, v239
    ds_read_u16_d16_hi v127, v127 offset:40960
    ds_read_u16_d16_hi v126, v126 offset:40960
    s_cmp_eq_u32 s20, 2
    s_cbranch_scc1 K2_LAST0P2
    s_cmp_eq_u32 s20, 4
    s_cbranch_scc1 K2_LAST0P4
    s_cmp_eq_u32 s20, 6
    s_cbranch_scc1 K2_LAST0P6
K2_LAST0P8:
    s_waitcnt lgkmcnt(12)
    v_mfma_f32_32x32x16_bf16 v[80:95], v[96:99], v[160:163], v[80:95]
    v_exp_f32 v128, v128
    v_mul_f32 v176, v112, v176
    v_exp_f32 v129, v129
    v_mul_f32 v177, v113, v177
    v_add_f32 v128, 1.0, v128
    v_cvt_pk_bf16_f32 v112, v112, v176
    v_add_f32 v129, 1.0, v129
    v_cvt_pk_bf16_f32 v113, v113, v177
    v_rcp_f32 v128, v128
    v_rcp_f32 v129, v129
    v_mfma_f32_32x32x16_bf16 v[80:95], v[100:103], v[164:167], v[80:95]
    v_cvt_pkrtz_f16_f32 v130, v130, v131
    v_mul_f32 v178, v114, v178
    v_and_b32_sdwa v131, s67, v130 dst_sel:DWORD dst_unused:UNUSED_PAD src0_sel:DWORD src1_sel:WORD_1
    v_mul_f32 v179, v115, v179
    v_and_b32 v130, s67, v130
    v_cvt_pk_bf16_f32 v114, v114, v178
    v_cvt_pk_bf16_f32 v115, v115, v179
    ds_read_u16_d16_hi v131, v131 offset:40960
    ds_read_u16_d16_hi v130, v130 offset:40960
    s_waitcnt lgkmcnt(10)
    v_mfma_f32_32x32x16_bf16 v[80:95], v[104:107], v[168:171], v[80:95]
    v_cvt_pkrtz_f16_f32 v132, v132, v133
    v_mul_f32 v180, v116, v180
    v_and_b32_sdwa v133, s67, v132 dst_sel:DWORD dst_unused:UNUSED_PAD src0_sel:DWORD src1_sel:WORD_1
    v_mul_f32 v181, v117, v181
    v_and_b32 v132, s67, v132
    v_cvt_pk_bf16_f32 v116, v116, v180
    v_cvt_pk_bf16_f32 v117, v117, v181
    ds_read_u16_d16_hi v133, v133 offset:40960
    ds_read_u16_d16_hi v132, v132 offset:40960
    v_mfma_f32_32x32x16_bf16 v[80:95], v[108:111], v[172:175], v[80:95]
    v_cvt_pkrtz_f16_f32 v134, v134, v135
    v_mul_f32 v182, v118, v182
    v_and_b32_sdwa v135, s67, v134 dst_sel:DWORD dst_unused:UNUSED_PAD src0_sel:DWORD src1_sel:WORD_1
    v_mul_f32 v183, v119, v183
    v_and_b32 v134, s67, v134
    v_cvt_pk_bf16_f32 v118, v118, v182
    v_cvt_pk_bf16_f32 v119, v119, v183
    ds_read_u16_d16_hi v135, v135 offset:40960
    ds_read_u16_d16_hi v134, v134 offset:40960
    s_waitcnt lgkmcnt(10)
    v_mfma_f32_32x32x16_bf16 v[96:111], v[32:35], v[28:31], 0
    v_cvt_pkrtz_f16_f32 v136, v136, v137
    v_mul_f32 v184, v120, v184
    v_and_b32_sdwa v137, s67, v136 dst_sel:DWORD dst_unused:UNUSED_PAD src0_sel:DWORD src1_sel:WORD_1
    v_mul_f32 v185, v121, v185
    v_and_b32 v136, s67, v136
    v_cvt_pk_bf16_f32 v120, v120, v184
    v_cvt_pk_bf16_f32 v121, v121, v185
    ds_read_u16_d16_hi v137, v137 offset:40960
    ds_read_u16_d16_hi v136, v136 offset:40960
    v_cvt_pkrtz_f16_f32 v138, v138, v139
    v_mul_f32 v186, v122, v186
    v_and_b32_sdwa v139, s67, v138 dst_sel:DWORD dst_unused:UNUSED_PAD src0_sel:DWORD src1_sel:WORD_1
    v_mul_f32 v187, v123, v187
    v_and_b32 v138, s67, v138
    v_cvt_pk_bf16_f32 v122, v122, v186
    v_cvt_pk_bf16_f32 v123, v123, v187
    ds_read_u16_d16_hi v139, v139 offset:40960
    ds_read_u16_d16_hi v138, v138 offset:40960
    s_waitcnt lgkmcnt(10)
    v_cvt_pkrtz_f16_f32 v140, v140, v141
    v_mul_f32 v188, v124, v188
    v_and_b32_sdwa v141, s67, v140 dst_sel:DWORD dst_unused:UNUSED_PAD src0_sel:DWORD src1_sel:WORD_1
    v_mul_f32 v189, v125, v189
    v_and_b32 v140, s67, v140
    v_cvt_pk_bf16_f32 v124, v124, v188
    v_cvt_pk_bf16_f32 v125, v125, v189
    ds_read_u16_d16_hi v141, v141 offset:40960
    ds_read_u16_d16_hi v140, v140 offset:40960
    v_cvt_pkrtz_f16_f32 v142, v142, v143
    v_mul_f32 v190, v126, v190
    v_and_b32_sdwa v143, s67, v142 dst_sel:DWORD dst_unused:UNUSED_PAD src0_sel:DWORD src1_sel:WORD_1
    v_mul_f32 v191, v127, v191
    v_and_b32 v142, s67, v142
    v_cvt_pk_bf16_f32 v126, v126, v190
    v_cvt_pk_bf16_f32 v127, v127, v191
    ds_read_u16_d16_hi v143, v143 offset:40960
    ds_read_u16_d16_hi v142, v142 offset:40960
    s_waitcnt lgkmcnt(12)
    v_mfma_f32_32x32x16_bf16 v[64:79], v[96:99], v[112:115], v[64:79]
    v_mul_f32 v192, v128, v192
    v_mul_f32 v193, v129, v193
    v_cvt_pk_bf16_f32 v128, v128, v192
    v_cvt_pk_bf16_f32 v129, v129, v193
    v_mfma_f32_32x32x16_bf16 v[64:79], v[100:103], v[116:119], v[64:79]
    v_mul_f32 v194, v130, v194
    v_mul_f32 v195, v131, v195
    v_cvt_pk_bf16_f32 v130, v130, v194
    v_cvt_pk_bf16_f32 v131, v131, v195
    s_waitcnt lgkmcnt(8)
    v_mfma_f32_32x32x16_bf16 v[64:79], v[104:107], v[120:123], v[64:79]
    v_mul_f32 v196, v132, v196
    v_mul_f32 v197, v133, v197
    v_cvt_pk_bf16_f32 v132, v132, v196
    v_cvt_pk_bf16_f32 v133, v133, v197
    v_mfma_f32_32x32x16_bf16 v[64:79], v[108:111], v[124:127], v[64:79]
    v_mul_f32 v198, v134, v198
    v_mul_f32 v199, v135, v199
    v_cvt_pk_bf16_f32 v134, v134, v198
    v_cvt_pk_bf16_f32 v135, v135, v199
    s_waitcnt lgkmcnt(4)
    v_mul_f32 v200, v136, v200
    v_mul_f32 v201, v137, v201
    v_cvt_pk_bf16_f32 v136, v136, v200
    v_cvt_pk_bf16_f32 v137, v137, v201
    v_mul_f32 v202, v138, v202
    v_mul_f32 v203, v139, v203
    v_cvt_pk_bf16_f32 v138, v138, v202
    v_cvt_pk_bf16_f32 v139, v139, v203
    s_waitcnt lgkmcnt(0)
    v_mul_f32 v204, v140, v204
    v_mul_f32 v205, v141, v205
    v_cvt_pk_bf16_f32 v140, v140, v204
    v_cvt_pk_bf16_f32 v141, v141, v205
    v_mul_f32 v206, v142, v206
    v_mul_f32 v207, v143, v207
    v_cvt_pk_bf16_f32 v142, v142, v206
    v_cvt_pk_bf16_f32 v143, v143, v207
    s_nop 1
    v_mfma_f32_32x32x16_bf16 v[80:95], v[96:99], v[128:131], v[80:95]
    v_mfma_f32_32x32x16_bf16 v[80:95], v[100:103], v[132:135], v[80:95]
    v_mfma_f32_32x32x16_bf16 v[80:95], v[104:107], v[136:139], v[80:95]
    v_mfma_f32_32x32x16_bf16 v[80:95], v[108:111], v[140:143], v[80:95]
    s_branch K2_DONE
K2_GIVEUP:
    v_mov_b32 v166, 260
    v_mov_b32 v167, 1
    s_mov_b64 exec, 1
    ds_add_u32 v166, v167
    s_mov_b64 exec, -1
    v_mov_b32 v166, 268
K2_SPINE:
    ds_read_b32 v167, v166
    s_waitcnt lgkmcnt(0)
    v_cmp_gt_u32 vcc, 4, v167
    s_cbranch_vccnz K2_SPINE
    s_branch K2_SLOW
K2_LOADER:
    v_lshrrev_b32 v164, 4, v160
    s_lshl_b32 s52, s49, 2
    v_add_u32 v2, s52, v164
    v_and_b32 v165, 15, v0
    v_xor_b32 v2, v2, v165
    v_lshlrev_b32 v2, 4, v2
    v_lshl_add_u32 v2, v164, 8, v2
    s_lshl_b32 s52, s49, 10
    s_add_u32 m0, s52, 151552
    s_add_u32 s53, s52, 0
    buffer_load_dwordx4 v2, s[28:31], s53 offen lds
    s_add_u32 m0, s52, 155648
    s_add_u32 s53, s52, 4096
    buffer_load_dwordx4 v2, s[28:31], s53 offen lds
    s_add_u32 m0, s52, 159744
    s_add_u32 s53, s52, 8192
    buffer_load_dwordx4 v2, s[28:31], s53 offen lds
    s_lshl_b32 s82, s49, 13
    s_lshr_b32 s59, s2, 3
    s_add_u32 s16, s59, 0
    s_and_b32 s16, s16, 3
    s_lshl_b32 s16, s16, 10
    s_add_u32 s53, s82, s16
    buffer_load_dwordx4 v[64:67], v3, s[32:35], s53 offen
    s_add_u32 s53, s53, 4096
    buffer_load_dwordx4 v[80:83], v3, s[32:35], s53 offen
    s_add_u32 s53, s53, 28672
    buffer_load_dwordx4 v[176:179], v3, s[32:35], s53 offen
    s_add_u32 s53, s53, 4096
    buffer_load_dwordx4 v[192:195], v3, s[32:35], s53 offen
    s_add_u32 s17, s59, 1
    s_and_b32 s17, s17, 3
    s_lshl_b32 s17, s17, 10
    s_add_u32 s53, s82, s17
    buffer_load_dwordx4 v[68:71], v3, s[32:35], s53 offen
    s_add_u32 s53, s53, 4096
    buffer_load_dwordx4 v[84:87], v3, s[32:35], s53 offen
    s_add_u32 s53, s53, 28672
    buffer_load_dwordx4 v[180:183], v3, s[32:35], s53 offen
    s_add_u32 s53, s53, 4096
    buffer_load_dwordx4 v[196:199], v3, s[32:35], s53 offen
    s_add_u32 s18, s59, 2
    s_and_b32 s18, s18, 3
    s_lshl_b32 s18, s18, 10
    s_add_u32 s53, s82, s18
    buffer_load_dwordx4 v[72:75], v3, s[32:35], s53 offen
    s_add_u32 s53, s53, 4096
    buffer_load_dwordx4 v[88:91], v3, s[32:35], s53 offen
    s_add_u32 s53, s53, 28672
    buffer_load_dwordx4 v[184:187], v3, s[32:35], s53 offen
    s_add_u32 s53, s53, 4096
    buffer_load_dwordx4 v[200:203], v3, s[32:35], s53 offen
    s_add_u32 s19, s59, 3
    s_and_b32 s19, s19, 3
    s_lshl_b32 s19, s19, 10
    s_add_u32 s53, s82, s19
    buffer_load_dwordx4 v[76:79], v3, s[32:35], s53 offen
    s_add_u32 s53, s53, 4096
    buffer_load_dwordx4 v[92:95], v3, s[32:35], s53 offen
    s_add_u32 s53, s53, 28672
    buffer_load_dwordx4 v[188:191], v3, s[32:35], s53 offen
    s_add_u32 s53, s53, 4096
    buffer_load_dwordx4 v[204:207], v3, s[32:35], s53 offen
    s_lshl_b32 s51, s49, 12
    s_add_u32 m0, s51, 48128
    s_add_u32 s53, s51, 138240
    buffer_load_dwordx4 v3, s[32:35], s53 offen offset:0 lds
    buffer_load_dwordx4 v3, s[32:35], s53 offen offset:1024 lds
    buffer_load_dwordx4 v3, s[32:35], s53 offen offset:2048 lds
    buffer_load_dwordx4 v3, s[32:35], s53 offen offset:3072 lds
    s_mul_i32 s51, s49, 3072
    s_add_u32 m0, s51, 80896
    s_add_u32 s53, s51, 171008
    buffer_load_dwordx4 v3, s[32:35], s53 offen offset:0 lds
    buffer_load_dwordx4 v3, s[32:35], s53 offen offset:1024 lds
    buffer_load_dwordx4 v3, s[32:35], s53 offen offset:2048 lds
    s_and_b32 s51, s49, 1
    s_lshl_b32 s51, s51, 15
    s_add_u32 m0, s51, 72704
    s_add_u32 s53, s51, 162816
    buffer_load_dwordx4 v3, s[32:35], s53 offen lds
    s_lshl_b32 s52, s50, 11
    s_add_u32 s52, s52, 65536
    buffer_load_dwordx4 v[8:11], v3, s[32:35], s52 offen
    buffer_load_dwordx4 v[12:15], v3, s[32:35], s52 offen offset:1024
    s_waitcnt vmcnt(26)
    v_mov_b32 v166, 264
    v_mov_b32 v167, 1
    s_mov_b64 exec, 1
    ds_add_u32 v166, v167
    s_mov_b64 exec, -1
    v_mov_b32 v168, v160
    v_and_b32 v160, 15, v0
    v_bfe_u32 v161, v0, 4, 2
    v_xor_b32 v162, v160, v161
    v_lshlrev_b32 v162, 4, v162
    v_lshl_add_u32 v162, v160, 8, v162
    v_add_u32 v162, 151552, v162
    v_mul_u32_u24 v160, 272, v160
    v_mov_b32 v166, 264
K2_SPINC:
    ds_read_b32 v167, v166
    s_waitcnt lgkmcnt(0)
    v_cmp_gt_u32 vcc, 4, v167
    s_cbranch_vccnz K2_SPINC
    s_lshr_b32 s51, s16, 4
    v_xor_b32 v163, s51, v162
    ds_read_b128 v[112:115], v163 offset:0
    ds_read_b128 v[128:131], v163 offset:4096
    ds_read_b128 v[144:147], v163 offset:8192
    s_lshr_b32 s51, s17, 4
    v_xor_b32 v163, s51, v162
    ds_read_b128 v[116:119], v163 offset:0
    ds_read_b128 v[132:135], v163 offset:4096
    ds_read_b128 v[148:151], v163 offset:8192
    s_lshr_b32 s51, s18, 4
    v_xor_b32 v163, s51, v162
    ds_read_b128 v[120:123], v163 offset:0
    ds_read_b128 v[136:139], v163 offset:4096
    ds_read_b128 v[152:155], v163 offset:8192
    s_lshr_b32 s51, s19, 4
    v_xor_b32 v163, s51, v162
    ds_read_b128 v[124:127], v163 offset:0
    ds_read_b128 v[140:143], v163 offset:4096
    ds_read_b128 v[156:159], v163 offset:8192
    s_lshr_b32 s51, s49, 1
    s_lshl_b32 s51, s51, 7
    s_and_b32 s52, s49, 1
    s_lshl_b32 s52, s52, 5
    s_add_u32 s51, s51, s52
    v_lshl_add_u32 v164, v161, 3, v160
    v_add_u32 v164, s51, v164
    s_lshl_b32 s51, s49, 6
    v_lshl_add_u32 v165, v161, 3, v160
    v_add_u32 v165, s51, v165
    s_waitcnt vmcnt(22) lgkmcnt(9)
    v_mfma_f32_16x16x32_bf16 v[208:211], v[64:67], v[112:115], 0
    s_lshl_b32 s51, s50, 8
    s_add_u32 s51, s51, 16777088
    s_add_u32 s36, s14, s51
    v_mfma_f32_16x16x32_bf16 v[212:215], v[80:83], v[112:115], 0
    s_addc_u32 s37, s15, 0
    s_or_b32 s37, s37, 0x40000
    s_mov_b32 s38, 64
    v_mfma_f32_16x16x32_bf16 v[216:219], v[64:67], v[128:131], 0
    s_mov_b32 s39, 0x800000
    s_mov_b32 s40, s6
    s_mov_b32 s41, s7
    v_mfma_f32_16x16x32_bf16 v[220:223], v[80:83], v[128:131], 0
    s_mov_b32 s42, 10240000
    s_mov_b32 s43, 0x20000
    s_mov_b32 s60, 0xffffffe0
    v_mfma_f32_16x16x32_bf16 v[224:227], v[64:67], v[144:147], 0
    s_mov_b32 s61, 128
    s_mov_b32 s62, 0xc7b8aa3b
    s_mov_b32 s63, 0xfc
    v_mfma_f32_16x16x32_bf16 v[228:231], v[80:83], v[144:147], 0
    s_mov_b32 s67, 0xfffe
    s_mov_b32 s64, 512
    s_mov_b32 s55, 0
    v_mfma_f32_16x16x32_bf16 v[232:235], v[176:179], v[112:115], 0
    s_mov_b32 s56, 0
    s_mov_b32 s58, 0
    s_mov_b32 s80, 0
    v_mfma_f32_16x16x32_bf16 v[236:239], v[192:195], v[112:115], 0
    s_mul_i32 s51, s50, 3
    s_xor_b32 s83, s49, s51
    v_lshrrev_b32 v243, 5, v168
    v_mfma_f32_16x16x32_bf16 v[96:99], v[176:179], v[128:131], 0
    v_and_b32 v244, 31, v0
    v_lshlrev_b32 v1, 4, v243
    v_lshlrev_b32 v253, 8, v243
    v_mfma_f32_16x16x32_bf16 v[100:103], v[192:195], v[128:131], 0
    v_and_b32 v245, 3, v0
    v_mov_b32 v247, 0x3f80
    v_cmp_eq_u32 vcc, 0, v245
    v_mfma_f32_16x16x32_bf16 v[104:107], v[176:179], v[144:147], 0
    s_nop 1
    v_cndmask_b32 v24, 0, v247, vcc
    v_cmp_eq_u32 vcc, 1, v245
    v_mfma_f32_16x16x32_bf16 v[48:51], v[192:195], v[144:147], 0
    s_nop 1
    v_cndmask_b32 v25, 0, v247, vcc
    v_cmp_eq_u32 vcc, 2, v245
    s_waitcnt vmcnt(18) lgkmcnt(6)
    v_mfma_f32_16x16x32_bf16 v[208:211], v[68:71], v[116:119], v[208:211]
    s_nop 1
    v_cndmask_b32 v26, 0, v247, vcc
    v_cmp_eq_u32 vcc, 3, v245
    v_mfma_f32_16x16x32_bf16 v[212:215], v[84:87], v[116:119], v[212:215]
    s_nop 1
    v_cndmask_b32 v27, 0, v247, vcc
    v_cmp_gt_u32 s[78:79], 16, v244
    v_mfma_f32_16x16x32_bf16 v[216:219], v[68:71], v[132:135], v[216:219]
    v_mov_b32 v246, 0x3fe
    v_mov_b32 v248, 0x4780
    v_cndmask_b32 v246, v248, v246, s[78:79]
    v_mfma_f32_16x16x32_bf16 v[220:223], v[84:87], v[132:135], v[220:223]
    v_and_b32 v245, 15, v0
    v_lshlrev_b32 v249, 3, v243
    v_sub_u32 v245, v245, v249
    v_mfma_f32_16x16x32_bf16 v[224:227], v[68:71], v[148:151], v[224:227]
    v_lshlrev_b32 v247, 16, v246
    v_cmp_eq_u32 vcc, 0, v245
    v_cmp_eq_u32 s[78:79], 1, v245
    v_mfma_f32_16x16x32_bf16 v[228:231], v[84:87], v[148:151], v[228:231]
    s_nop 0
    v_cndmask_b32 v28, 0, v246, vcc
    v_cndmask_b32 v249, 0, v247, s[78:79]
    v_mfma_f32_16x16x32_bf16 v[232:235], v[180:183], v[116:119], v[232:235]
    v_or_b32 v28, v28, v249
    v_cmp_eq_u32 vcc, 2, v245
    v_cmp_eq_u32 s[78:79], 3, v245
    v_mfma_f32_16x16x32_bf16 v[236:239], v[196:199], v[116:119], v[236:239]
    s_nop 0
    v_cndmask_b32 v29, 0, v246, vcc
    v_cndmask_b32 v249, 0, v247, s[78:79]
    v_mfma_f32_16x16x32_bf16 v[96:99], v[180:183], v[132:135], v[96:99]
    v_or_b32 v29, v29, v249
    v_cmp_eq_u32 vcc, 4, v245
    v_cmp_eq_u32 s[78:79], 5, v245
    v_mfma_f32_16x16x32_bf16 v[100:103], v[196:199], v[132:135], v[100:103]
    s_nop 0
    v_cndmask_b32 v30, 0, v246, vcc
    v_cndmask_b32 v249, 0, v247, s[78:79]
    v_mfma_f32_16x16x32_bf16 v[104:107], v[180:183], v[148:151], v[104:107]
    v_or_b32 v30, v30, v249
    v_cmp_eq_u32 vcc, 6, v245
    v_cmp_eq_u32 s[78:79], 7, v245
    v_mfma_f32_16x16x32_bf16 v[48:51], v[196:199], v[148:151], v[48:51]
    s_nop 0
    v_cndmask_b32 v31, 0, v246, vcc
    v_cndmask_b32 v249, 0, v247, s[78:79]
    s_waitcnt vmcnt(14) lgkmcnt(3)
    v_mfma_f32_16x16x32_bf16 v[208:211], v[72:75], v[120:123], v[208:211]
    v_or_b32 v31, v31, v249
    v_mfma_f32_16x16x32_bf16 v[212:215], v[88:91], v[120:123], v[212:215]
    v_mfma_f32_16x16x32_bf16 v[216:219], v[72:75], v[136:139], v[216:219]
    v_mfma_f32_16x16x32_bf16 v[220:223], v[88:91], v[136:139], v[220:223]
    v_mfma_f32_16x16x32_bf16 v[224:227], v[72:75], v[152:155], v[224:227]
    v_mfma_f32_16x16x32_bf16 v[228:231], v[88:91], v[152:155], v[228:231]
    v_mfma_f32_16x16x32_bf16 v[232:235], v[184:187], v[120:123], v[232:235]
    v_mfma_f32_16x16x32_bf16 v[236:239], v[200:203], v[120:123], v[236:239]
    v_mfma_f32_16x16x32_bf16 v[96:99], v[184:187], v[136:139], v[96:99]
    v_mfma_f32_16x16x32_bf16 v[100:103], v[200:203], v[136:139], v[100:103]
    v_mfma_f32_16x16x32_bf16 v[104:107], v[184:187], v[152:155], v[104:107]
    v_mfma_f32_16x16x32_bf16 v[48:51], v[200:203], v[152:155], v[48:51]
    s_waitcnt vmcnt(10) lgkmcnt(0)
    v_mfma_f32_16x16x32_bf16 v[208:211], v[76:79], v[124:127], v[208:211]
    v_mfma_f32_16x16x32_bf16 v[212:215], v[92:95], v[124:127], v[212:215]
    v_mfma_f32_16x16x32_bf16 v[216:219], v[76:79], v[140:143], v[216:219]
    v_mfma_f32_16x16x32_bf16 v[220:223], v[92:95], v[140:143], v[220:223]
    v_mfma_f32_16x16x32_bf16 v[224:227], v[76:79], v[156:159], v[224:227]
    v_mfma_f32_16x16x32_bf16 v[228:231], v[92:95], v[156:159], v[228:231]
    v_mfma_f32_16x16x32_bf16 v[232:235], v[188:191], v[124:127], v[232:235]
    v_mfma_f32_16x16x32_bf16 v[236:239], v[204:207], v[124:127], v[236:239]
    v_mfma_f32_16x16x32_bf16 v[96:99], v[188:191], v[140:143], v[96:99]
    v_mul_f32 v208, s62, v208
    v_mul_f32 v212, s62, v212
    v_mul_f32 v209, s62, v209
    v_mfma_f32_16x16x32_bf16 v[100:103], v[204:207], v[140:143], v[100:103]
    v_mul_f32 v213, s62, v213
    v_mul_f32 v210, s62, v210
    v_mul_f32 v214, s62, v214
    v_mfma_f32_16x16x32_bf16 v[104:107], v[188:191], v[156:159], v[104:107]
    v_mul_f32 v211, s62, v211
    v_mul_f32 v215, s62, v215
    v_cvt_pk_bf16_f32 v40, v208, v210
    v_mfma_f32_16x16x32_bf16 v[48:51], v[204:207], v[156:159], v[48:51]
    v_cvt_pk_bf16_f32 v41, v212, v214
    v_cvt_pk_bf16_f32 v42, v209, v211
    v_cvt_pk_bf16_f32 v43, v213, v215
    ds_write_b64 v164, v[40:41] offset:14848
    ds_write_b64 v164, v[42:43] offset:14912
    v_mul_f32 v216, s62, v216
    v_mul_f32 v220, s62, v220
    v_mul_f32 v217, s62, v217
    v_mul_f32 v221, s62, v221
    v_mul_f32 v218, s62, v218
    v_mul_f32 v222, s62, v222
    v_mul_f32 v219, s62, v219
    v_mul_f32 v223, s62, v223
    v_cvt_pk_bf16_f32 v44, v216, v218
    v_cvt_pk_bf16_f32 v45, v220, v222
    v_cvt_pk_bf16_f32 v46, v217, v219
    v_cvt_pk_bf16_f32 v47, v221, v223
    ds_write_b64 v164, v[44:45] offset:19200
    ds_write_b64 v164, v[46:47] offset:19264
    v_mul_f32 v224, s62, v224
    v_mul_f32 v228, s62, v228
    v_mul_f32 v225, s62, v225
    v_mul_f32 v229, s62, v229
    v_mul_f32 v226, s62, v226
    v_mul_f32 v230, s62, v230
    v_mul_f32 v227, s62, v227
    v_mul_f32 v231, s62, v231
    v_cvt_pk_bf16_f32 v40, v224, v226
    v_cvt_pk_bf16_f32 v41, v228, v230
    v_cvt_pk_bf16_f32 v42, v225, v227
    v_cvt_pk_bf16_f32 v43, v229, v231
    ds_write_b64 v164, v[40:41] offset:23552
    ds_write_b64 v164, v[42:43] offset:23616
    v_cvt_pk_bf16_f32 v112, v232, v233
    v_cvt_pk_bf16_f32 v113, v234, v235
    v_cvt_pk_bf16_f32 v114, v236, v237
    v_cvt_pk_bf16_f32 v115, v238, v239
    ds_write_b64 v165, v[112:113] offset:27904
    ds_write_b64 v165, v[114:115] offset:27936
    v_cvt_pk_bf16_f32 v116, v96, v97
    v_cvt_pk_bf16_f32 v117, v98, v99
    v_cvt_pk_bf16_f32 v118, v100, v101
    v_cvt_pk_bf16_f32 v119, v102, v103
    ds_write_b64 v165, v[116:117] offset:32256
    ds_write_b64 v165, v[118:119] offset:32288
    v_cvt_pk_bf16_f32 v120, v104, v105
    v_cvt_pk_bf16_f32 v121, v106, v107
    v_cvt_pk_bf16_f32 v122, v48, v49
    v_cvt_pk_bf16_f32 v123, v50, v51
    ds_write_b64 v165, v[120:121] offset:36608
    ds_write_b64 v165, v[122:123] offset:36640
    s_waitcnt vmcnt(0)
    v_mov_b32 v166, 268
    v_mov_b32 v167, 1
    s_mov_b64 exec, 1
    ds_add_u32 v166, v167
    s_mov_b64 exec, -1
K2_NOBULK:
    v_mov_b32 v48, 128
    v_mov_b32 v49, 128
    v_mov_b32 v50, 128
    v_mov_b32 v51, 128
    v_mov_b32 v52, 128
    v_mov_b32 v53, 128
    v_mov_b32 v54, 128
    v_mov_b32 v55, 128
    v_mov_b32 v56, 128
    v_mov_b32 v57, 128
    v_mov_b32 v58, 128
    v_mov_b32 v59, 128
    v_mov_b32 v60, 128
    v_mov_b32 v61, 128
    v_mov_b32 v62, 128
    v_mov_b32 v63, 128
    v_mov_b32 v166, 260
K2_SPINF:
    ds_read_b32 v167, v166
    s_waitcnt lgkmcnt(0)
    v_cmp_gt_u32 vcc, 4, v167
    s_cbranch_vccnz K2_SPINF
    v_mov_b32 v162, 828
    ds_read2_b32 v[164:165], v162 offset0:0 offset1:16
    ds_read2_b32 v[166:167], v162 offset0:32 offset1:48
    s_waitcnt lgkmcnt(0)
    v_readfirstlane_b32 s16, v164
    v_readfirstlane_b32 s17, v165
    v_readfirstlane_b32 s18, v166
    v_readfirstlane_b32 s19, v167
    s_max_u32 s51, s16, s17
    s_max_u32 s52, s18, s19
    s_max_u32 s51, s51, s52
    s_cmp_gt_u32 s51, 1664
    s_cbranch_scc1 K2_SLOW
    s_setprio 1
    s_add_u32 s80, s16, s17
    s_add_u32 s52, s18, s19
    s_add_u32 s80, s80, s52
    s_or_b32 s17, s17, 1
    s_or_b32 s18, s18, 2
    s_or_b32 s19, s19, 3
    s_max_u32 s20, s16, s17
    s_min_u32 s17, s16, s17
    s_max_u32 s16, s18, s19
    s_min_u32 s19, s18, s19
    s_max_u32 s18, s20, s16
    s_min_u32 s16, s20, s16
    s_max_u32 s20, s17, s19
    s_min_u32 s19, s17, s19
    s_max_u32 s17, s20, s16
    s_min_u32 s16, s20, s16
    s_bitcmp1_b32 s83, 0
    s_cselect_b32 s18, s17, s18
    s_cselect_b32 s16, s19, s16
    s_bitcmp1_b32 s83, 1
    s_cselect_b32 s51, s16, s18
    s_and_b32 s49, s51, 3
    s_andn2_b32 s51, s51, 3
    s_mul_i32 s58, s49, 1664
    s_add_u32 s54, s51, 127
    s_lshr_b32 s54, s54, 7
    s_add_u32 s20, s51, 124
    s_bfe_u32 s20, s20, 0x20005
    s_lshl_b32 s20, s20, 1
    s_add_u32 s20, s20, 2
    v_and_b32 v160, 31, v0
    v_xor_b32 v2, 16, v1
    v_xor_b32 v3, 4, v160
    v_lshlrev_b32 v3, 2, v3
    v_add_u32 v2, s58, v2
    v_add_u32 v3, s58, v3
    s_mul_i32 s51, s49, 2560
    s_lshl_b32 s52, s50, 7
    s_add_u32 s51, s51, s52
    v_and_b32 v6, 17, v0
    v_lshlrev_b32 v6, 2, v6
    v_bfe_u32 v161, v0, 1, 1
    v_lshl_add_u32 v6, v161, 5, v6
    v_bfe_u32 v161, v0, 2, 2
    v_lshl_add_u32 v6, v161, 3, v6
    v_lshl_add_u32 v6, v253, 2, v6
    v_add_u32 v6, s51, v6
    v_bfe_u32 v7, v0, 1, 5
    v_lshlrev_b32 v7, 2, v7
    v_add_u32 v7, s58, v7
    v_lshlrev_b32 v252, 4, v0
    v_xor_b32 v252, v252, v0
    v_and_b32 v252, 16, v252
    v_lshlrev_b32 v254, 1, v0
    v_xor_b32 v254, v254, v1
    v_and_b32 v254, 16, v254
    v_add_u32 v254, 106496, v254
    s_lshl_b32 s51, s49, 2
    s_add_u32 s51, s51, 288
    v_mov_b32 v255, s51
    s_lshl_b32 s22, s58, 3
    s_add_u32 s22, s22, 106496
    s_mov_b32 s21, 0
    s_mov_b32 s23, 0
    s_mov_b32 s57, s54
K2_REFILLC:
    s_cmp_eq_u32 s54, 0
    s_cbranch_scc1 K2_FILLEDC
    ds_read_b128 v[48:51], v2 offset:1536
    ds_read_b128 v[52:55], v2 offset:1568
    ds_read_b128 v[56:59], v2 offset:1600
    ds_read_b128 v[60:63], v2 offset:1632
    ds_read_b32 v5, v3 offset:8192
    ds_read_b32 v97, v3 offset:8320
    s_waitcnt lgkmcnt(0)
    buffer_load_dword v176, v48, s[36:39], 0 offen
    buffer_load_dword v177, v49, s[36:39], 0 offen
    buffer_load_dword v178, v50, s[36:39], 0 offen
    buffer_load_dword v179, v51, s[36:39], 0 offen
    buffer_load_dword v180, v52, s[36:39], 0 offen
    buffer_load_dword v181, v53, s[36:39], 0 offen
    buffer_load_dword v182, v54, s[36:39], 0 offen
    buffer_load_dword v183, v55, s[36:39], 0 offen
    buffer_load_dword v184, v56, s[36:39], 0 offen
    buffer_load_dword v185, v57, s[36:39], 0 offen
    buffer_load_dword v186, v58, s[36:39], 0 offen
    buffer_load_dword v187, v59, s[36:39], 0 offen
    buffer_load_dword v188, v60, s[36:39], 0 offen
    buffer_load_dword v189, v61, s[36:39], 0 offen
    buffer_load_dword v190, v62, s[36:39], 0 offen
    buffer_load_dword v191, v63, s[36:39], 0 offen
    v_and_b32 v5, 30, v5
    v_lshl_add_u32 v5, v5, 3, v253
    ds_read_b128 v[32:35], v5 offset:1024
    v_mov_b32 v5, v97
    v_and_b32 v5, 30, v5
    v_lshl_add_u32 v5, v5, 3, v253
    ds_read_b128 v[36:39], v5 offset:1024
    buffer_load_dword v192, v48, s[36:39], 0 offen offset:128
    buffer_load_dword v193, v49, s[36:39], 0 offen offset:128
    buffer_load_dword v194, v50, s[36:39], 0 offen offset:128
    buffer_load_dword v195, v51, s[36:39], 0 offen offset:128
    buffer_load_dword v196, v52, s[36:39], 0 offen offset:128
    buffer_load_dword v197, v53, s[36:39], 0 offen offset:128
    buffer_load_dword v198, v54, s[36:39], 0 offen offset:128
    buffer_load_dword v199, v55, s[36:39], 0 offen offset:128
    buffer_load_dword v200, v56, s[36:39], 0 offen offset:128
    buffer_load_dword v201, v57, s[36:39], 0 offen offset:128
    buffer_load_dword v202, v58, s[36:39], 0 offen offset:128
    buffer_load_dword v203, v59, s[36:39], 0 offen offset:128
    buffer_load_dword v204, v60, s[36:39], 0 offen offset:128
    buffer_load_dword v205, v61, s[36:39], 0 offen offset:128
    buffer_load_dword v206, v62, s[36:39], 0 offen offset:128
    buffer_load_dword v207, v63, s[36:39], 0 offen offset:128
    ds_read_b128 v[48:51], v2 offset:1664
    ds_read_b128 v[52:55], v2 offset:1696
    ds_read_b128 v[56:59], v2 offset:1728
    ds_read_b128 v[60:63], v2 offset:1760
K2_FILLEDC:
    s_cmp_lg_u32 s55, 0
    s_cbranch_scc1 K2_GOC
    v_mov_b32 v64, 0
    v_mov_b32 v65, 0
    v_mov_b32 v66, 0
    v_mov_b32 v67, 0
    v_mov_b32 v68, 0
    v_mov_b32 v69, 0
    v_mov_b32 v70, 0
    v_mov_b32 v71, 0
    v_mov_b32 v72, 0
    v_mov_b32 v73, 0
    v_mov_b32 v74, 0
    v_mov_b32 v75, 0
    v_mov_b32 v76, 0
    v_mov_b32 v77, 0
    v_mov_b32 v78, 0
    v_mov_b32 v79, 0
    v_mov_b32 v80, 0
    v_mov_b32 v81, 0
    v_mov_b32 v82, 0
    v_mov_b32 v83, 0
    v_mov_b32 v84, 0
    v_mov_b32 v85, 0
    v_mov_b32 v86, 0
    v_mov_b32 v87, 0
    v_mov_b32 v88, 0
    v_mov_b32 v89, 0
    v_mov_b32 v90, 0
    v_mov_b32 v91, 0
    v_mov_b32 v92, 0
    v_mov_b32 v93, 0
    v_mov_b32 v94, 0
    v_mov_b32 v95, 0
    v_bfe_u32 v160, v0, 2, 2
    v_lshrrev_b32 v161, 1, v1
    v_add_u32 v160, v160, v161
    v_mul_u32_u24 v160, 272, v160
    v_bfe_u32 v162, v0, 4, 1
    v_lshl_add_u32 v160, v162, 5, v160
    v_and_b32 v162, 3, v0
    v_lshl_add_u32 v160, v162, 3, v160
    s_mul_i32 s51, s49, 2720
    s_lshl_b32 s52, s50, 7
    s_add_u32 s51, s51, s52
    v_add_u32 v160, s51, v160
    v_mul_u32_u24 v161, 136, v161
    v_and_b32 v162, 127, v6
    v_add3_u32 v161, v162, s51, v161
    v_mov_b32 v166, 268
K2_SPING:
    ds_read_b32 v167, v166
    s_waitcnt lgkmcnt(0)
    v_cmp_gt_u32 vcc, 4, v167
    s_cbranch_vccnz K2_SPING
    ds_read_b64_tr_b16 v[16:17], v160 offset:14848
    ds_read_b64_tr_b16 v[18:19], v160 offset:15936
    ds_read_b64_tr_b16 v[20:21], v160 offset:14912
    ds_read_b64_tr_b16 v[22:23], v160 offset:16000
    ds_read_b32 v246, v161 offset:27904
    ds_read_b32 v247, v161 offset:28176
    ds_read_b32 v248, v161 offset:28448
    ds_read_b32 v249, v161 offset:28720
    ds_read_b32 v250, v161 offset:30080
    ds_read_b32 v251, v161 offset:30352
    s_branch K2_GOC
K2_EMPTY:
    buffer_load_dword v240, v6, s[28:31], 0 offen offset:0
    buffer_load_dword v241, v6, s[28:31], 0 offen offset:256
    buffer_load_dword v242, v6, s[28:31], 0 offen offset:512
    buffer_load_dword v243, v6, s[28:31], 0 offen offset:768
    buffer_load_dword v244, v6, s[28:31], 0 offen offset:2048
    buffer_load_dword v245, v6, s[28:31], 0 offen offset:2304
    s_branch K2_DONE
K2_SP2:
    ds_read_b32 v4, v255
    s_waitcnt lgkmcnt(0)
    v_cmp_gt_u32 vcc, s23, v4
    s_cbranch_vccnz K2_SP2
    s_branch K2_OK2
K2_SP3:
    ds_read_b32 v4, v255
    s_waitcnt lgkmcnt(0)
    v_cmp_gt_u32 vcc, s23, v4
    s_cbranch_vccnz K2_SP3
    s_branch K2_OK3
K2_SP4:
    ds_read_b32 v4, v255
    s_waitcnt lgkmcnt(0)
    v_cmp_gt_u32 vcc, s23, v4
    s_cbranch_vccnz K2_SP4
    s_branch K2_OK4
K2_SP5:
    ds_read_b32 v4, v255
    s_waitcnt lgkmcnt(0)
    v_cmp_gt_u32 vcc, s23, v4
    s_cbranch_vccnz K2_SP5
    s_branch K2_OK5
K2_SP6:
    ds_read_b32 v4, v255
    s_waitcnt lgkmcnt(0)
    v_cmp_gt_u32 vcc, s23, v4
    s_cbranch_vccnz K2_SP6
    s_branch K2_OK6
K2_SP7:
    ds_read_b32 v4, v255
    s_waitcnt lgkmcnt(0)
    v_cmp_gt_u32 vcc, s23, v4
    s_cbranch_vccnz K2_SP7
    s_branch K2_OK7
K2_SP8:
    ds_read_b32 v4, v255
    s_waitcnt lgkmcnt(0)
    v_cmp_gt_u32 vcc, s23, v4
    s_cbranch_vccnz K2_SP8
    s_branch K2_OK8
K2_GOC:
    s_cmp_eq_u32 s54, 0
    s_cbranch_scc1 K2_EMPTY
    s_cmp_gt_u32 s54, 2
    s_cbranch_scc1 K2_ENTFC
    s_cmp_eq_u32 s54, 2
    s_cbranch_scc1 K2_ENTPC
    ds_read_b32 v4, v255
    s_waitcnt lgkmcnt(0)
    s_add_u32 s23, s23, 1
    v_cmp_gt_u32 vcc, s23, v4
    s_cbranch_vccnz K2_SP8
K2_OK8:
    v_lshl_add_u32 v4, v3, 3, v254
    ds_read_b128 v[40:43], v4 offset:0
    s_waitcnt lgkmcnt(0)
    v_mfma_f32_32x32x16_bf16 v[112:127], v[40:43], v[8:11], 0
    v_mfma_f32_32x32x16_bf16 v[112:127], v[32:35], v[16:19], v[112:127]
    v_mfma_f32_32x32x16_bf16 v[128:143], v[40:43], v[12:15], 0
    v_mfma_f32_32x32x16_bf16 v[128:143], v[32:35], v[20:23], v[128:143]
    s_nop 7
    s_waitcnt vmcnt(16)
    v_mfma_f32_4x4x4_16b_bf16 v[112:115], v[24:25], v[176:177], v[112:115]
    v_mfma_f32_4x4x4_16b_bf16 v[116:119], v[24:25], v[180:181], v[116:119]
    v_mfma_f32_4x4x4_16b_bf16 v[120:123], v[24:25], v[184:185], v[120:123]
    v_mfma_f32_4x4x4_16b_bf16 v[124:127], v[24:25], v[188:189], v[124:127]
    v_mfma_f32_4x4x4_16b_bf16 v[112:115], v[26:27], v[178:179], v[112:115]
    v_mfma_f32_4x4x4_16b_bf16 v[116:119], v[26:27], v[182:183], v[116:119]
    v_mfma_f32_4x4x4_16b_bf16 v[120:123], v[26:27], v[186:187], v[120:123]
    v_mfma_f32_4x4x4_16b_bf16 v[124:127], v[26:27], v[190:191], v[124:127]
    s_nop 3
    v_exp_f32 v112, v112
    v_exp_f32 v113, v113
    s_nop 0
    v_add_f32 v112, 1.0, v112
    v_add_f32 v113, 1.0, v113
    v_rcp_f32 v112, v112
    v_rcp_f32 v113, v113
    v_cvt_pkrtz_f16_f32 v114, v114, v115
    v_and_b32_sdwa v115, s67, v114 dst_sel:DWORD dst_unused:UNUSED_PAD src0_sel:DWORD src1_sel:WORD_1
    v_and_b32 v114, s67, v114
    ds_read_u16_d16_hi v115, v115 offset:40960
    ds_read_u16_d16_hi v114, v114 offset:40960
    v_cvt_pkrtz_f16_f32 v116, v116, v117
    v_and_b32_sdwa v117, s67, v116 dst_sel:DWORD dst_unused:UNUSED_PAD src0_sel:DWORD src1_sel:WORD_1
    v_and_b32 v116, s67, v116
    ds_read_u16_d16_hi v117, v117 offset:40960
    ds_read_u16_d16_hi v116, v116 offset:40960
    v_cvt_pkrtz_f16_f32 v118, v118, v119
    v_and_b32_sdwa v119, s67, v118 dst_sel:DWORD dst_unused:UNUSED_PAD src0_sel:DWORD src1_sel:WORD_1
    v_and_b32 v118, s67, v118
    ds_read_u16_d16_hi v119, v119 offset:40960
    ds_read_u16_d16_hi v118, v118 offset:40960
    s_waitcnt vmcnt(0)
    v_mfma_f32_4x4x4_16b_bf16 v[128:131], v[24:25], v[192:193], v[128:131]
    v_mfma_f32_4x4x4_16b_bf16 v[132:135], v[24:25], v[196:197], v[132:135]
    v_mfma_f32_4x4x4_16b_bf16 v[136:139], v[24:25], v[200:201], v[136:139]
    v_mfma_f32_4x4x4_16b_bf16 v[140:143], v[24:25], v[204:205], v[140:143]
    v_mfma_f32_4x4x4_16b_bf16 v[128:131], v[26:27], v[194:195], v[128:131]
    v_mfma_f32_4x4x4_16b_bf16 v[132:135], v[26:27], v[198:199], v[132:135]
    v_mfma_f32_4x4x4_16b_bf16 v[136:139], v[26:27], v[202:203], v[136:139]
    v_mfma_f32_4x4x4_16b_bf16 v[140:143], v[26:27], v[206:207], v[140:143]
    s_waitcnt lgkmcnt(13)
    v_cvt_pkrtz_f16_f32 v120, v120, v121
    v_and_b32_sdwa v121, s67, v120 dst_sel:DWORD dst_unused:UNUSED_PAD src0_sel:DWORD src1_sel:WORD_1
    v_and_b32 v120, s67, v120
    ds_read_u16_d16_hi v121, v121 offset:40960
    ds_read_u16_d16_hi v120, v120 offset:40960
    s_waitcnt lgkmcnt(13)
    v_cvt_pkrtz_f16_f32 v122, v122, v123
    v_and_b32_sdwa v123, s67, v122 dst_sel:DWORD dst_unused:UNUSED_PAD src0_sel:DWORD src1_sel:WORD_1
    v_and_b32 v122, s67, v122
    ds_read_u16_d16_hi v123, v123 offset:40960
    ds_read_u16_d16_hi v122, v122 offset:40960
    s_waitcnt lgkmcnt(13)
    v_cvt_pkrtz_f16_f32 v124, v124, v125
    v_and_b32_sdwa v125, s67, v124 dst_sel:DWORD dst_unused:UNUSED_PAD src0_sel:DWORD src1_sel:WORD_1
    v_and_b32 v124, s67, v124
    ds_read_u16_d16_hi v125, v125 offset:40960
    ds_read_u16_d16_hi v124, v124 offset:40960
    s_waitcnt lgkmcnt(13)
    v_cvt_pkrtz_f16_f32 v126, v126, v127
    v_and_b32_sdwa v127, s67, v126 dst_sel:DWORD dst_unused:UNUSED_PAD src0_sel:DWORD src1_sel:WORD_1
    v_and_b32 v126, s67, v126
    ds_read_u16_d16_hi v127, v127 offset:40960
    ds_read_u16_d16_hi v126, v126 offset:40960
    s_waitcnt lgkmcnt(12)
    v_mfma_f32_32x32x16_bf16 v[96:111], v[32:35], v[28:31], 0
    v_exp_f32 v128, v128
    v_mul_f32 v176, v112, v176
    v_exp_f32 v129, v129
    v_mul_f32 v177, v113, v177
    v_add_f32 v128, 1.0, v128
    v_cvt_pk_bf16_f32 v112, v112, v176
    v_add_f32 v129, 1.0, v129
    v_cvt_pk_bf16_f32 v113, v113, v177
    v_rcp_f32 v128, v128
    v_rcp_f32 v129, v129
    v_cvt_pkrtz_f16_f32 v130, v130, v131
    v_mul_f32 v178, v114, v178
    v_and_b32_sdwa v131, s67, v130 dst_sel:DWORD dst_unused:UNUSED_PAD src0_sel:DWORD src1_sel:WORD_1
    v_mul_f32 v179, v115, v179
    v_and_b32 v130, s67, v130
    v_cvt_pk_bf16_f32 v114, v114, v178
    v_cvt_pk_bf16_f32 v115, v115, v179
    ds_read_u16_d16_hi v131, v131 offset:40960
    ds_read_u16_d16_hi v130, v130 offset:40960
    s_waitcnt lgkmcnt(10)
    v_cvt_pkrtz_f16_f32 v132, v132, v133
    v_mul_f32 v180, v116, v180
    v_and_b32_sdwa v133, s67, v132 dst_sel:DWORD dst_unused:UNUSED_PAD src0_sel:DWORD src1_sel:WORD_1
    v_mul_f32 v181, v117, v181
    v_and_b32 v132, s67, v132
    v_cvt_pk_bf16_f32 v116, v116, v180
    v_cvt_pk_bf16_f32 v117, v117, v181
    ds_read_u16_d16_hi v133, v133 offset:40960
    ds_read_u16_d16_hi v132, v132 offset:40960
    v_cvt_pkrtz_f16_f32 v134, v134, v135
    v_mul_f32 v182, v118, v182
    v_and_b32_sdwa v135, s67, v134 dst_sel:DWORD dst_unused:UNUSED_PAD src0_sel:DWORD src1_sel:WORD_1
    v_mul_f32 v183, v119, v183
    v_and_b32 v134, s67, v134
    v_cvt_pk_bf16_f32 v118, v118, v182
    v_cvt_pk_bf16_f32 v119, v119, v183
    ds_read_u16_d16_hi v135, v135 offset:40960
    ds_read_u16_d16_hi v134, v134 offset:40960
    s_waitcnt lgkmcnt(10)
    v_cvt_pkrtz_f16_f32 v136, v136, v137
    v_mul_f32 v184, v120, v184
    v_and_b32_sdwa v137, s67, v136 dst_sel:DWORD dst_unused:UNUSED_PAD src0_sel:DWORD src1_sel:WORD_1
    v_mul_f32 v185, v121, v185
    v_and_b32 v136, s67, v136
    v_cvt_pk_bf16_f32 v120, v120, v184
    v_cvt_pk_bf16_f32 v121, v121, v185
    ds_read_u16_d16_hi v137, v137 offset:40960
    ds_read_u16_d16_hi v136, v136 offset:40960
    v_cvt_pkrtz_f16_f32 v138, v138, v139
    v_mul_f32 v186, v122, v186
    v_and_b32_sdwa v139, s67, v138 dst_sel:DWORD dst_unused:UNUSED_PAD src0_sel:DWORD src1_sel:WORD_1
    v_mul_f32 v187, v123, v187
    v_and_b32 v138, s67, v138
    v_cvt_pk_bf16_f32 v122, v122, v186
    v_cvt_pk_bf16_f32 v123, v123, v187
    ds_read_u16_d16_hi v139, v139 offset:40960
    ds_read_u16_d16_hi v138, v138 offset:40960
    s_waitcnt lgkmcnt(10)
    v_cvt_pkrtz_f16_f32 v140, v140, v141
    v_mul_f32 v188, v124, v188
    v_and_b32_sdwa v141, s67, v140 dst_sel:DWORD dst_unused:UNUSED_PAD src0_sel:DWORD src1_sel:WORD_1
    v_mul_f32 v189, v125, v189
    v_and_b32 v140, s67, v140
    v_cvt_pk_bf16_f32 v124, v124, v188
    v_cvt_pk_bf16_f32 v125, v125, v189
    ds_read_u16_d16_hi v141, v141 offset:40960
    ds_read_u16_d16_hi v140, v140 offset:40960
    v_cvt_pkrtz_f16_f32 v142, v142, v143
    v_mul_f32 v190, v126, v190
    v_and_b32_sdwa v143, s67, v142 dst_sel:DWORD dst_unused:UNUSED_PAD src0_sel:DWORD src1_sel:WORD_1
    v_mul_f32 v191, v127, v191
    v_and_b32 v142, s67, v142
    v_cvt_pk_bf16_f32 v126, v126, v190
    v_cvt_pk_bf16_f32 v127, v127, v191
    ds_read_u16_d16_hi v143, v143 offset:40960
    ds_read_u16_d16_hi v142, v142 offset:40960
    s_branch K2_MIDL0C
K2_ENTPC:
    ds_read_b32 v4, v255
    s_waitcnt lgkmcnt(0)
    s_add_u32 s23, s23, 1
    v_cmp_gt_u32 vcc, s23, v4
    s_cbranch_vccnz K2_SP6
K2_OK6:
    v_lshl_add_u32 v4, v3, 3, v254
    ds_read_b128 v[40:43], v4 offset:0
    ds_read_b32 v4, v255
    s_waitcnt lgkmcnt(1)
    v_mfma_f32_32x32x16_bf16 v[112:127], v[40:43], v[8:11], 0
    v_mfma_f32_32x32x16_bf16 v[112:127], v[32:35], v[16:19], v[112:127]
    v_mfma_f32_32x32x16_bf16 v[128:143], v[40:43], v[12:15], 0
    v_mfma_f32_32x32x16_bf16 v[128:143], v[32:35], v[20:23], v[128:143]
    s_nop 7
    s_waitcnt vmcnt(16)
    v_mfma_f32_4x4x4_16b_bf16 v[112:115], v[24:25], v[176:177], v[112:115]
    v_mfma_f32_4x4x4_16b_bf16 v[116:119], v[24:25], v[180:181], v[116:119]
    v_mfma_f32_4x4x4_16b_bf16 v[120:123], v[24:25], v[184:185], v[120:123]
    v_mfma_f32_4x4x4_16b_bf16 v[124:127], v[24:25], v[188:189], v[124:127]
    v_mfma_f32_4x4x4_16b_bf16 v[112:115], v[26:27], v[178:179], v[112:115]
    v_mfma_f32_4x4x4_16b_bf16 v[116:119], v[26:27], v[182:183], v[116:119]
    v_mfma_f32_4x4x4_16b_bf16 v[120:123], v[26:27], v[186:187], v[120:123]
    v_mfma_f32_4x4x4_16b_bf16 v[124:127], v[26:27], v[190:191], v[124:127]
    s_nop 3
    s_waitcnt lgkmcnt(6)
    v_exp_f32 v112, v112
    v_exp_f32 v113, v113
    s_nop 0
    v_add_f32 v112, 1.0, v112
    v_add_f32 v113, 1.0, v113
    v_rcp_f32 v112, v112
    v_rcp_f32 v113, v113
    buffer_load_dword v208, v48, s[36:39], 0 offen
    buffer_load_dword v209, v49, s[36:39], 0 offen
    buffer_load_dword v210, v50, s[36:39], 0 offen
    buffer_load_dword v211, v51, s[36:39], 0 offen
    s_waitcnt lgkmcnt(5)
    v_cvt_pkrtz_f16_f32 v114, v114, v115
    v_and_b32_sdwa v115, s67, v114 dst_sel:DWORD dst_unused:UNUSED_PAD src0_sel:DWORD src1_sel:WORD_1
    v_and_b32 v114, s67, v114
    ds_read_u16_d16_hi v115, v115 offset:40960
    ds_read_u16_d16_hi v114, v114 offset:40960
    buffer_load_dword v212, v52, s[36:39], 0 offen
    buffer_load_dword v213, v53, s[36:39], 0 offen
    buffer_load_dword v214, v54, s[36:39], 0 offen
    buffer_load_dword v215, v55, s[36:39], 0 offen
    s_waitcnt lgkmcnt(6)
    v_cvt_pkrtz_f16_f32 v116, v116, v117
    v_and_b32_sdwa v117, s67, v116 dst_sel:DWORD dst_unused:UNUSED_PAD src0_sel:DWORD src1_sel:WORD_1
    v_and_b32 v116, s67, v116
    ds_read_u16_d16_hi v117, v117 offset:40960
    ds_read_u16_d16_hi v116, v116 offset:40960
    buffer_load_dword v216, v56, s[36:39], 0 offen
    buffer_load_dword v217, v57, s[36:39], 0 offen
    buffer_load_dword v218, v58, s[36:39], 0 offen
    buffer_load_dword v219, v59, s[36:39], 0 offen
    s_waitcnt lgkmcnt(7)
    v_cvt_pkrtz_f16_f32 v118, v118, v119
    v_and_b32_sdwa v119, s67, v118 dst_sel:DWORD dst_unused:UNUSED_PAD src0_sel:DWORD src1_sel:WORD_1
    v_and_b32 v118, s67, v118
    ds_read_u16_d16_hi v119, v119 offset:40960
    ds_read_u16_d16_hi v118, v118 offset:40960
    buffer_load_dword v220, v60, s[36:39], 0 offen
    buffer_load_dword v221, v61, s[36:39], 0 offen
    buffer_load_dword v222, v62, s[36:39], 0 offen
    buffer_load_dword v223, v63, s[36:39], 0 offen
    s_waitcnt vmcnt(16)
    v_mfma_f32_4x4x4_16b_bf16 v[128:131], v[24:25], v[192:193], v[128:131]
    v_mfma_f32_4x4x4_16b_bf16 v[132:135], v[24:25], v[196:197], v[132:135]
    v_mfma_f32_4x4x4_16b_bf16 v[136:139], v[24:25], v[200:201], v[136:139]
    v_mfma_f32_4x4x4_16b_bf16 v[140:143], v[24:25], v[204:205], v[140:143]
    v_mfma_f32_4x4x4_16b_bf16 v[128:131], v[26:27], v[194:195], v[128:131]
    v_mfma_f32_4x4x4_16b_bf16 v[132:135], v[26:27], v[198:199], v[132:135]
    v_mfma_f32_4x4x4_16b_bf16 v[136:139], v[26:27], v[202:203], v[136:139]
    v_mfma_f32_4x4x4_16b_bf16 v[140:143], v[26:27], v[206:207], v[140:143]
    s_waitcnt lgkmcnt(13)
    v_cvt_pkrtz_f16_f32 v120, v120, v121
    v_and_b32_sdwa v121, s67, v120 dst_sel:DWORD dst_unused:UNUSED_PAD src0_sel:DWORD src1_sel:WORD_1
    v_and_b32 v120, s67, v120
    ds_read_u16_d16_hi v121, v121 offset:40960
    ds_read_u16_d16_hi v120, v120 offset:40960
    s_waitcnt lgkmcnt(13)
    v_cvt_pkrtz_f16_f32 v122, v122, v123
    v_and_b32_sdwa v123, s67, v122 dst_sel:DWORD dst_unused:UNUSED_PAD src0_sel:DWORD src1_sel:WORD_1
    v_and_b32 v122, s67, v122
    ds_read_u16_d16_hi v123, v123 offset:40960
    ds_read_u16_d16_hi v122, v122 offset:40960
    s_waitcnt lgkmcnt(10)
    v_cvt_pkrtz_f16_f32 v124, v124, v125
    v_and_b32_sdwa v125, s67, v124 dst_sel:DWORD dst_unused:UNUSED_PAD src0_sel:DWORD src1_sel:WORD_1
    v_and_b32 v124, s67, v124
    ds_read_u16_d16_hi v125, v125 offset:40960
    ds_read_u16_d16_hi v124, v124 offset:40960
    s_waitcnt vmcnt(36)
    s_add_u32 s23, s23, 1
    v_cmp_gt_u32 vcc, s23, v4
    s_cbranch_vccnz K2_SP7
K2_OK7:
    v_lshl_add_u32 v4, v3, 3, v254
    ds_read_b128 v[44:47], v4 offset:1024
    s_waitcnt lgkmcnt(13)
    v_cvt_pkrtz_f16_f32 v126, v126, v127
    v_and_b32_sdwa v127, s67, v126 dst_sel:DWORD dst_unused:UNUSED_PAD src0_sel:DWORD src1_sel:WORD_1
    v_and_b32 v126, s67, v126
    ds_read_u16_d16_hi v127, v127 offset:40960
    ds_read_u16_d16_hi v126, v126 offset:40960
    s_waitcnt lgkmcnt(2)
    v_mfma_f32_32x32x16_bf16 v[144:159], v[44:47], v[8:11], 0
    v_exp_f32 v128, v128
    v_mul_f32 v176, v112, v176
    v_exp_f32 v129, v129
    v_mul_f32 v177, v113, v177
    v_add_f32 v128, 1.0, v128
    v_cvt_pk_bf16_f32 v112, v112, v176
    v_add_f32 v129, 1.0, v129
    v_cvt_pk_bf16_f32 v113, v113, v177
    v_rcp_f32 v128, v128
    v_rcp_f32 v129, v129
    buffer_load_dword v224, v48, s[36:39], 0 offen offset:128
    buffer_load_dword v225, v49, s[36:39], 0 offen offset:128
    buffer_load_dword v226, v50, s[36:39], 0 offen offset:128
    buffer_load_dword v227, v51, s[36:39], 0 offen offset:128
    v_mfma_f32_32x32x16_bf16 v[144:159], v[36:39], v[16:19], v[144:159]
    v_cvt_pkrtz_f16_f32 v130, v130, v131
    v_mul_f32 v178, v114, v178
    v_and_b32_sdwa v131, s67, v130 dst_sel:DWORD dst_unused:UNUSED_PAD src0_sel:DWORD src1_sel:WORD_1
    v_mul_f32 v179, v115, v179
    v_and_b32 v130, s67, v130
    v_cvt_pk_bf16_f32 v114, v114, v178
    v_cvt_pk_bf16_f32 v115, v115, v179
    ds_read_u16_d16_hi v131, v131 offset:40960
    ds_read_u16_d16_hi v130, v130 offset:40960
    buffer_load_dword v228, v52, s[36:39], 0 offen offset:128
    buffer_load_dword v229, v53, s[36:39], 0 offen offset:128
    buffer_load_dword v230, v54, s[36:39], 0 offen offset:128
    buffer_load_dword v231, v55, s[36:39], 0 offen offset:128
    s_waitcnt lgkmcnt(11)
    v_mfma_f32_32x32x16_bf16 v[96:111], v[32:35], v[28:31], 0
    v_cvt_pkrtz_f16_f32 v132, v132, v133
    v_mul_f32 v180, v116, v180
    v_and_b32_sdwa v133, s67, v132 dst_sel:DWORD dst_unused:UNUSED_PAD src0_sel:DWORD src1_sel:WORD_1
    v_mul_f32 v181, v117, v181
    v_and_b32 v132, s67, v132
    v_cvt_pk_bf16_f32 v116, v116, v180
    v_cvt_pk_bf16_f32 v117, v117, v181
    ds_read_u16_d16_hi v133, v133 offset:40960
    ds_read_u16_d16_hi v132, v132 offset:40960
    buffer_load_dword v232, v56, s[36:39], 0 offen offset:128
    buffer_load_dword v233, v57, s[36:39], 0 offen offset:128
    buffer_load_dword v234, v58, s[36:39], 0 offen offset:128
    buffer_load_dword v235, v59, s[36:39], 0 offen offset:128
    v_cvt_pkrtz_f16_f32 v134, v134, v135
    v_mul_f32 v182, v118, v182
    v_and_b32_sdwa v135, s67, v134 dst_sel:DWORD dst_unused:UNUSED_PAD src0_sel:DWORD src1_sel:WORD_1
    v_mul_f32 v183, v119, v183
    v_and_b32 v134, s67, v134
    v_cvt_pk_bf16_f32 v118, v118, v182
    v_cvt_pk_bf16_f32 v119, v119, v183
    ds_read_u16_d16_hi v135, v135 offset:40960
    ds_read_u16_d16_hi v134, v134 offset:40960
    buffer_load_dword v236, v60, s[36:39], 0 offen offset:128
    buffer_load_dword v237, v61, s[36:39], 0 offen offset:128
    buffer_load_dword v238, v62, s[36:39], 0 offen offset:128
    buffer_load_dword v239, v63, s[36:39], 0 offen offset:128
    s_waitcnt lgkmcnt(11)
    v_cvt_pkrtz_f16_f32 v136, v136, v137
    v_mul_f32 v184, v120, v184
    v_and_b32_sdwa v137, s67, v136 dst_sel:DWORD dst_unused:UNUSED_PAD src0_sel:DWORD src1_sel:WORD_1
    v_mul_f32 v185, v121, v185
    v_and_b32 v136, s67, v136
    v_cvt_pk_bf16_f32 v120, v120, v184
    v_cvt_pk_bf16_f32 v121, v121, v185
    ds_read_u16_d16_hi v137, v137 offset:40960
    ds_read_u16_d16_hi v136, v136 offset:40960
    buffer_load_dword v240, v6, s[28:31], 0 offen offset:0
    buffer_load_dword v241, v6, s[28:31], 0 offen offset:256
    buffer_load_dword v242, v6, s[28:31], 0 offen offset:512
    buffer_load_dword v243, v6, s[28:31], 0 offen offset:768
    buffer_load_dword v244, v6, s[28:31], 0 offen offset:2048
    buffer_load_dword v245, v6, s[28:31], 0 offen offset:2304
    v_cvt_pkrtz_f16_f32 v138, v138, v139
    v_mul_f32 v186, v122, v186
    v_and_b32_sdwa v139, s67, v138 dst_sel:DWORD dst_unused:UNUSED_PAD src0_sel:DWORD src1_sel:WORD_1
    v_mul_f32 v187, v123, v187
    s_waitcnt vmcnt(22)
    v_mfma_f32_4x4x4_16b_bf16 v[144:147], v[24:25], v[208:209], v[144:147]
    v_and_b32 v138, s67, v138
    v_mfma_f32_4x4x4_16b_bf16 v[148:151], v[24:25], v[212:213], v[148:151]
    v_cvt_pk_bf16_f32 v122, v122, v186
    v_cvt_pk_bf16_f32 v123, v123, v187
    ds_read_u16_d16_hi v139, v139 offset:40960
    ds_read_u16_d16_hi v138, v138 offset:40960
    s_waitcnt lgkmcnt(10)
    v_mfma_f32_4x4x4_16b_bf16 v[152:155], v[24:25], v[216:217], v[152:155]
    v_cvt_pkrtz_f16_f32 v140, v140, v141
    v_mfma_f32_4x4x4_16b_bf16 v[156:159], v[24:25], v[220:221], v[156:159]
    v_mul_f32 v188, v124, v188
    v_mfma_f32_4x4x4_16b_bf16 v[144:147], v[26:27], v[210:211], v[144:147]
    v_and_b32_sdwa v141, s67, v140 dst_sel:DWORD dst_unused:UNUSED_PAD src0_sel:DWORD src1_sel:WORD_1
    v_mfma_f32_4x4x4_16b_bf16 v[148:151], v[26:27], v[214:215], v[148:151]
    v_mul_f32 v189, v125, v189
    v_and_b32 v140, s67, v140
    v_cvt_pk_bf16_f32 v124, v124, v188
    v_cvt_pk_bf16_f32 v125, v125, v189
    ds_read_u16_d16_hi v141, v141 offset:40960
    ds_read_u16_d16_hi v140, v140 offset:40960
    v_mfma_f32_4x4x4_16b_bf16 v[152:155], v[26:27], v[218:219], v[152:155]
    v_cvt_pkrtz_f16_f32 v142, v142, v143
    v_mfma_f32_4x4x4_16b_bf16 v[156:159], v[26:27], v[222:223], v[156:159]
    v_mul_f32 v190, v126, v190
    v_and_b32_sdwa v143, s67, v142 dst_sel:DWORD dst_unused:UNUSED_PAD src0_sel:DWORD src1_sel:WORD_1
    v_mul_f32 v191, v127, v191
    v_and_b32 v142, s67, v142
    v_cvt_pk_bf16_f32 v126, v126, v190
    v_cvt_pk_bf16_f32 v127, v127, v191
    ds_read_u16_d16_hi v143, v143 offset:40960
    ds_read_u16_d16_hi v142, v142 offset:40960
    s_branch K2_MIDP0C
K2_ENTFC:
    ds_read_b32 v4, v255
    s_waitcnt lgkmcnt(0)
    s_add_u32 s23, s23, 1
    v_cmp_gt_u32 vcc, s23, v4
    s_cbranch_vccnz K2_SP2
K2_OK2:
    v_lshl_add_u32 v4, v3, 3, v254
    ds_read_b128 v[40:43], v4 offset:0
    ds_read_b32 v4, v255
    s_waitcnt lgkmcnt(1)
    v_mfma_f32_32x32x16_bf16 v[112:127], v[40:43], v[8:11], 0
    v_mfma_f32_32x32x16_bf16 v[112:127], v[32:35], v[16:19], v[112:127]
    v_mfma_f32_32x32x16_bf16 v[128:143], v[40:43], v[12:15], 0
    v_mfma_f32_32x32x16_bf16 v[128:143], v[32:35], v[20:23], v[128:143]
    s_nop 7
    s_waitcnt vmcnt(16)
    v_mfma_f32_4x4x4_16b_bf16 v[112:115], v[24:25], v[176:177], v[112:115]
    v_mfma_f32_4x4x4_16b_bf16 v[116:119], v[24:25], v[180:181], v[116:119]
    v_mfma_f32_4x4x4_16b_bf16 v[120:123], v[24:25], v[184:185], v[120:123]
    v_mfma_f32_4x4x4_16b_bf16 v[124:127], v[24:25], v[188:189], v[124:127]
    v_mfma_f32_4x4x4_16b_bf16 v[112:115], v[26:27], v[178:179], v[112:115]
    v_mfma_f32_4x4x4_16b_bf16 v[116:119], v[26:27], v[182:183], v[116:119]
    v_mfma_f32_4x4x4_16b_bf16 v[120:123], v[26:27], v[186:187], v[120:123]
    v_mfma_f32_4x4x4_16b_bf16 v[124:127], v[26:27], v[190:191], v[124:127]
    s_nop 3
    s_waitcnt lgkmcnt(6)
    v_exp_f32 v112, v112
    v_exp_f32 v113, v113
    s_nop 0
    v_add_f32 v112, 1.0, v112
    v_add_f32 v113, 1.0, v113
    v_rcp_f32 v112, v112
    v_rcp_f32 v113, v113
    buffer_load_dword v208, v48, s[36:39], 0 offen
    buffer_load_dword v209, v49, s[36:39], 0 offen
    buffer_load_dword v210, v50, s[36:39], 0 offen
    buffer_load_dword v211, v51, s[36:39], 0 offen
    s_waitcnt lgkmcnt(5)
    v_cvt_pkrtz_f16_f32 v114, v114, v115
    v_and_b32_sdwa v115, s67, v114 dst_sel:DWORD dst_unused:UNUSED_PAD src0_sel:DWORD src1_sel:WORD_1
    v_and_b32 v114, s67, v114
    ds_read_u16_d16_hi v115, v115 offset:40960
    ds_read_u16_d16_hi v114, v114 offset:40960
    buffer_load_dword v212, v52, s[36:39], 0 offen
    buffer_load_dword v213, v53, s[36:39], 0 offen
    buffer_load_dword v214, v54, s[36:39], 0 offen
    buffer_load_dword v215, v55, s[36:39], 0 offen
    s_waitcnt lgkmcnt(6)
    v_cvt_pkrtz_f16_f32 v116, v116, v117
    v_and_b32_sdwa v117, s67, v116 dst_sel:DWORD dst_unused:UNUSED_PAD src0_sel:DWORD src1_sel:WORD_1
    v_and_b32 v116, s67, v116
    ds_read_u16_d16_hi v117, v117 offset:40960
    ds_read_u16_d16_hi v116, v116 offset:40960
    buffer_load_dword v216, v56, s[36:39], 0 offen
    buffer_load_dword v217, v57, s[36:39], 0 offen
    buffer_load_dword v218, v58, s[36:39], 0 offen
    buffer_load_dword v219, v59, s[36:39], 0 offen
    s_waitcnt lgkmcnt(7)
    v_cvt_pkrtz_f16_f32 v118, v118, v119
    v_and_b32_sdwa v119, s67, v118 dst_sel:DWORD dst_unused:UNUSED_PAD src0_sel:DWORD src1_sel:WORD_1
    v_and_b32 v118, s67, v118
    ds_read_u16_d16_hi v119, v119 offset:40960
    ds_read_u16_d16_hi v118, v118 offset:40960
    buffer_load_dword v220, v60, s[36:39], 0 offen
    buffer_load_dword v221, v61, s[36:39], 0 offen
    buffer_load_dword v222, v62, s[36:39], 0 offen
    buffer_load_dword v223, v63, s[36:39], 0 offen
    s_waitcnt vmcnt(16)
    v_mfma_f32_4x4x4_16b_bf16 v[128:131], v[24:25], v[192:193], v[128:131]
    v_mfma_f32_4x4x4_16b_bf16 v[132:135], v[24:25], v[196:197], v[132:135]
    v_mfma_f32_4x4x4_16b_bf16 v[136:139], v[24:25], v[200:201], v[136:139]
    v_mfma_f32_4x4x4_16b_bf16 v[140:143], v[24:25], v[204:205], v[140:143]
    v_mfma_f32_4x4x4_16b_bf16 v[128:131], v[26:27], v[194:195], v[128:131]
    v_mfma_f32_4x4x4_16b_bf16 v[132:135], v[26:27], v[198:199], v[132:135]
    v_mfma_f32_4x4x4_16b_bf16 v[136:139], v[26:27], v[202:203], v[136:139]
    v_mfma_f32_4x4x4_16b_bf16 v[140:143], v[26:27], v[206:207], v[140:143]
    s_waitcnt lgkmcnt(13)
    v_cvt_pkrtz_f16_f32 v120, v120, v121
    v_and_b32_sdwa v121, s67, v120 dst_sel:DWORD dst_unused:UNUSED_PAD src0_sel:DWORD src1_sel:WORD_1
    v_and_b32 v120, s67, v120
    ds_read_u16_d16_hi v121, v121 offset:40960
    ds_read_u16_d16_hi v120, v120 offset:40960
    s_waitcnt lgkmcnt(13)
    v_cvt_pkrtz_f16_f32 v122, v122, v123
    v_and_b32_sdwa v123, s67, v122 dst_sel:DWORD dst_unused:UNUSED_PAD src0_sel:DWORD src1_sel:WORD_1
    v_and_b32 v122, s67, v122
    ds_read_u16_d16_hi v123, v123 offset:40960
    ds_read_u16_d16_hi v122, v122 offset:40960
    s_waitcnt lgkmcnt(10)
    v_cvt_pkrtz_f16_f32 v124, v124, v125
    v_and_b32_sdwa v125, s67, v124 dst_sel:DWORD dst_unused:UNUSED_PAD src0_sel:DWORD src1_sel:WORD_1
    v_and_b32 v124, s67, v124
    ds_read_u16_d16_hi v125, v125 offset:40960
    ds_read_u16_d16_hi v124, v124 offset:40960
    s_waitcnt vmcnt(36)
    s_add_u32 s23, s23, 1
    v_cmp_gt_u32 vcc, s23, v4
    s_cbranch_vccnz K2_SP3
K2_OK3:
    v_lshl_add_u32 v4, v3, 3, v254
    ds_read_b128 v[44:47], v4 offset:1024
    s_waitcnt lgkmcnt(13)
    v_cvt_pkrtz_f16_f32 v126, v126, v127
    v_and_b32_sdwa v127, s67, v126 dst_sel:DWORD dst_unused:UNUSED_PAD src0_sel:DWORD src1_sel:WORD_1
    v_and_b32 v126, s67, v126
    ds_read_u16_d16_hi v127, v127 offset:40960
    ds_read_u16_d16_hi v126, v126 offset:40960
    s_waitcnt lgkmcnt(2)
    v_mfma_f32_32x32x16_bf16 v[144:159], v[44:47], v[8:11], 0
    v_exp_f32 v128, v128
    v_mul_f32 v176, v112, v176
    v_exp_f32 v129, v129
    v_mul_f32 v177, v113, v177
    v_add_f32 v128, 1.0, v128
    v_cvt_pk_bf16_f32 v112, v112, v176
    v_add_f32 v129, 1.0, v129
    v_cvt_pk_bf16_f32 v113, v113, v177
    v_rcp_f32 v128, v128
    v_rcp_f32 v129, v129
    buffer_load_dword v224, v48, s[36:39], 0 offen offset:128
    buffer_load_dword v225, v49, s[36:39], 0 offen offset:128
    buffer_load_dword v226, v50, s[36:39], 0 offen offset:128
    buffer_load_dword v227, v51, s[36:39], 0 offen offset:128
    ds_read_b128 v[48:51], v2 offset:1792
    v_mfma_f32_32x32x16_bf16 v[144:159], v[36:39], v[16:19], v[144:159]
    v_cvt_pkrtz_f16_f32 v130, v130, v131
    v_mul_f32 v178, v114, v178
    v_and_b32_sdwa v131, s67, v130 dst_sel:DWORD dst_unused:UNUSED_PAD src0_sel:DWORD src1_sel:WORD_1
    v_mul_f32 v179, v115, v179
    v_and_b32 v130, s67, v130
    v_cvt_pk_bf16_f32 v114, v114, v178
    v_cvt_pk_bf16_f32 v115, v115, v179
    ds_read_u16_d16_hi v131, v131 offset:40960
    ds_read_u16_d16_hi v130, v130 offset:40960
    buffer_load_dword v228, v52, s[36:39], 0 offen offset:128
    buffer_load_dword v229, v53, s[36:39], 0 offen offset:128
    buffer_load_dword v230, v54, s[36:39], 0 offen offset:128
    buffer_load_dword v231, v55, s[36:39], 0 offen offset:128
    ds_read_b128 v[52:55], v2 offset:1824
    s_waitcnt lgkmcnt(9)
    v_mfma_f32_32x32x16_bf16 v[96:111], v[32:35], v[28:31], 0
    v_cvt_pkrtz_f16_f32 v132, v132, v133
    v_mul_f32 v180, v116, v180
    v_and_b32_sdwa v133, s67, v132 dst_sel:DWORD dst_unused:UNUSED_PAD src0_sel:DWORD src1_sel:WORD_1
    v_mul_f32 v181, v117, v181
    v_and_b32 v132, s67, v132
    v_cvt_pk_bf16_f32 v116, v116, v180
    v_cvt_pk_bf16_f32 v117, v117, v181
    ds_read_u16_d16_hi v133, v133 offset:40960
    ds_read_u16_d16_hi v132, v132 offset:40960
    buffer_load_dword v232, v56, s[36:39], 0 offen offset:128
    buffer_load_dword v233, v57, s[36:39], 0 offen offset:128
    buffer_load_dword v234, v58, s[36:39], 0 offen offset:128
    buffer_load_dword v235, v59, s[36:39], 0 offen offset:128
    ds_read_b128 v[56:59], v2 offset:1856
    v_cvt_pkrtz_f16_f32 v134, v134, v135
    v_mul_f32 v182, v118, v182
    v_and_b32_sdwa v135, s67, v134 dst_sel:DWORD dst_unused:UNUSED_PAD src0_sel:DWORD src1_sel:WORD_1
    v_mul_f32 v183, v119, v183
    v_and_b32 v134, s67, v134
    v_cvt_pk_bf16_f32 v118, v118, v182
    v_cvt_pk_bf16_f32 v119, v119, v183
    ds_read_u16_d16_hi v135, v135 offset:40960
    ds_read_u16_d16_hi v134, v134 offset:40960
    buffer_load_dword v236, v60, s[36:39], 0 offen offset:128
    buffer_load_dword v237, v61, s[36:39], 0 offen offset:128
    buffer_load_dword v238, v62, s[36:39], 0 offen offset:128
    buffer_load_dword v239, v63, s[36:39], 0 offen offset:128
    ds_read_b128 v[60:63], v2 offset:1888
    s_waitcnt lgkmcnt(10)
    v_cvt_pkrtz_f16_f32 v136, v136, v137
    v_mul_f32 v184, v120, v184
    v_and_b32_sdwa v137, s67, v136 dst_sel:DWORD dst_unused:UNUSED_PAD src0_sel:DWORD src1_sel:WORD_1
    v_mul_f32 v185, v121, v185
    v_and_b32 v136, s67, v136
    v_cvt_pk_bf16_f32 v120, v120, v184
    v_cvt_pk_bf16_f32 v121, v121, v185
    ds_read_u16_d16_hi v137, v137 offset:40960
    ds_read_u16_d16_hi v136, v136 offset:40960
    v_cvt_pkrtz_f16_f32 v138, v138, v139
    v_mul_f32 v186, v122, v186
    v_and_b32_sdwa v139, s67, v138 dst_sel:DWORD dst_unused:UNUSED_PAD src0_sel:DWORD src1_sel:WORD_1
    v_mul_f32 v187, v123, v187
    s_waitcnt vmcnt(16)
    v_mfma_f32_4x4x4_16b_bf16 v[144:147], v[24:25], v[208:209], v[144:147]
    v_and_b32 v138, s67, v138
    v_mfma_f32_4x4x4_16b_bf16 v[148:151], v[24:25], v[212:213], v[148:151]
    v_cvt_pk_bf16_f32 v122, v122, v186
    v_cvt_pk_bf16_f32 v123, v123, v187
    ds_read_u16_d16_hi v139, v139 offset:40960
    ds_read_u16_d16_hi v138, v138 offset:40960
    ds_read_b32 v5, v3 offset:8448
    s_waitcnt lgkmcnt(11)
    v_mfma_f32_4x4x4_16b_bf16 v[152:155], v[24:25], v[216:217], v[152:155]
    v_cvt_pkrtz_f16_f32 v140, v140, v141
    v_mfma_f32_4x4x4_16b_bf16 v[156:159], v[24:25], v[220:221], v[156:159]
    v_mul_f32 v188, v124, v188
    v_mfma_f32_4x4x4_16b_bf16 v[144:147], v[26:27], v[210:211], v[144:147]
    v_and_b32_sdwa v141, s67, v140 dst_sel:DWORD dst_unused:UNUSED_PAD src0_sel:DWORD src1_sel:WORD_1
    v_mfma_f32_4x4x4_16b_bf16 v[148:151], v[26:27], v[214:215], v[148:151]
    v_mul_f32 v189, v125, v189
    v_and_b32 v140, s67, v140
    v_cvt_pk_bf16_f32 v124, v124, v188
    v_cvt_pk_bf16_f32 v125, v125, v189
    ds_read_u16_d16_hi v141, v141 offset:40960
    ds_read_u16_d16_hi v140, v140 offset:40960
    v_mfma_f32_4x4x4_16b_bf16 v[152:155], v[26:27], v[218:219], v[152:155]
    v_cvt_pkrtz_f16_f32 v142, v142, v143
    v_mfma_f32_4x4x4_16b_bf16 v[156:159], v[26:27], v[222:223], v[156:159]
    v_mul_f32 v190, v126, v190
    v_and_b32_sdwa v143, s67, v142 dst_sel:DWORD dst_unused:UNUSED_PAD src0_sel:DWORD src1_sel:WORD_1
    v_mul_f32 v191, v127, v191
    v_and_b32 v142, s67, v142
    v_cvt_pk_bf16_f32 v126, v126, v190
    v_cvt_pk_bf16_f32 v127, v127, v191
    ds_read_u16_d16_hi v143, v143 offset:40960
    ds_read_u16_d16_hi v142, v142 offset:40960
    s_branch K2_MIDF0C
    .p2align 6
K2_BODYF0C:
    s_waitcnt lgkmcnt(11)
    v_mfma_f32_32x32x16_bf16 v[80:95], v[96:99], v[160:163], v[80:95]
    v_exp_f32 v128, v128
    v_mul_f32 v176, v112, v176
    v_exp_f32 v129, v129
    v_mul_f32 v177, v113, v177
    v_add_f32 v128, 1.0, v128
    v_cvt_pk_bf16_f32 v112, v112, v176
    v_mfma_f32_32x32x16_bf16 v[80:95], v[100:103], v[164:167], v[80:95]
    v_add_f32 v129, 1.0, v129
    v_cvt_pk_bf16_f32 v113, v113, v177
    v_rcp_f32 v128, v128
    v_rcp_f32 v129, v129
    buffer_load_dword v224, v48, s[36:39], 0 offen offset:128
    buffer_load_dword v225, v49, s[36:39], 0 offen offset:128
    buffer_load_dword v226, v50, s[36:39], 0 offen offset:128
    buffer_load_dword v227, v51, s[36:39], 0 offen offset:128
    ds_read_b128 v[48:51], v2 offset:1792
    v_mfma_f32_32x32x16_bf16 v[80:95], v[104:107], v[168:171], v[80:95]
    v_cvt_pkrtz_f16_f32 v130, v130, v131
    v_mul_f32 v178, v114, v178
    v_and_b32_sdwa v131, s67, v130 dst_sel:DWORD dst_unused:UNUSED_PAD src0_sel:DWORD src1_sel:WORD_1
    v_mul_f32 v179, v115, v179
    v_and_b32 v130, s67, v130
    v_cvt_pk_bf16_f32 v114, v114, v178
    v_cvt_pk_bf16_f32 v115, v115, v179
    ds_read_u16_d16_hi v131, v131 offset:40960
    ds_read_u16_d16_hi v130, v130 offset:40960
    buffer_load_dword v228, v52, s[36:39], 0 offen offset:128
    buffer_load_dword v229, v53, s[36:39], 0 offen offset:128
    buffer_load_dword v230, v54, s[36:39], 0 offen offset:128
    buffer_load_dword v231, v55, s[36:39], 0 offen offset:128
    ds_read_b128 v[52:55], v2 offset:1824
    s_waitcnt lgkmcnt(6)
    v_mfma_f32_32x32x16_bf16 v[144:159], v[44:47], v[8:11], 0
    v_cvt_pkrtz_f16_f32 v132, v132, v133
    v_mul_f32 v180, v116, v180
    v_and_b32_sdwa v133, s67, v132 dst_sel:DWORD dst_unused:UNUSED_PAD src0_sel:DWORD src1_sel:WORD_1
    v_mul_f32 v181, v117, v181
    v_and_b32 v132, s67, v132
    v_cvt_pk_bf16_f32 v116, v116, v180
    v_cvt_pk_bf16_f32 v117, v117, v181
    ds_read_u16_d16_hi v133, v133 offset:40960
    ds_read_u16_d16_hi v132, v132 offset:40960
    buffer_load_dword v232, v56, s[36:39], 0 offen offset:128
    buffer_load_dword v233, v57, s[36:39], 0 offen offset:128
    buffer_load_dword v234, v58, s[36:39], 0 offen offset:128
    buffer_load_dword v235, v59, s[36:39], 0 offen offset:128
    ds_read_b128 v[56:59], v2 offset:1856
    v_mfma_f32_32x32x16_bf16 v[144:159], v[36:39], v[16:19], v[144:159]
    v_cvt_pkrtz_f16_f32 v134, v134, v135
    v_mul_f32 v182, v118, v182
    v_and_b32_sdwa v135, s67, v134 dst_sel:DWORD dst_unused:UNUSED_PAD src0_sel:DWORD src1_sel:WORD_1
    v_mul_f32 v183, v119, v183
    v_and_b32 v134, s67, v134
    v_cvt_pk_bf16_f32 v118, v118, v182
    v_cvt_pk_bf16_f32 v119, v119, v183
    ds_read_u16_d16_hi v135, v135 offset:40960
    ds_read_u16_d16_hi v134, v134 offset:40960
    buffer_load_dword v236, v60, s[36:39], 0 offen offset:128
    buffer_load_dword v237, v61, s[36:39], 0 offen offset:128
    buffer_load_dword v238, v62, s[36:39], 0 offen offset:128
    buffer_load_dword v239, v63, s[36:39], 0 offen offset:128
    ds_read_b128 v[60:63], v2 offset:1888
    s_waitcnt lgkmcnt(10)
    v_mfma_f32_32x32x16_bf16 v[80:95], v[108:111], v[172:175], v[80:95]
    v_cvt_pkrtz_f16_f32 v136, v136, v137
    v_mul_f32 v184, v120, v184
    v_and_b32_sdwa v137, s67, v136 dst_sel:DWORD dst_unused:UNUSED_PAD src0_sel:DWORD src1_sel:WORD_1
    v_mul_f32 v185, v121, v185
    v_and_b32 v136, s67, v136
    v_cvt_pk_bf16_f32 v120, v120, v184
    v_cvt_pk_bf16_f32 v121, v121, v185
    ds_read_u16_d16_hi v137, v137 offset:40960
    ds_read_u16_d16_hi v136, v136 offset:40960
    v_mfma_f32_32x32x16_bf16 v[96:111], v[32:35], v[28:31], 0
    v_cvt_pkrtz_f16_f32 v138, v138, v139
    v_mul_f32 v186, v122, v186
    v_and_b32_sdwa v139, s67, v138 dst_sel:DWORD dst_unused:UNUSED_PAD src0_sel:DWORD src1_sel:WORD_1
    v_mul_f32 v187, v123, v187
    s_waitcnt vmcnt(16)
    v_mfma_f32_4x4x4_16b_bf16 v[144:147], v[24:25], v[208:209], v[144:147]
    v_and_b32 v138, s67, v138
    v_mfma_f32_4x4x4_16b_bf16 v[148:151], v[24:25], v[212:213], v[148:151]
    v_cvt_pk_bf16_f32 v122, v122, v186
    v_cvt_pk_bf16_f32 v123, v123, v187
    ds_read_u16_d16_hi v139, v139 offset:40960
    ds_read_u16_d16_hi v138, v138 offset:40960
    ds_read_b32 v5, v3 offset:8448
    s_waitcnt lgkmcnt(11)
    v_mfma_f32_4x4x4_16b_bf16 v[152:155], v[24:25], v[216:217], v[152:155]
    v_cvt_pkrtz_f16_f32 v140, v140, v141
    v_mfma_f32_4x4x4_16b_bf16 v[156:159], v[24:25], v[220:221], v[156:159]
    v_mul_f32 v188, v124, v188
    v_mfma_f32_4x4x4_16b_bf16 v[144:147], v[26:27], v[210:211], v[144:147]
    v_and_b32_sdwa v141, s67, v140 dst_sel:DWORD dst_unused:UNUSED_PAD src0_sel:DWORD src1_sel:WORD_1
    v_mfma_f32_4x4x4_16b_bf16 v[148:151], v[26:27], v[214:215], v[148:151]
    v_mul_f32 v189, v125, v189
    v_and_b32 v140, s67, v140
    v_cvt_pk_bf16_f32 v124, v124, v188
    v_cvt_pk_bf16_f32 v125, v125, v189
    ds_read_u16_d16_hi v141, v141 offset:40960
    ds_read_u16_d16_hi v140, v140 offset:40960
    v_mfma_f32_4x4x4_16b_bf16 v[152:155], v[26:27], v[218:219], v[152:155]
    v_cvt_pkrtz_f16_f32 v142, v142, v143
    v_mfma_f32_4x4x4_16b_bf16 v[156:159], v[26:27], v[222:223], v[156:159]
    v_mul_f32 v190, v126, v190
    v_and_b32_sdwa v143, s67, v142 dst_sel:DWORD dst_unused:UNUSED_PAD src0_sel:DWORD src1_sel:WORD_1
    v_mul_f32 v191, v127, v191
    v_and_b32 v142, s67, v142
    v_cvt_pk_bf16_f32 v126, v126, v190
    v_cvt_pk_bf16_f32 v127, v127, v191
    ds_read_u16_d16_hi v143, v143 offset:40960
    ds_read_u16_d16_hi v142, v142 offset:40960
K2_MIDF0C:
    s_waitcnt lgkmcnt(12)
    v_mfma_f32_32x32x16_bf16 v[64:79], v[96:99], v[112:115], v[64:79]
    v_exp_f32 v144, v144
    v_mul_f32 v192, v128, v192
    v_exp_f32 v145, v145
    v_mul_f32 v193, v129, v193
    v_add_f32 v144, 1.0, v144
    v_cvt_pk_bf16_f32 v128, v128, v192
    v_add_f32 v145, 1.0, v145
    v_cvt_pk_bf16_f32 v129, v129, v193
    v_rcp_f32 v144, v144
    v_rcp_f32 v145, v145
    buffer_load_dword v176, v48, s[36:39], 0 offen
    buffer_load_dword v177, v49, s[36:39], 0 offen
    buffer_load_dword v178, v50, s[36:39], 0 offen
    buffer_load_dword v179, v51, s[36:39], 0 offen
    v_mfma_f32_32x32x16_bf16 v[64:79], v[100:103], v[116:119], v[64:79]
    v_cvt_pkrtz_f16_f32 v146, v146, v147
    v_mul_f32 v194, v130, v194
    v_and_b32_sdwa v147, s67, v146 dst_sel:DWORD dst_unused:UNUSED_PAD src0_sel:DWORD src1_sel:WORD_1
    v_mul_f32 v195, v131, v195
    v_and_b32 v146, s67, v146
    v_cvt_pk_bf16_f32 v130, v130, v194
    v_cvt_pk_bf16_f32 v131, v131, v195
    ds_read_u16_d16_hi v147, v147 offset:40960
    ds_read_u16_d16_hi v146, v146 offset:40960
    buffer_load_dword v180, v52, s[36:39], 0 offen
    buffer_load_dword v181, v53, s[36:39], 0 offen
    buffer_load_dword v182, v54, s[36:39], 0 offen
    buffer_load_dword v183, v55, s[36:39], 0 offen
    ds_read_b32 v4, v255
    s_waitcnt lgkmcnt(7)
    v_mfma_f32_32x32x16_bf16 v[160:175], v[44:47], v[12:15], 0
    v_cvt_pkrtz_f16_f32 v148, v148, v149
    v_mul_f32 v196, v132, v196
    v_and_b32_sdwa v149, s67, v148 dst_sel:DWORD dst_unused:UNUSED_PAD src0_sel:DWORD src1_sel:WORD_1
    v_mul_f32 v197, v133, v197
    v_and_b32 v148, s67, v148
    v_cvt_pk_bf16_f32 v132, v132, v196
    v_cvt_pk_bf16_f32 v133, v133, v197
    ds_read_u16_d16_hi v149, v149 offset:40960
    ds_read_u16_d16_hi v148, v148 offset:40960
    buffer_load_dword v184, v56, s[36:39], 0 offen
    buffer_load_dword v185, v57, s[36:39], 0 offen
    buffer_load_dword v186, v58, s[36:39], 0 offen
    buffer_load_dword v187, v59, s[36:39], 0 offen
    v_and_b32 v5, 30, v5
    v_lshl_add_u32 v5, v5, 3, v253
    ds_read_b128 v[32:35], v5 offset:1024
    v_mfma_f32_32x32x16_bf16 v[160:175], v[36:39], v[20:23], v[160:175]
    v_cvt_pkrtz_f16_f32 v150, v150, v151
    v_mul_f32 v198, v134, v198
    v_and_b32_sdwa v151, s67, v150 dst_sel:DWORD dst_unused:UNUSED_PAD src0_sel:DWORD src1_sel:WORD_1
    v_mul_f32 v199, v135, v199
    v_and_b32 v150, s67, v150
    v_cvt_pk_bf16_f32 v134, v134, v198
    v_cvt_pk_bf16_f32 v135, v135, v199
    ds_read_u16_d16_hi v151, v151 offset:40960
    ds_read_u16_d16_hi v150, v150 offset:40960
    buffer_load_dword v188, v60, s[36:39], 0 offen
    buffer_load_dword v189, v61, s[36:39], 0 offen
    buffer_load_dword v190, v62, s[36:39], 0 offen
    buffer_load_dword v191, v63, s[36:39], 0 offen
    s_waitcnt lgkmcnt(11)
    v_mfma_f32_32x32x16_bf16 v[64:79], v[104:107], v[120:123], v[64:79]
    v_cvt_pkrtz_f16_f32 v152, v152, v153
    v_mul_f32 v200, v136, v200
    v_and_b32_sdwa v153, s67, v152 dst_sel:DWORD dst_unused:UNUSED_PAD src0_sel:DWORD src1_sel:WORD_1
    v_mul_f32 v201, v137, v201
    v_and_b32 v152, s67, v152
    v_cvt_pk_bf16_f32 v136, v136, v200
    v_cvt_pk_bf16_f32 v137, v137, v201
    ds_read_u16_d16_hi v153, v153 offset:40960
    ds_read_u16_d16_hi v152, v152 offset:40960
    v_mfma_f32_32x32x16_bf16 v[64:79], v[108:111], v[124:127], v[64:79]
    v_cvt_pkrtz_f16_f32 v154, v154, v155
    v_mul_f32 v202, v138, v202
    v_and_b32_sdwa v155, s67, v154 dst_sel:DWORD dst_unused:UNUSED_PAD src0_sel:DWORD src1_sel:WORD_1
    v_mul_f32 v203, v139, v203
    s_waitcnt vmcnt(16)
    v_mfma_f32_4x4x4_16b_bf16 v[160:163], v[24:25], v[224:225], v[160:163]
    v_and_b32 v154, s67, v154
    v_mfma_f32_4x4x4_16b_bf16 v[164:167], v[24:25], v[228:229], v[164:167]
    v_cvt_pk_bf16_f32 v138, v138, v202
    v_cvt_pk_bf16_f32 v139, v139, v203
    ds_read_u16_d16_hi v155, v155 offset:40960
    ds_read_u16_d16_hi v154, v154 offset:40960
    s_waitcnt lgkmcnt(9)
    v_mfma_f32_4x4x4_16b_bf16 v[168:171], v[24:25], v[232:233], v[168:171]
    v_cvt_pkrtz_f16_f32 v156, v156, v157
    v_mfma_f32_4x4x4_16b_bf16 v[172:175], v[24:25], v[236:237], v[172:175]
    v_mul_f32 v204, v140, v204
    v_mfma_f32_4x4x4_16b_bf16 v[160:163], v[26:27], v[226:227], v[160:163]
    v_and_b32_sdwa v157, s67, v156 dst_sel:DWORD dst_unused:UNUSED_PAD src0_sel:DWORD src1_sel:WORD_1
    v_mfma_f32_4x4x4_16b_bf16 v[164:167], v[26:27], v[230:231], v[164:167]
    v_mul_f32 v205, v141, v205
    v_and_b32 v156, s67, v156
    v_cvt_pk_bf16_f32 v140, v140, v204
    v_cvt_pk_bf16_f32 v141, v141, v205
    ds_read_u16_d16_hi v157, v157 offset:40960
    ds_read_u16_d16_hi v156, v156 offset:40960
    s_add_u32 s23, s23, 1
    v_cmp_gt_u32 vcc, s23, v4
    s_cbranch_vccnz K2_SP4
K2_OK4:
    v_lshl_add_u32 v4, v3, 3, v254
    ds_read_b128 v[40:43], v4 offset:2048
    v_mfma_f32_4x4x4_16b_bf16 v[168:171], v[26:27], v[234:235], v[168:171]
    v_cvt_pkrtz_f16_f32 v158, v158, v159
    v_mfma_f32_4x4x4_16b_bf16 v[172:175], v[26:27], v[238:239], v[172:175]
    v_mul_f32 v206, v142, v206
    v_and_b32_sdwa v159, s67, v158 dst_sel:DWORD dst_unused:UNUSED_PAD src0_sel:DWORD src1_sel:WORD_1
    v_mul_f32 v207, v143, v207
    v_and_b32 v158, s67, v158
    v_cvt_pk_bf16_f32 v142, v142, v206
    v_cvt_pk_bf16_f32 v143, v143, v207
    ds_read_u16_d16_hi v159, v159 offset:40960
    ds_read_u16_d16_hi v158, v158 offset:40960
    s_sub_u32 s54, s54, 1
    s_cmp_eq_u32 s54, 2
    s_cbranch_scc1 K2_BODYP1C
K2_BODYF1C:
    s_waitcnt lgkmcnt(11)
    v_mfma_f32_32x32x16_bf16 v[80:95], v[96:99], v[128:131], v[80:95]
    v_exp_f32 v160, v160
    v_mul_f32 v208, v144, v208
    v_exp_f32 v161, v161
    v_mul_f32 v209, v145, v209
    v_add_f32 v160, 1.0, v160
    v_cvt_pk_bf16_f32 v144, v144, v208
    v_mfma_f32_32x32x16_bf16 v[80:95], v[100:103], v[132:135], v[80:95]
    v_add_f32 v161, 1.0, v161
    v_cvt_pk_bf16_f32 v145, v145, v209
    v_rcp_f32 v160, v160
    v_rcp_f32 v161, v161
    buffer_load_dword v192, v48, s[36:39], 0 offen offset:128
    buffer_load_dword v193, v49, s[36:39], 0 offen offset:128
    buffer_load_dword v194, v50, s[36:39], 0 offen offset:128
    buffer_load_dword v195, v51, s[36:39], 0 offen offset:128
    ds_read_b128 v[48:51], v2 offset:1920
    v_mfma_f32_32x32x16_bf16 v[80:95], v[104:107], v[136:139], v[80:95]
    v_cvt_pkrtz_f16_f32 v162, v162, v163
    v_mul_f32 v210, v146, v210
    v_and_b32_sdwa v163, s67, v162 dst_sel:DWORD dst_unused:UNUSED_PAD src0_sel:DWORD src1_sel:WORD_1
    v_mul_f32 v211, v147, v211
    v_and_b32 v162, s67, v162
    v_cvt_pk_bf16_f32 v146, v146, v210
    v_cvt_pk_bf16_f32 v147, v147, v211
    ds_read_u16_d16_hi v163, v163 offset:40960
    ds_read_u16_d16_hi v162, v162 offset:40960
    buffer_load_dword v196, v52, s[36:39], 0 offen offset:128
    buffer_load_dword v197, v53, s[36:39], 0 offen offset:128
    buffer_load_dword v198, v54, s[36:39], 0 offen offset:128
    buffer_load_dword v199, v55, s[36:39], 0 offen offset:128
    ds_read_b128 v[52:55], v2 offset:1952
    s_waitcnt lgkmcnt(6)
    v_mfma_f32_32x32x16_bf16 v[112:127], v[40:43], v[8:11], 0
    v_cvt_pkrtz_f16_f32 v164, v164, v165
    v_mul_f32 v212, v148, v212
    v_and_b32_sdwa v165, s67, v164 dst_sel:DWORD dst_unused:UNUSED_PAD src0_sel:DWORD src1_sel:WORD_1
    v_mul_f32 v213, v149, v213
    v_and_b32 v164, s67, v164
    v_cvt_pk_bf16_f32 v148, v148, v212
    v_cvt_pk_bf16_f32 v149, v149, v213
    ds_read_u16_d16_hi v165, v165 offset:40960
    ds_read_u16_d16_hi v164, v164 offset:40960
    buffer_load_dword v200, v56, s[36:39], 0 offen offset:128
    buffer_load_dword v201, v57, s[36:39], 0 offen offset:128
    buffer_load_dword v202, v58, s[36:39], 0 offen offset:128
    buffer_load_dword v203, v59, s[36:39], 0 offen offset:128
    ds_read_b128 v[56:59], v2 offset:1984
    v_mfma_f32_32x32x16_bf16 v[112:127], v[32:35], v[16:19], v[112:127]
    v_cvt_pkrtz_f16_f32 v166, v166, v167
    v_mul_f32 v214, v150, v214
    v_and_b32_sdwa v167, s67, v166 dst_sel:DWORD dst_unused:UNUSED_PAD src0_sel:DWORD src1_sel:WORD_1
    v_mul_f32 v215, v151, v215
    v_and_b32 v166, s67, v166
    v_cvt_pk_bf16_f32 v150, v150, v214
    v_cvt_pk_bf16_f32 v151, v151, v215
    ds_read_u16_d16_hi v167, v167 offset:40960
    ds_read_u16_d16_hi v166, v166 offset:40960
    buffer_load_dword v204, v60, s[36:39], 0 offen offset:128
    buffer_load_dword v205, v61, s[36:39], 0 offen offset:128
    buffer_load_dword v206, v62, s[36:39], 0 offen offset:128
    buffer_load_dword v207, v63, s[36:39], 0 offen offset:128
    ds_read_b128 v[60:63], v2 offset:2016
    s_waitcnt lgkmcnt(10)
    v_mfma_f32_32x32x16_bf16 v[80:95], v[108:111], v[140:143], v[80:95]
    v_cvt_pkrtz_f16_f32 v168, v168, v169
    v_mul_f32 v216, v152, v216
    v_and_b32_sdwa v169, s67, v168 dst_sel:DWORD dst_unused:UNUSED_PAD src0_sel:DWORD src1_sel:WORD_1
    v_mul_f32 v217, v153, v217
    v_and_b32 v168, s67, v168
    v_cvt_pk_bf16_f32 v152, v152, v216
    v_cvt_pk_bf16_f32 v153, v153, v217
    ds_read_u16_d16_hi v169, v169 offset:40960
    ds_read_u16_d16_hi v168, v168 offset:40960
    v_mfma_f32_32x32x16_bf16 v[96:111], v[36:39], v[28:31], 0
    v_cvt_pkrtz_f16_f32 v170, v170, v171
    v_mul_f32 v218, v154, v218
    v_and_b32_sdwa v171, s67, v170 dst_sel:DWORD dst_unused:UNUSED_PAD src0_sel:DWORD src1_sel:WORD_1
    v_mul_f32 v219, v155, v219
    s_waitcnt vmcnt(16)
    v_mfma_f32_4x4x4_16b_bf16 v[112:115], v[24:25], v[176:177], v[112:115]
    v_and_b32 v170, s67, v170
    v_mfma_f32_4x4x4_16b_bf16 v[116:119], v[24:25], v[180:181], v[116:119]
    v_cvt_pk_bf16_f32 v154, v154, v218
    v_cvt_pk_bf16_f32 v155, v155, v219
    ds_read_u16_d16_hi v171, v171 offset:40960
    ds_read_u16_d16_hi v170, v170 offset:40960
    ds_read_b32 v5, v3 offset:8576
    s_waitcnt lgkmcnt(11)
    v_mfma_f32_4x4x4_16b_bf16 v[120:123], v[24:25], v[184:185], v[120:123]
    v_cvt_pkrtz_f16_f32 v172, v172, v173
    v_mfma_f32_4x4x4_16b_bf16 v[124:127], v[24:25], v[188:189], v[124:127]
    v_mul_f32 v220, v156, v220
    v_mfma_f32_4x4x4_16b_bf16 v[112:115], v[26:27], v[178:179], v[112:115]
    v_and_b32_sdwa v173, s67, v172 dst_sel:DWORD dst_unused:UNUSED_PAD src0_sel:DWORD src1_sel:WORD_1
    v_mfma_f32_4x4x4_16b_bf16 v[116:119], v[26:27], v[182:183], v[116:119]
    v_mul_f32 v221, v157, v221
    v_and_b32 v172, s67, v172
    v_cvt_pk_bf16_f32 v156, v156, v220
    v_cvt_pk_bf16_f32 v157, v157, v221
    ds_read_u16_d16_hi v173, v173 offset:40960
    ds_read_u16_d16_hi v172, v172 offset:40960
    v_mfma_f32_4x4x4_16b_bf16 v[120:123], v[26:27], v[186:187], v[120:123]
    v_cvt_pkrtz_f16_f32 v174, v174, v175
    v_mfma_f32_4x4x4_16b_bf16 v[124:127], v[26:27], v[190:191], v[124:127]
    v_mul_f32 v222, v158, v222
    v_and_b32_sdwa v175, s67, v174 dst_sel:DWORD dst_unused:UNUSED_PAD src0_sel:DWORD src1_sel:WORD_1
    v_mul_f32 v223, v159, v223
    v_and_b32 v174, s67, v174
    v_cvt_pk_bf16_f32 v158, v158, v222
    v_cvt_pk_bf16_f32 v159, v159, v223
    ds_read_u16_d16_hi v175, v175 offset:40960
    ds_read_u16_d16_hi v174, v174 offset:40960
K2_MIDF1C:
    s_waitcnt lgkmcnt(12)
    v_mfma_f32_32x32x16_bf16 v[64:79], v[96:99], v[144:147], v[64:79]
    v_exp_f32 v112, v112
    v_mul_f32 v224, v160, v224
    v_exp_f32 v113, v113
    v_mul_f32 v225, v161, v225
    v_add_f32 v112, 1.0, v112
    v_cvt_pk_bf16_f32 v160, v160, v224
    v_add_f32 v113, 1.0, v113
    v_cvt_pk_bf16_f32 v161, v161, v225
    v_rcp_f32 v112, v112
    v_rcp_f32 v113, v113
    buffer_load_dword v208, v48, s[36:39], 0 offen
    buffer_load_dword v209, v49, s[36:39], 0 offen
    buffer_load_dword v210, v50, s[36:39], 0 offen
    buffer_load_dword v211, v51, s[36:39], 0 offen
    v_mfma_f32_32x32x16_bf16 v[64:79], v[100:103], v[148:151], v[64:79]
    v_cvt_pkrtz_f16_f32 v114, v114, v115
    v_mul_f32 v226, v162, v226
    v_and_b32_sdwa v115, s67, v114 dst_sel:DWORD dst_unused:UNUSED_PAD src0_sel:DWORD src1_sel:WORD_1
    v_mul_f32 v227, v163, v227
    v_and_b32 v114, s67, v114
    v_cvt_pk_bf16_f32 v162, v162, v226
    v_cvt_pk_bf16_f32 v163, v163, v227
    ds_read_u16_d16_hi v115, v115 offset:40960
    ds_read_u16_d16_hi v114, v114 offset:40960
    buffer_load_dword v212, v52, s[36:39], 0 offen
    buffer_load_dword v213, v53, s[36:39], 0 offen
    buffer_load_dword v214, v54, s[36:39], 0 offen
    buffer_load_dword v215, v55, s[36:39], 0 offen
    ds_read_b32 v4, v255
    s_waitcnt lgkmcnt(7)
    v_mfma_f32_32x32x16_bf16 v[128:143], v[40:43], v[12:15], 0
    v_cvt_pkrtz_f16_f32 v116, v116, v117
    v_mul_f32 v228, v164, v228
    v_and_b32_sdwa v117, s67, v116 dst_sel:DWORD dst_unused:UNUSED_PAD src0_sel:DWORD src1_sel:WORD_1
    v_mul_f32 v229, v165, v229
    v_and_b32 v116, s67, v116
    v_cvt_pk_bf16_f32 v164, v164, v228
    v_cvt_pk_bf16_f32 v165, v165, v229
    ds_read_u16_d16_hi v117, v117 offset:40960
    ds_read_u16_d16_hi v116, v116 offset:40960
    buffer_load_dword v216, v56, s[36:39], 0 offen
    buffer_load_dword v217, v57, s[36:39], 0 offen
    buffer_load_dword v218, v58, s[36:39], 0 offen
    buffer_load_dword v219, v59, s[36:39], 0 offen
    v_and_b32 v5, 30, v5
    v_lshl_add_u32 v5, v5, 3, v253
    ds_read_b128 v[36:39], v5 offset:1024
    v_mfma_f32_32x32x16_bf16 v[128:143], v[32:35], v[20:23], v[128:143]
    v_cvt_pkrtz_f16_f32 v118, v118, v119
    v_mul_f32 v230, v166, v230
    v_and_b32_sdwa v119, s67, v118 dst_sel:DWORD dst_unused:UNUSED_PAD src0_sel:DWORD src1_sel:WORD_1
    v_mul_f32 v231, v167, v231
    v_and_b32 v118, s67, v118
    v_cvt_pk_bf16_f32 v166, v166, v230
    v_cvt_pk_bf16_f32 v167, v167, v231
    ds_read_u16_d16_hi v119, v119 offset:40960
    ds_read_u16_d16_hi v118, v118 offset:40960
    buffer_load_dword v220, v60, s[36:39], 0 offen
    buffer_load_dword v221, v61, s[36:39], 0 offen
    buffer_load_dword v222, v62, s[36:39], 0 offen
    buffer_load_dword v223, v63, s[36:39], 0 offen
    s_waitcnt lgkmcnt(11)
    v_mfma_f32_32x32x16_bf16 v[64:79], v[104:107], v[152:155], v[64:79]
    v_cvt_pkrtz_f16_f32 v120, v120, v121
    v_mul_f32 v232, v168, v232
    v_and_b32_sdwa v121, s67, v120 dst_sel:DWORD dst_unused:UNUSED_PAD src0_sel:DWORD src1_sel:WORD_1
    v_mul_f32 v233, v169, v233
    v_and_b32 v120, s67, v120
    v_cvt_pk_bf16_f32 v168, v168, v232
    v_cvt_pk_bf16_f32 v169, v169, v233
    ds_read_u16_d16_hi v121, v121 offset:40960
    ds_read_u16_d16_hi v120, v120 offset:40960
    v_mfma_f32_32x32x16_bf16 v[64:79], v[108:111], v[156:159], v[64:79]
    v_cvt_pkrtz_f16_f32 v122, v122, v123
    v_mul_f32 v234, v170, v234
    v_and_b32_sdwa v123, s67, v122 dst_sel:DWORD dst_unused:UNUSED_PAD src0_sel:DWORD src1_sel:WORD_1
    v_mul_f32 v235, v171, v235
    s_waitcnt vmcnt(16)
    v_mfma_f32_4x4x4_16b_bf16 v[128:131], v[24:25], v[192:193], v[128:131]
    v_and_b32 v122, s67, v122
    v_mfma_f32_4x4x4_16b_bf16 v[132:135], v[24:25], v[196:197], v[132:135]
    v_cvt_pk_bf16_f32 v170, v170, v234
    v_cvt_pk_bf16_f32 v171, v171, v235
    ds_read_u16_d16_hi v123, v123 offset:40960
    ds_read_u16_d16_hi v122, v122 offset:40960
    s_waitcnt lgkmcnt(9)
    v_mfma_f32_4x4x4_16b_bf16 v[136:139], v[24:25], v[200:201], v[136:139]
    v_cvt_pkrtz_f16_f32 v124, v124, v125
    v_mfma_f32_4x4x4_16b_bf16 v[140:143], v[24:25], v[204:205], v[140:143]
    v_mul_f32 v236, v172, v236
    v_mfma_f32_4x4x4_16b_bf16 v[128:131], v[26:27], v[194:195], v[128:131]
    v_and_b32_sdwa v125, s67, v124 dst_sel:DWORD dst_unused:UNUSED_PAD src0_sel:DWORD src1_sel:WORD_1
    v_mfma_f32_4x4x4_16b_bf16 v[132:135], v[26:27], v[198:199], v[132:135]
    v_mul_f32 v237, v173, v237
    v_and_b32 v124, s67, v124
    v_cvt_pk_bf16_f32 v172, v172, v236
    v_cvt_pk_bf16_f32 v173, v173, v237
    ds_read_u16_d16_hi v125, v125 offset:40960
    ds_read_u16_d16_hi v124, v124 offset:40960
    s_add_u32 s23, s23, 1
    v_cmp_gt_u32 vcc, s23, v4
    s_cbranch_vccnz K2_SP5
K2_OK5:
    v_lshl_add_u32 v4, v3, 3, v254
    ds_read_b128 v[44:47], v4 offset:3072
    v_mfma_f32_4x4x4_16b_bf16 v[136:139], v[26:27], v[202:203], v[136:139]
    v_cvt_pkrtz_f16_f32 v126, v126, v127
    v_mfma_f32_4x4x4_16b_bf16 v[140:143], v[26:27], v[206:207], v[140:143]
    v_mul_f32 v238, v174, v238
    v_and_b32_sdwa v127, s67, v126 dst_sel:DWORD dst_unused:UNUSED_PAD src0_sel:DWORD src1_sel:WORD_1
    v_mul_f32 v239, v175, v239
    v_and_b32 v126, s67, v126
    v_cvt_pk_bf16_f32 v174, v174, v238
    v_cvt_pk_bf16_f32 v175, v175, v239
    ds_read_u16_d16_hi v127, v127 offset:40960
    ds_read_u16_d16_hi v126, v126 offset:40960
    v_add_u32 v2, 256, v2
    v_add_u32 v3, 256, v3
    s_sub_u32 s54, s54, 1
    s_cmp_eq_u32 s54, 2
    s_cbranch_scc1 K2_BODYP0C
    s_branch K2_BODYF0C
K2_MIDL0C:
    buffer_load_dword v240, v6, s[28:31], 0 offen offset:0
    buffer_load_dword v241, v6, s[28:31], 0 offen offset:256
    buffer_load_dword v242, v6, s[28:31], 0 offen offset:512
    buffer_load_dword v243, v6, s[28:31], 0 offen offset:768
    buffer_load_dword v244, v6, s[28:31], 0 offen offset:2048
    buffer_load_dword v245, v6, s[28:31], 0 offen offset:2304
    s_waitcnt lgkmcnt(12)
    v_mfma_f32_32x32x16_bf16 v[64:79], v[96:99], v[112:115], v[64:79]
    v_mul_f32 v192, v128, v192
    v_mul_f32 v193, v129, v193
    v_cvt_pk_bf16_f32 v128, v128, v192
    v_cvt_pk_bf16_f32 v129, v129, v193
    v_mfma_f32_32x32x16_bf16 v[64:79], v[100:103], v[116:119], v[64:79]
    v_mul_f32 v194, v130, v194
    v_mul_f32 v195, v131, v195
    v_cvt_pk_bf16_f32 v130, v130, v194
    v_cvt_pk_bf16_f32 v131, v131, v195
    s_waitcnt lgkmcnt(8)
    v_mfma_f32_32x32x16_bf16 v[64:79], v[104:107], v[120:123], v[64:79]
    v_mul_f32 v196, v132, v196
    v_mul_f32 v197, v133, v197
    v_cvt_pk_bf16_f32 v132, v132, v196
    v_cvt_pk_bf16_f32 v133, v133, v197
    v_mfma_f32_32x32x16_bf16 v[64:79], v[108:111], v[124:127], v[64:79]
    v_mul_f32 v198, v134, v198
    v_mul_f32 v199, v135, v199
    v_cvt_pk_bf16_f32 v134, v134, v198
    v_cvt_pk_bf16_f32 v135, v135, v199
    s_waitcnt lgkmcnt(4)
    v_mul_f32 v200, v136, v200
    v_mul_f32 v201, v137, v201
    v_cvt_pk_bf16_f32 v136, v136, v200
    v_cvt_pk_bf16_f32 v137, v137, v201
    v_mul_f32 v202, v138, v202
    v_mul_f32 v203, v139, v203
    v_cvt_pk_bf16_f32 v138, v138, v202
    v_cvt_pk_bf16_f32 v139, v139, v203
    s_waitcnt lgkmcnt(0)
    v_mul_f32 v204, v140, v204
    v_mul_f32 v205, v141, v205
    v_cvt_pk_bf16_f32 v140, v140, v204
    v_cvt_pk_bf16_f32 v141, v141, v205
    v_mul_f32 v206, v142, v206
    v_mul_f32 v207, v143, v207
    v_cvt_pk_bf16_f32 v142, v142, v206
    v_cvt_pk_bf16_f32 v143, v143, v207
    s_nop 1
    v_mfma_f32_32x32x16_bf16 v[80:95], v[96:99], v[128:131], v[80:95]
    v_mfma_f32_32x32x16_bf16 v[80:95], v[100:103], v[132:135], v[80:95]
    v_mfma_f32_32x32x16_bf16 v[80:95], v[104:107], v[136:139], v[80:95]
    v_mfma_f32_32x32x16_bf16 v[80:95], v[108:111], v[140:143], v[80:95]
    s_branch K2_DONE
K2_LAST0C2:
    s_waitcnt lgkmcnt(12)
    v_mfma_f32_32x32x16_bf16 v[80:95], v[96:99], v[160:163], v[80:95]
    v_exp_f32 v128, v128
    v_mul_f32 v176, v112, v176
    v_exp_f32 v129, v129
    v_mul_f32 v177, v113, v177
    v_add_f32 v128, 1.0, v128
    v_cvt_pk_bf16_f32 v112, v112, v176
    v_add_f32 v129, 1.0, v129
    v_cvt_pk_bf16_f32 v113, v113, v177
    v_rcp_f32 v128, v128
    v_rcp_f32 v129, v129
    v_mfma_f32_32x32x16_bf16 v[80:95], v[100:103], v[164:167], v[80:95]
    v_cvt_pkrtz_f16_f32 v130, v130, v131
    v_mul_f32 v178, v114, v178
    v_and_b32_sdwa v131, s67, v130 dst_sel:DWORD dst_unused:UNUSED_PAD src0_sel:DWORD src1_sel:WORD_1
    v_mul_f32 v179, v115, v179
    v_and_b32 v130, s67, v130
    v_cvt_pk_bf16_f32 v114, v114, v178
    v_cvt_pk_bf16_f32 v115, v115, v179
    ds_read_u16_d16_hi v131, v131 offset:40960
    ds_read_u16_d16_hi v130, v130 offset:40960
    v_mfma_f32_32x32x16_bf16 v[80:95], v[104:107], v[168:171], v[80:95]
    v_mfma_f32_32x32x16_bf16 v[80:95], v[108:111], v[172:175], v[80:95]
    v_mfma_f32_32x32x16_bf16 v[96:111], v[32:35], v[28:31], 0
    s_nop 11
    s_waitcnt lgkmcnt(0)
    v_mfma_f32_32x32x16_bf16 v[64:79], v[96:99], v[112:115], v[64:79]
    v_mul_f32 v192, v128, v192
    v_mul_f32 v193, v129, v193
    v_cvt_pk_bf16_f32 v128, v128, v192
    v_cvt_pk_bf16_f32 v129, v129, v193
    v_mul_f32 v194, v130, v194
    v_mul_f32 v195, v131, v195
    v_cvt_pk_bf16_f32 v130, v130, v194
    v_cvt_pk_bf16_f32 v131, v131, v195
    s_nop 1
    v_mfma_f32_32x32x16_bf16 v[80:95], v[96:99], v[128:131], v[80:95]
    s_branch K2_DONE
K2_LAST0C4:
    s_waitcnt lgkmcnt(12)
    v_mfma_f32_32x32x16_bf16 v[80:95], v[96:99], v[160:163], v[80:95]
    v_exp_f32 v128, v128
    v_mul_f32 v176, v112, v176
    v_exp_f32 v129, v129
    v_mul_f32 v177, v113, v177
    v_add_f32 v128, 1.0, v128
    v_cvt_pk_bf16_f32 v112, v112, v176
    v_add_f32 v129, 1.0, v129
    v_cvt_pk_bf16_f32 v113, v113, v177
    v_rcp_f32 v128, v128
    v_rcp_f32 v129, v129
    v_mfma_f32_32x32x16_bf16 v[80:95], v[100:103], v[164:167], v[80:95]
    v_cvt_pkrtz_f16_f32 v130, v130, v131
    v_mul_f32 v178, v114, v178
    v_and_b32_sdwa v131, s67, v130 dst_sel:DWORD dst_unused:UNUSED_PAD src0_sel:DWORD src1_sel:WORD_1
    v_mul_f32 v179, v115, v179
    v_and_b32 v130, s67, v130
    v_cvt_pk_bf16_f32 v114, v114, v178
    v_cvt_pk_bf16_f32 v115, v115, v179
    ds_read_u16_d16_hi v131, v131 offset:40960
    ds_read_u16_d16_hi v130, v130 offset:40960
    s_waitcnt lgkmcnt(10)
    v_mfma_f32_32x32x16_bf16 v[80:95], v[104:107], v[168:171], v[80:95]
    v_cvt_pkrtz_f16_f32 v132, v132, v133
    v_mul_f32 v180, v116, v180
    v_and_b32_sdwa v133, s67, v132 dst_sel:DWORD dst_unused:UNUSED_PAD src0_sel:DWORD src1_sel:WORD_1
    v_mul_f32 v181, v117, v181
    v_and_b32 v132, s67, v132
    v_cvt_pk_bf16_f32 v116, v116, v180
    v_cvt_pk_bf16_f32 v117, v117, v181
    ds_read_u16_d16_hi v133, v133 offset:40960
    ds_read_u16_d16_hi v132, v132 offset:40960
    v_mfma_f32_32x32x16_bf16 v[80:95], v[108:111], v[172:175], v[80:95]
    v_cvt_pkrtz_f16_f32 v134, v134, v135
    v_mul_f32 v182, v118, v182
    v_and_b32_sdwa v135, s67, v134 dst_sel:DWORD dst_unused:UNUSED_PAD src0_sel:DWORD src1_sel:WORD_1
    v_mul_f32 v183, v119, v183
    v_and_b32 v134, s67, v134
    v_cvt_pk_bf16_f32 v118, v118, v182
    v_cvt_pk_bf16_f32 v119, v119, v183
    ds_read_u16_d16_hi v135, v135 offset:40960
    ds_read_u16_d16_hi v134, v134 offset:40960
    v_mfma_f32_32x32x16_bf16 v[96:111], v[32:35], v[28:31], 0
    s_nop 11
    s_waitcnt lgkmcnt(4)
    v_mfma_f32_32x32x16_bf16 v[64:79], v[96:99], v[112:115], v[64:79]
    v_mul_f32 v192, v128, v192
    v_mul_f32 v193, v129, v193
    v_cvt_pk_bf16_f32 v128, v128, v192
    v_cvt_pk_bf16_f32 v129, v129, v193
    v_mfma_f32_32x32x16_bf16 v[64:79], v[100:103], v[116:119], v[64:79]
    v_mul_f32 v194, v130, v194
    v_mul_f32 v195, v131, v195
    v_cvt_pk_bf16_f32 v130, v130, v194
    v_cvt_pk_bf16_f32 v131, v131, v195
    s_waitcnt lgkmcnt(0)
    v_mul_f32 v196, v132, v196
    v_mul_f32 v197, v133, v197
    v_cvt_pk_bf16_f32 v132, v132, v196
    v_cvt_pk_bf16_f32 v133, v133, v197
    v_mul_f32 v198, v134, v198
    v_mul_f32 v199, v135, v199
    v_cvt_pk_bf16_f32 v134, v134, v198
    v_cvt_pk_bf16_f32 v135, v135, v199
    s_nop 1
    v_mfma_f32_32x32x16_bf16 v[80:95], v[96:99], v[128:131], v[80:95]
    v_mfma_f32_32x32x16_bf16 v[80:95], v[100:103], v[132:135], v[80:95]
    s_branch K2_DONE
K2_LAST0C6:
    s_waitcnt lgkmcnt(12)
    v_mfma_f32_32x32x16_bf16 v[80:95], v[96:99], v[160:163], v[80:95]
    v_exp_f32 v128, v128
    v_mul_f32 v176, v112, v176
    v_exp_f32 v129, v129
    v_mul_f32 v177, v113, v177
    v_add_f32 v128, 1.0, v128
    v_cvt_pk_bf16_f32 v112, v112, v176
    v_add_f32 v129, 1.0, v129
    v_cvt_pk_bf16_f32 v113, v113, v177
    v_rcp_f32 v128, v128
    v_rcp_f32 v129, v129
    v_mfma_f32_32x32x16_bf16 v[80:95], v[100:103], v[164:167], v[80:95]
    v_cvt_pkrtz_f16_f32 v130, v130, v131
    v_mul_f32 v178, v114, v178
    v_and_b32_sdwa v131, s67, v130 dst_sel:DWORD dst_unused:UNUSED_PAD src0_sel:DWORD src1_sel:WORD_1
    v_mul_f32 v179, v115, v179
    v_and_b32 v130, s67, v130
    v_cvt_pk_bf16_f32 v114, v114, v178
    v_cvt_pk_bf16_f32 v115, v115, v179
    ds_read_u16_d16_hi v131, v131 offset:40960
    ds_read_u16_d16_hi v130, v130 offset:40960
    s_waitcnt lgkmcnt(10)
    v_mfma_f32_32x32x16_bf16 v[80:95], v[104:107], v[168:171], v[80:95]
    v_cvt_pkrtz_f16_f32 v132, v132, v133
    v_mul_f32 v180, v116, v180
    v_and_b32_sdwa v133, s67, v132 dst_sel:DWORD dst_unused:UNUSED_PAD src0_sel:DWORD src1_sel:WORD_1
    v_mul_f32 v181, v117, v181
    v_and_b32 v132, s67, v132
    v_cvt_pk_bf16_f32 v116, v116, v180
    v_cvt_pk_bf16_f32 v117, v117, v181
    ds_read_u16_d16_hi v133, v133 offset:40960
    ds_read_u16_d16_hi v132, v132 offset:40960
    v_mfma_f32_32x32x16_bf16 v[80:95], v[108:111], v[172:175], v[80:95]
    v_cvt_pkrtz_f16_f32 v134, v134, v135
    v_mul_f32 v182, v118, v182
    v_and_b32_sdwa v135, s67, v134 dst_sel:DWORD dst_unused:UNUSED_PAD src0_sel:DWORD src1_sel:WORD_1
    v_mul_f32 v183, v119, v183
    v_and_b32 v134, s67, v134
    v_cvt_pk_bf16_f32 v118, v118, v182
    v_cvt_pk_bf16_f32 v119, v119, v183
    ds_read_u16_d16_hi v135, v135 offset:40960
    ds_read_u16_d16_hi v134, v134 offset:40960
    s_waitcnt lgkmcnt(10)
    v_mfma_f32_32x32x16_bf16 v[96:111], v[32:35], v[28:31], 0
    v_cvt_pkrtz_f16_f32 v136, v136, v137
    v_mul_f32 v184, v120, v184
    v_and_b32_sdwa v137, s67, v136 dst_sel:DWORD dst_unused:UNUSED_PAD src0_sel:DWORD src1_sel:WORD_1
    v_mul_f32 v185, v121, v185
    v_and_b32 v136, s67, v136
    v_cvt_pk_bf16_f32 v120, v120, v184
    v_cvt_pk_bf16_f32 v121, v121, v185
    ds_read_u16_d16_hi v137, v137 offset:40960
    ds_read_u16_d16_hi v136, v136 offset:40960
    v_cvt_pkrtz_f16_f32 v138, v138, v139
    v_mul_f32 v186, v122, v186
    v_and_b32_sdwa v139, s67, v138 dst_sel:DWORD dst_unused:UNUSED_PAD src0_sel:DWORD src1_sel:WORD_1
    v_mul_f32 v187, v123, v187
    v_and_b32 v138, s67, v138
    v_cvt_pk_bf16_f32 v122, v122, v186
    v_cvt_pk_bf16_f32 v123, v123, v187
    ds_read_u16_d16_hi v139, v139 offset:40960
    ds_read_u16_d16_hi v138, v138 offset:40960
    s_waitcnt lgkmcnt(8)
    v_mfma_f32_32x32x16_bf16 v[64:79], v[96:99], v[112:115], v[64:79]
    v_mul_f32 v192, v128, v192
    v_mul_f32 v193, v129, v193
    v_cvt_pk_bf16_f32 v128, v128, v192
    v_cvt_pk_bf16_f32 v129, v129, v193
    v_mfma_f32_32x32x16_bf16 v[64:79], v[100:103], v[116:119], v[64:79]
    v_mul_f32 v194, v130, v194
    v_mul_f32 v195, v131, v195
    v_cvt_pk_bf16_f32 v130, v130, v194
    v_cvt_pk_bf16_f32 v131, v131, v195
    s_waitcnt lgkmcnt(4)
    v_mfma_f32_32x32x16_bf16 v[64:79], v[104:107], v[120:123], v[64:79]
    v_mul_f32 v196, v132, v196
    v_mul_f32 v197, v133, v197
    v_cvt_pk_bf16_f32 v132, v132, v196
    v_cvt_pk_bf16_f32 v133, v133, v197
    v_mul_f32 v198, v134, v198
    v_mul_f32 v199, v135, v199
    v_cvt_pk_bf16_f32 v134, v134, v198
    v_cvt_pk_bf16_f32 v135, v135, v199
    s_waitcnt lgkmcnt(0)
    v_mul_f32 v200, v136, v200
    v_mul_f32 v201, v137, v201
    v_cvt_pk_bf16_f32 v136, v136, v200
    v_cvt_pk_bf16_f32 v137, v137, v201
    v_mul_f32 v202, v138, v202
    v_mul_f32 v203, v139, v203
    v_cvt_pk_bf16_f32 v138, v138, v202
    v_cvt_pk_bf16_f32 v139, v139, v203
    s_nop 1
    v_mfma_f32_32x32x16_bf16 v[80:95], v[96:99], v[128:131], v[80:95]
    v_mfma_f32_32x32x16_bf16 v[80:95], v[100:103], v[132:135], v[80:95]
    v_mfma_f32_32x32x16_bf16 v[80:95], v[104:107], v[136:139], v[80:95]
    s_branch K2_DONE
K2_LAST1C2:
    s_waitcnt lgkmcnt(12)
    v_mfma_f32_32x32x16_bf16 v[80:95], v[96:99], v[128:131], v[80:95]
    v_exp_f32 v160, v160
    v_mul_f32 v208, v144, v208
    v_exp_f32 v161, v161
    v_mul_f32 v209, v145, v209
    v_add_f32 v160, 1.0, v160
    v_cvt_pk_bf16_f32 v144, v144, v208
    v_add_f32 v161, 1.0, v161
    v_cvt_pk_bf16_f32 v145, v145, v209
    v_rcp_f32 v160, v160
    v_rcp_f32 v161, v161
    v_mfma_f32_32x32x16_bf16 v[80:95], v[100:103], v[132:135], v[80:95]
    v_cvt_pkrtz_f16_f32 v162, v162, v163
    v_mul_f32 v210, v146, v210
    v_and_b32_sdwa v163, s67, v162 dst_sel:DWORD dst_unused:UNUSED_PAD src0_sel:DWORD src1_sel:WORD_1
    v_mul_f32 v211, v147, v211
    v_and_b32 v162, s67, v162
    v_cvt_pk_bf16_f32 v146, v146, v210
    v_cvt_pk_bf16_f32 v147, v147, v211
    ds_read_u16_d16_hi v163, v163 offset:40960
    ds_read_u16_d16_hi v162, v162 offset:40960
    v_mfma_f32_32x32x16_bf16 v[80:95], v[104:107], v[136:139], v[80:95]
    v_mfma_f32_32x32x16_bf16 v[80:95], v[108:111], v[140:143], v[80:95]
    v_mfma_f32_32x32x16_bf16 v[96:111], v[36:39], v[28:31], 0
    s_nop 11
    s_waitcnt lgkmcnt(0)
    v_mfma_f32_32x32x16_bf16 v[64:79], v[96:99], v[144:147], v[64:79]
    v_mul_f32 v224, v160, v224
    v_mul_f32 v225, v161, v225
    v_cvt_pk_bf16_f32 v160, v160, v224
    v_cvt_pk_bf16_f32 v161, v161, v225
    v_mul_f32 v226, v162, v226
    v_mul_f32 v227, v163, v227
    v_cvt_pk_bf16_f32 v162, v162, v226
    v_cvt_pk_bf16_f32 v163, v163, v227
    s_nop 1
    v_mfma_f32_32x32x16_bf16 v[80:95], v[96:99], v[160:163], v[80:95]
    s_branch K2_DONE
K2_LAST1C4:
    s_waitcnt lgkmcnt(12)
    v_mfma_f32_32x32x16_bf16 v[80:95], v[96:99], v[128:131], v[80:95]
    v_exp_f32 v160, v160
    v_mul_f32 v208, v144, v208
    v_exp_f32 v161, v161
    v_mul_f32 v209, v145, v209
    v_add_f32 v160, 1.0, v160
    v_cvt_pk_bf16_f32 v144, v144, v208
    v_add_f32 v161, 1.0, v161
    v_cvt_pk_bf16_f32 v145, v145, v209
    v_rcp_f32 v160, v160
    v_rcp_f32 v161, v161
    v_mfma_f32_32x32x16_bf16 v[80:95], v[100:103], v[132:135], v[80:95]
    v_cvt_pkrtz_f16_f32 v162, v162, v163
    v_mul_f32 v210, v146, v210
    v_and_b32_sdwa v163, s67, v162 dst_sel:DWORD dst_unused:UNUSED_PAD src0_sel:DWORD src1_sel:WORD_1
    v_mul_f32 v211, v147, v211
    v_and_b32 v162, s67, v162
    v_cvt_pk_bf16_f32 v146, v146, v210
    v_cvt_pk_bf16_f32 v147, v147, v211
    ds_read_u16_d16_hi v163, v163 offset:40960
    ds_read_u16_d16_hi v162, v162 offset:40960
    s_waitcnt lgkmcnt(10)
    v_mfma_f32_32x32x16_bf16 v[80:95], v[104:107], v[136:139], v[80:95]
    v_cvt_pkrtz_f16_f32 v164, v164, v165
    v_mul_f32 v212, v148, v212
    v_and_b32_sdwa v165, s67, v164 dst_sel:DWORD dst_unused:UNUSED_PAD src0_sel:DWORD src1_sel:WORD_1
    v_mul_f32 v213, v149, v213
    v_and_b32 v164, s67, v164
    v_cvt_pk_bf16_f32 v148, v148, v212
    v_cvt_pk_bf16_f32 v149, v149, v213
    ds_read_u16_d16_hi v165, v165 offset:40960
    ds_read_u16_d16_hi v164, v164 offset:40960
    v_mfma_f32_32x32x16_bf16 v[80:95], v[108:111], v[140:143], v[80:95]
    v_cvt_pkrtz_f16_f32 v166, v166, v167
    v_mul_f32 v214, v150, v214
    v_and_b32_sdwa v167, s67, v166 dst_sel:DWORD dst_unused:UNUSED_PAD src0_sel:DWORD src1_sel:WORD_1
    v_mul_f32 v215, v151, v215
    v_and_b32 v166, s67, v166
    v_cvt_pk_bf16_f32 v150, v150, v214
    v_cvt_pk_bf16_f32 v151, v151, v215
    ds_read_u16_d16_hi v167, v167 offset:40960
    ds_read_u16_d16_hi v166, v166 offset:40960
    v_mfma_f32_32x32x16_bf16 v[96:111], v[36:39], v[28:31], 0
    s_nop 11
    s_waitcnt lgkmcnt(4)
    v_mfma_f32_32x32x16_bf16 v[64:79], v[96:99], v[144:147], v[64:79]
    v_mul_f32 v224, v160, v224
    v_mul_f32 v225, v161, v225
    v_cvt_pk_bf16_f32 v160, v160, v224
    v_cvt_pk_bf16_f32 v161, v161, v225
    v_mfma_f32_32x32x16_bf16 v[64:79], v[100:103], v[148:151], v[64:79]
    v_mul_f32 v226, v162, v226
    v_mul_f32 v227, v163, v227
    v_cvt_pk_bf16_f32 v162, v162, v226
    v_cvt_pk_bf16_f32 v163, v163, v227
    s_waitcnt lgkmcnt(0)
    v_mul_f32 v228, v164, v228
    v_mul_f32 v229, v165, v229
    v_cvt_pk_bf16_f32 v164, v164, v228
    v_cvt_pk_bf16_f32 v165, v165, v229
    v_mul_f32 v230, v166, v230
    v_mul_f32 v231, v167, v231
    v_cvt_pk_bf16_f32 v166, v166, v230
    v_cvt_pk_bf16_f32 v167, v167, v231
    s_nop 1
    v_mfma_f32_32x32x16_bf16 v[80:95], v[96:99], v[160:163], v[80:95]
    v_mfma_f32_32x32x16_bf16 v[80:95], v[100:103], v[164:167], v[80:95]
    s_branch K2_DONE
K2_LAST1C6:
    s_waitcnt lgkmcnt(12)
    v_mfma_f32_32x32x16_bf16 v[80:95], v[96:99], v[128:131], v[80:95]
    v_exp_f32 v160, v160
    v_mul_f32 v208, v144, v208
    v_exp_f32 v161, v161
    v_mul_f32 v209, v145, v209
    v_add_f32 v160, 1.0, v160
    v_cvt_pk_bf16_f32 v144, v144, v208
    v_add_f32 v161, 1.0, v161
    v_cvt_pk_bf16_f32 v145, v145, v209
    v_rcp_f32 v160, v160
    v_rcp_f32 v161, v161
    v_mfma_f32_32x32x16_bf16 v[80:95], v[100:103], v[132:135], v[80:95]
    v_cvt_pkrtz_f16_f32 v162, v162, v163
    v_mul_f32 v210, v146, v210
    v_and_b32_sdwa v163, s67, v162 dst_sel:DWORD dst_unused:UNUSED_PAD src0_sel:DWORD src1_sel:WORD_1
    v_mul_f32 v211, v147, v211
    v_and_b32 v162, s67, v162
    v_cvt_pk_bf16_f32 v146, v146, v210
    v_cvt_pk_bf16_f32 v147, v147, v211
    ds_read_u16_d16_hi v163, v163 offset:40960
    ds_read_u16_d16_hi v162, v162 offset:40960
    s_waitcnt lgkmcnt(10)
    v_mfma_f32_32x32x16_bf16 v[80:95], v[104:107], v[136:139], v[80:95]
    v_cvt_pkrtz_f16_f32 v164, v164, v165
    v_mul_f32 v212, v148, v212
    v_and_b32_sdwa v165, s67, v164 dst_sel:DWORD dst_unused:UNUSED_PAD src0_sel:DWORD src1_sel:WORD_1
    v_mul_f32 v213, v149, v213
    v_and_b32 v164, s67, v164
    v_cvt_pk_bf16_f32 v148, v148, v212
    v_cvt_pk_bf16_f32 v149, v149, v213
    ds_read_u16_d16_hi v165, v165 offset:40960
    ds_read_u16_d16_hi v164, v164 offset:40960
    v_mfma_f32_32x32x16_bf16 v[80:95], v[108:111], v[140:143], v[80:95]
    v_cvt_pkrtz_f16_f32 v166, v166, v167
    v_mul_f32 v214, v150, v214
    v_and_b32_sdwa v167, s67, v166 dst_sel:DWORD dst_unused:UNUSED_PAD src0_sel:DWORD src1_sel:WORD_1
    v_mul_f32 v215, v151, v215
    v_and_b32 v166, s67, v166
    v_cvt_pk_bf16_f32 v150, v150, v214
    v_cvt_pk_bf16_f32 v151, v151, v215
    ds_read_u16_d16_hi v167, v167 offset:40960
    ds_read_u16_d16_hi v166, v166 offset:40960
    s_waitcnt lgkmcnt(10)
    v_mfma_f32_32x32x16_bf16 v[96:111], v[36:39], v[28:31], 0
    v_cvt_pkrtz_f16_f32 v168, v168, v169
    v_mul_f32 v216, v152, v216
    v_and_b32_sdwa v169, s67, v168 dst_sel:DWORD dst_unused:UNUSED_PAD src0_sel:DWORD src1_sel:WORD_1
    v_mul_f32 v217, v153, v217
    v_and_b32 v168, s67, v168
    v_cvt_pk_bf16_f32 v152, v152, v216
    v_cvt_pk_bf16_f32 v153, v153, v217
    ds_read_u16_d16_hi v169, v169 offset:40960
    ds_read_u16_d16_hi v168, v168 offset:40960
    v_cvt_pkrtz_f16_f32 v170, v170, v171
    v_mul_f32 v218, v154, v218
    v_and_b32_sdwa v171, s67, v170 dst_sel:DWORD dst_unused:UNUSED_PAD src0_sel:DWORD src1_sel:WORD_1
    v_mul_f32 v219, v155, v219
    v_and_b32 v170, s67, v170
    v_cvt_pk_bf16_f32 v154, v154, v218
    v_cvt_pk_bf16_f32 v155, v155, v219
    ds_read_u16_d16_hi v171, v171 offset:40960
    ds_read_u16_d16_hi v170, v170 offset:40960
    s_waitcnt lgkmcnt(8)
    v_mfma_f32_32x32x16_bf16 v[64:79], v[96:99], v[144:147], v[64:79]
    v_mul_f32 v224, v160, v224
    v_mul_f32 v225, v161, v225
    v_cvt_pk_bf16_f32 v160, v160, v224
    v_cvt_pk_bf16_f32 v161, v161, v225
    v_mfma_f32_32x32x16_bf16 v[64:79], v[100:103], v[148:151], v[64:79]
    v_mul_f32 v226, v162, v226
    v_mul_f32 v227, v163, v227
    v_cvt_pk_bf16_f32 v162, v162, v226
    v_cvt_pk_bf16_f32 v163, v163, v227
    s_waitcnt lgkmcnt(4)
    v_mfma_f32_32x32x16_bf16 v[64:79], v[104:107], v[152:155], v[64:79]
    v_mul_f32 v228, v164, v228
    v_mul_f32 v229, v165, v229
    v_cvt_pk_bf16_f32 v164, v164, v228
    v_cvt_pk_bf16_f32 v165, v165, v229
    v_mul_f32 v230, v166, v230
    v_mul_f32 v231, v167, v231
    v_cvt_pk_bf16_f32 v166, v166, v230
    v_cvt_pk_bf16_f32 v167, v167, v231
    s_waitcnt lgkmcnt(0)
    v_mul_f32 v232, v168, v232
    v_mul_f32 v233, v169, v233
    v_cvt_pk_bf16_f32 v168, v168, v232
    v_cvt_pk_bf16_f32 v169, v169, v233
    v_mul_f32 v234, v170, v234
    v_mul_f32 v235, v171, v235
    v_cvt_pk_bf16_f32 v170, v170, v234
    v_cvt_pk_bf16_f32 v171, v171, v235
    s_nop 1
    v_mfma_f32_32x32x16_bf16 v[80:95], v[96:99], v[160:163], v[80:95]
    v_mfma_f32_32x32x16_bf16 v[80:95], v[100:103], v[164:167], v[80:95]
    v_mfma_f32_32x32x16_bf16 v[80:95], v[104:107], v[168:171], v[80:95]
    s_branch K2_DONE
K2_BODYP0C:
    s_waitcnt lgkmcnt(13)
    v_mfma_f32_32x32x16_bf16 v[80:95], v[96:99], v[160:163], v[80:95]
    v_exp_f32 v128, v128
    v_mul_f32 v176, v112, v176
    v_exp_f32 v129, v129
    v_mul_f32 v177, v113, v177
    v_add_f32 v128, 1.0, v128
    v_cvt_pk_bf16_f32 v112, v112, v176
    v_mfma_f32_32x32x16_bf16 v[80:95], v[100:103], v[164:167], v[80:95]
    v_add_f32 v129, 1.0, v129
    v_cvt_pk_bf16_f32 v113, v113, v177
    v_rcp_f32 v128, v128
    v_rcp_f32 v129, v129
    buffer_load_dword v224, v48, s[36:39], 0 offen offset:128
    buffer_load_dword v225, v49, s[36:39], 0 offen offset:128
    buffer_load_dword v226, v50, s[36:39], 0 offen offset:128
    buffer_load_dword v227, v51, s[36:39], 0 offen offset:128
    v_mfma_f32_32x32x16_bf16 v[80:95], v[104:107], v[168:171], v[80:95]
    v_cvt_pkrtz_f16_f32 v130, v130, v131
    v_mul_f32 v178, v114, v178
    v_and_b32_sdwa v131, s67, v130 dst_sel:DWORD dst_unused:UNUSED_PAD src0_sel:DWORD src1_sel:WORD_1
    v_mul_f32 v179, v115, v179
    v_and_b32 v130, s67, v130
    v_cvt_pk_bf16_f32 v114, v114, v178
    v_cvt_pk_bf16_f32 v115, v115, v179
    ds_read_u16_d16_hi v131, v131 offset:40960
    ds_read_u16_d16_hi v130, v130 offset:40960
    buffer_load_dword v228, v52, s[36:39], 0 offen offset:128
    buffer_load_dword v229, v53, s[36:39], 0 offen offset:128
    buffer_load_dword v230, v54, s[36:39], 0 offen offset:128
    buffer_load_dword v231, v55, s[36:39], 0 offen offset:128
    s_waitcnt lgkmcnt(4)
    v_mfma_f32_32x32x16_bf16 v[144:159], v[44:47], v[8:11], 0
    v_cvt_pkrtz_f16_f32 v132, v132, v133
    v_mul_f32 v180, v116, v180
    v_and_b32_sdwa v133, s67, v132 dst_sel:DWORD dst_unused:UNUSED_PAD src0_sel:DWORD src1_sel:WORD_1
    v_mul_f32 v181, v117, v181
    v_and_b32 v132, s67, v132
    v_cvt_pk_bf16_f32 v116, v116, v180
    v_cvt_pk_bf16_f32 v117, v117, v181
    ds_read_u16_d16_hi v133, v133 offset:40960
    ds_read_u16_d16_hi v132, v132 offset:40960
    buffer_load_dword v232, v56, s[36:39], 0 offen offset:128
    buffer_load_dword v233, v57, s[36:39], 0 offen offset:128
    buffer_load_dword v234, v58, s[36:39], 0 offen offset:128
    buffer_load_dword v235, v59, s[36:39], 0 offen offset:128
    v_mfma_f32_32x32x16_bf16 v[144:159], v[36:39], v[16:19], v[144:159]
    v_cvt_pkrtz_f16_f32 v134, v134, v135
    v_mul_f32 v182, v118, v182
    v_and_b32_sdwa v135, s67, v134 dst_sel:DWORD dst_unused:UNUSED_PAD src0_sel:DWORD src1_sel:WORD_1
    v_mul_f32 v183, v119, v183
    v_and_b32 v134, s67, v134
    v_cvt_pk_bf16_f32 v118, v118, v182
    v_cvt_pk_bf16_f32 v119, v119, v183
    ds_read_u16_d16_hi v135, v135 offset:40960
    ds_read_u16_d16_hi v134, v134 offset:40960
    buffer_load_dword v236, v60, s[36:39], 0 offen offset:128
    buffer_load_dword v237, v61, s[36:39], 0 offen offset:128
    buffer_load_dword v238, v62, s[36:39], 0 offen offset:128
    buffer_load_dword v239, v63, s[36:39], 0 offen offset:128
    s_waitcnt lgkmcnt(11)
    v_mfma_f32_32x32x16_bf16 v[80:95], v[108:111], v[172:175], v[80:95]
    v_cvt_pkrtz_f16_f32 v136, v136, v137
    v_mul_f32 v184, v120, v184
    v_and_b32_sdwa v137, s67, v136 dst_sel:DWORD dst_unused:UNUSED_PAD src0_sel:DWORD src1_sel:WORD_1
    v_mul_f32 v185, v121, v185
    v_and_b32 v136, s67, v136
    v_cvt_pk_bf16_f32 v120, v120, v184
    v_cvt_pk_bf16_f32 v121, v121, v185
    ds_read_u16_d16_hi v137, v137 offset:40960
    ds_read_u16_d16_hi v136, v136 offset:40960
    buffer_load_dword v240, v6, s[28:31], 0 offen offset:0
    buffer_load_dword v241, v6, s[28:31], 0 offen offset:256
    buffer_load_dword v242, v6, s[28:31], 0 offen offset:512
    buffer_load_dword v243, v6, s[28:31], 0 offen offset:768
    buffer_load_dword v244, v6, s[28:31], 0 offen offset:2048
    buffer_load_dword v245, v6, s[28:31], 0 offen offset:2304
    v_mfma_f32_32x32x16_bf16 v[96:111], v[32:35], v[28:31], 0
    v_cvt_pkrtz_f16_f32 v138, v138, v139
    v_mul_f32 v186, v122, v186
    v_and_b32_sdwa v139, s67, v138 dst_sel:DWORD dst_unused:UNUSED_PAD src0_sel:DWORD src1_sel:WORD_1
    v_mul_f32 v187, v123, v187
    s_waitcnt vmcnt(22)
    v_mfma_f32_4x4x4_16b_bf16 v[144:147], v[24:25], v[208:209], v[144:147]
    v_and_b32 v138, s67, v138
    v_mfma_f32_4x4x4_16b_bf16 v[148:151], v[24:25], v[212:213], v[148:151]
    v_cvt_pk_bf16_f32 v122, v122, v186
    v_cvt_pk_bf16_f32 v123, v123, v187
    ds_read_u16_d16_hi v139, v139 offset:40960
    ds_read_u16_d16_hi v138, v138 offset:40960
    s_waitcnt lgkmcnt(10)
    v_mfma_f32_4x4x4_16b_bf16 v[152:155], v[24:25], v[216:217], v[152:155]
    v_cvt_pkrtz_f16_f32 v140, v140, v141
    v_mfma_f32_4x4x4_16b_bf16 v[156:159], v[24:25], v[220:221], v[156:159]
    v_mul_f32 v188, v124, v188
    v_mfma_f32_4x4x4_16b_bf16 v[144:147], v[26:27], v[210:211], v[144:147]
    v_and_b32_sdwa v141, s67, v140 dst_sel:DWORD dst_unused:UNUSED_PAD src0_sel:DWORD src1_sel:WORD_1
    v_mfma_f32_4x4x4_16b_bf16 v[148:151], v[26:27], v[214:215], v[148:151]
    v_mul_f32 v189, v125, v189
    v_and_b32 v140, s67, v140
    v_cvt_pk_bf16_f32 v124, v124, v188
    v_cvt_pk_bf16_f32 v125, v125, v189
    ds_read_u16_d16_hi v141, v141 offset:40960
    ds_read_u16_d16_hi v140, v140 offset:40960
    v_mfma_f32_4x4x4_16b_bf16 v[152:155], v[26:27], v[218:219], v[152:155]
    v_cvt_pkrtz_f16_f32 v142, v142, v143
    v_mfma_f32_4x4x4_16b_bf16 v[156:159], v[26:27], v[222:223], v[156:159]
    v_mul_f32 v190, v126, v190
    v_and_b32_sdwa v143, s67, v142 dst_sel:DWORD dst_unused:UNUSED_PAD src0_sel:DWORD src1_sel:WORD_1
    v_mul_f32 v191, v127, v191
    v_and_b32 v142, s67, v142
    v_cvt_pk_bf16_f32 v126, v126, v190
    v_cvt_pk_bf16_f32 v127, v127, v191
    ds_read_u16_d16_hi v143, v143 offset:40960
    ds_read_u16_d16_hi v142, v142 offset:40960
K2_MIDP0C:
    s_waitcnt lgkmcnt(12)
    v_mfma_f32_32x32x16_bf16 v[64:79], v[96:99], v[112:115], v[64:79]
    v_exp_f32 v144, v144
    v_mul_f32 v192, v128, v192
    v_exp_f32 v145, v145
    v_mul_f32 v193, v129, v193
    v_add_f32 v144, 1.0, v144
    v_cvt_pk_bf16_f32 v128, v128, v192
    v_add_f32 v145, 1.0, v145
    v_cvt_pk_bf16_f32 v129, v129, v193
    v_rcp_f32 v144, v144
    v_rcp_f32 v145, v145
    v_mfma_f32_32x32x16_bf16 v[64:79], v[100:103], v[116:119], v[64:79]
    v_cvt_pkrtz_f16_f32 v146, v146, v147
    v_mul_f32 v194, v130, v194
    v_and_b32_sdwa v147, s67, v146 dst_sel:DWORD dst_unused:UNUSED_PAD src0_sel:DWORD src1_sel:WORD_1
    v_mul_f32 v195, v131, v195
    v_and_b32 v146, s67, v146
    v_cvt_pk_bf16_f32 v130, v130, v194
    v_cvt_pk_bf16_f32 v131, v131, v195
    ds_read_u16_d16_hi v147, v147 offset:40960
    ds_read_u16_d16_hi v146, v146 offset:40960
    s_waitcnt lgkmcnt(10)
    v_mfma_f32_32x32x16_bf16 v[160:175], v[44:47], v[12:15], 0
    v_cvt_pkrtz_f16_f32 v148, v148, v149
    v_mul_f32 v196, v132, v196
    v_and_b32_sdwa v149, s67, v148 dst_sel:DWORD dst_unused:UNUSED_PAD src0_sel:DWORD src1_sel:WORD_1
    v_mul_f32 v197, v133, v197
    v_and_b32 v148, s67, v148
    v_cvt_pk_bf16_f32 v132, v132, v196
    v_cvt_pk_bf16_f32 v133, v133, v197
    ds_read_u16_d16_hi v149, v149 offset:40960
    ds_read_u16_d16_hi v148, v148 offset:40960
    v_mfma_f32_32x32x16_bf16 v[160:175], v[36:39], v[20:23], v[160:175]
    v_cvt_pkrtz_f16_f32 v150, v150, v151
    v_mul_f32 v198, v134, v198
    v_and_b32_sdwa v151, s67, v150 dst_sel:DWORD dst_unused:UNUSED_PAD src0_sel:DWORD src1_sel:WORD_1
    v_mul_f32 v199, v135, v199
    v_and_b32 v150, s67, v150
    v_cvt_pk_bf16_f32 v134, v134, v198
    v_cvt_pk_bf16_f32 v135, v135, v199
    ds_read_u16_d16_hi v151, v151 offset:40960
    ds_read_u16_d16_hi v150, v150 offset:40960
    s_waitcnt lgkmcnt(10)
    v_mfma_f32_32x32x16_bf16 v[64:79], v[104:107], v[120:123], v[64:79]
    v_cvt_pkrtz_f16_f32 v152, v152, v153
    v_mul_f32 v200, v136, v200
    v_and_b32_sdwa v153, s67, v152 dst_sel:DWORD dst_unused:UNUSED_PAD src0_sel:DWORD src1_sel:WORD_1
    v_mul_f32 v201, v137, v201
    v_and_b32 v152, s67, v152
    v_cvt_pk_bf16_f32 v136, v136, v200
    v_cvt_pk_bf16_f32 v137, v137, v201
    ds_read_u16_d16_hi v153, v153 offset:40960
    ds_read_u16_d16_hi v152, v152 offset:40960
    v_mfma_f32_32x32x16_bf16 v[64:79], v[108:111], v[124:127], v[64:79]
    v_cvt_pkrtz_f16_f32 v154, v154, v155
    v_mul_f32 v202, v138, v202
    v_and_b32_sdwa v155, s67, v154 dst_sel:DWORD dst_unused:UNUSED_PAD src0_sel:DWORD src1_sel:WORD_1
    v_mul_f32 v203, v139, v203
    s_waitcnt vmcnt(6)
    v_mfma_f32_4x4x4_16b_bf16 v[160:163], v[24:25], v[224:225], v[160:163]
    v_and_b32 v154, s67, v154
    v_mfma_f32_4x4x4_16b_bf16 v[164:167], v[24:25], v[228:229], v[164:167]
    v_cvt_pk_bf16_f32 v138, v138, v202
    v_cvt_pk_bf16_f32 v139, v139, v203
    ds_read_u16_d16_hi v155, v155 offset:40960
    ds_read_u16_d16_hi v154, v154 offset:40960
    s_waitcnt lgkmcnt(10)
    v_mfma_f32_4x4x4_16b_bf16 v[168:171], v[24:25], v[232:233], v[168:171]
    v_cvt_pkrtz_f16_f32 v156, v156, v157
    v_mfma_f32_4x4x4_16b_bf16 v[172:175], v[24:25], v[236:237], v[172:175]
    v_mul_f32 v204, v140, v204
    v_mfma_f32_4x4x4_16b_bf16 v[160:163], v[26:27], v[226:227], v[160:163]
    v_and_b32_sdwa v157, s67, v156 dst_sel:DWORD dst_unused:UNUSED_PAD src0_sel:DWORD src1_sel:WORD_1
    v_mfma_f32_4x4x4_16b_bf16 v[164:167], v[26:27], v[230:231], v[164:167]
    v_mul_f32 v205, v141, v205
    v_and_b32 v156, s67, v156
    v_cvt_pk_bf16_f32 v140, v140, v204
    v_cvt_pk_bf16_f32 v141, v141, v205
    ds_read_u16_d16_hi v157, v157 offset:40960
    ds_read_u16_d16_hi v156, v156 offset:40960
    v_mfma_f32_4x4x4_16b_bf16 v[168:171], v[26:27], v[234:235], v[168:171]
    v_cvt_pkrtz_f16_f32 v158, v158, v159
    v_mfma_f32_4x4x4_16b_bf16 v[172:175], v[26:27], v[238:239], v[172:175]
    v_mul_f32 v206, v142, v206
    v_and_b32_sdwa v159, s67, v158 dst_sel:DWORD dst_unused:UNUSED_PAD src0_sel:DWORD src1_sel:WORD_1
    v_mul_f32 v207, v143, v207
    v_and_b32 v158, s67, v158
    v_cvt_pk_bf16_f32 v142, v142, v206
    v_cvt_pk_bf16_f32 v143, v143, v207
    ds_read_u16_d16_hi v159, v159 offset:40960
    ds_read_u16_d16_hi v158, v158 offset:40960
    s_cmp_eq_u32 s20, 2
    s_cbranch_scc1 K2_LAST1C2
    s_cmp_eq_u32 s20, 4
    s_cbranch_scc1 K2_LAST1C4
    s_cmp_eq_u32 s20, 6
    s_cbranch_scc1 K2_LAST1C6
K2_LAST1C8:
    s_waitcnt lgkmcnt(12)
    v_mfma_f32_32x32x16_bf16 v[80:95], v[96:99], v[128:131], v[80:95]
    v_exp_f32 v160, v160
    v_mul_f32 v208, v144, v208
    v_exp_f32 v161, v161
    v_mul_f32 v209, v145, v209
    v_add_f32 v160, 1.0, v160
    v_cvt_pk_bf16_f32 v144, v144, v208
    v_add_f32 v161, 1.0, v161
    v_cvt_pk_bf16_f32 v145, v145, v209
    v_rcp_f32 v160, v160
    v_rcp_f32 v161, v161
    v_mfma_f32_32x32x16_bf16 v[80:95], v[100:103], v[132:135], v[80:95]
    v_cvt_pkrtz_f16_f32 v162, v162, v163
    v_mul_f32 v210, v146, v210
    v_and_b32_sdwa v163, s67, v162 dst_sel:DWORD dst_unused:UNUSED_PAD src0_sel:DWORD src1_sel:WORD_1
    v_mul_f32 v211, v147, v211
    v_and_b32 v162, s67, v162
    v_cvt_pk_bf16_f32 v146, v146, v210
    v_cvt_pk_bf16_f32 v147, v147, v211
    ds_read_u16_d16_hi v163, v163 offset:40960
    ds_read_u16_d16_hi v162, v162 offset:40960
    s_waitcnt lgkmcnt(10)
    v_mfma_f32_32x32x16_bf16 v[80:95], v[104:107], v[136:139], v[80:95]
    v_cvt_pkrtz_f16_f32 v164, v164, v165
    v_mul_f32 v212, v148, v212
    v_and_b32_sdwa v165, s67, v164 dst_sel:DWORD dst_unused:UNUSED_PAD src0_sel:DWORD src1_sel:WORD_1
    v_mul_f32 v213, v149, v213
    v_and_b32 v164, s67, v164
    v_cvt_pk_bf16_f32 v148, v148, v212
    v_cvt_pk_bf16_f32 v149, v149, v213
    ds_read_u16_d16_hi v165, v165 offset:40960
    ds_read_u16_d16_hi v164, v164 offset:40960
    v_mfma_f32_32x32x16_bf16 v[80:95], v[108:111], v[140:143], v[80:95]
    v_cvt_pkrtz_f16_f32 v166, v166, v167
    v_mul_f32 v214, v150, v214
    v_and_b32_sdwa v167, s67, v166 dst_sel:DWORD dst_unused:UNUSED_PAD src0_sel:DWORD src1_sel:WORD_1
    v_mul_f32 v215, v151, v215
    v_and_b32 v166, s67, v166
    v_cvt_pk_bf16_f32 v150, v150, v214
    v_cvt_pk_bf16_f32 v151, v151, v215
    ds_read_u16_d16_hi v167, v167 offset:40960
    ds_read_u16_d16_hi v166, v166 offset:40960
    s_waitcnt lgkmcnt(10)
    v_mfma_f32_32x32x16_bf16 v[96:111], v[36:39], v[28:31], 0
    v_cvt_pkrtz_f16_f32 v168, v168, v169
    v_mul_f32 v216, v152, v216
    v_and_b32_sdwa v169, s67, v168 dst_sel:DWORD dst_unused:UNUSED_PAD src0_sel:DWORD src1_sel:WORD_1
    v_mul_f32 v217, v153, v217
    v_and_b32 v168, s67, v168
    v_cvt_pk_bf16_f32 v152, v152, v216
    v_cvt_pk_bf16_f32 v153, v153, v217
    ds_read_u16_d16_hi v169, v169 offset:40960
    ds_read_u16_d16_hi v168, v168 offset:40960
    v_cvt_pkrtz_f16_f32 v170, v170, v171
    v_mul_f32 v218, v154, v218
    v_and_b32_sdwa v171, s67, v170 dst_sel:DWORD dst_unused:UNUSED_PAD src0_sel:DWORD src1_sel:WORD_1
    v_mul_f32 v219, v155, v219
    v_and_b32 v170, s67, v170
    v_cvt_pk_bf16_f32 v154, v154, v218
    v_cvt_pk_bf16_f32 v155, v155, v219
    ds_read_u16_d16_hi v171, v171 offset:40960
    ds_read_u16_d16_hi v170, v170 offset:40960
    s_waitcnt lgkmcnt(10)
    v_cvt_pkrtz_f16_f32 v172, v172, v173
    v_mul_f32 v220, v156, v220
    v_and_b32_sdwa v173, s67, v172 dst_sel:DWORD dst_unused:UNUSED_PAD src0_sel:DWORD src1_sel:WORD_1
    v_mul_f32 v221, v157, v221
    v_and_b32 v172, s67, v172
    v_cvt_pk_bf16_f32 v156, v156, v220
    v_cvt_pk_bf16_f32 v157, v157, v221
    ds_read_u16_d16_hi v173, v173 offset:40960
    ds_read_u16_d16_hi v172, v172 offset:40960
    v_cvt_pkrtz_f16_f32 v174, v174, v175
    v_mul_f32 v222, v158, v222
    v_and_b32_sdwa v175, s67, v174 dst_sel:DWORD dst_unused:UNUSED_PAD src0_sel:DWORD src1_sel:WORD_1
    v_mul_f32 v223, v159, v223
    v_and_b32 v174, s67, v174
    v_cvt_pk_bf16_f32 v158, v158, v222
    v_cvt_pk_bf16_f32 v159, v159, v223
    ds_read_u16_d16_hi v175, v175 offset:40960
    ds_read_u16_d16_hi v174, v174 offset:40960
    s_waitcnt lgkmcnt(12)
    v_mfma_f32_32x32x16_bf16 v[64:79], v[96:99], v[144:147], v[64:79]
    v_mul_f32 v224, v160, v224
    v_mul_f32 v225, v161, v225
    v_cvt_pk_bf16_f32 v160, v160, v224
    v_cvt_pk_bf16_f32 v161, v161, v225
    v_mfma_f32_32x32x16_bf16 v[64:79], v[100:103], v[148:151], v[64:79]
    v_mul_f32 v226, v162, v226
    v_mul_f32 v227, v163, v227
    v_cvt_pk_bf16_f32 v162, v162, v226
    v_cvt_pk_bf16_f32 v163, v163, v227
    s_waitcnt lgkmcnt(8)
    v_mfma_f32_32x32x16_bf16 v[64:79], v[104:107], v[152:155], v[64:79]
    v_mul_f32 v228, v164, v228
    v_mul_f32 v229, v165, v229
    v_cvt_pk_bf16_f32 v164, v164, v228
    v_cvt_pk_bf16_f32 v165, v165, v229
    v_mfma_f32_32x32x16_bf16 v[64:79], v[108:111], v[156:159], v[64:79]
    v_mul_f32 v230, v166, v230
    v_mul_f32 v231, v167, v231
    v_cvt_pk_bf16_f32 v166, v166, v230
    v_cvt_pk_bf16_f32 v167, v167, v231
    s_waitcnt lgkmcnt(4)
    v_mul_f32 v232, v168, v232
    v_mul_f32 v233, v169, v233
    v_cvt_pk_bf16_f32 v168, v168, v232
    v_cvt_pk_bf16_f32 v169, v169, v233
    v_mul_f32 v234, v170, v234
    v_mul_f32 v235, v171, v235
    v_cvt_pk_bf16_f32 v170, v170, v234
    v_cvt_pk_bf16_f32 v171, v171, v235
    s_waitcnt lgkmcnt(0)
    v_mul_f32 v236, v172, v236
    v_mul_f32 v237, v173, v237
    v_cvt_pk_bf16_f32 v172, v172, v236
    v_cvt_pk_bf16_f32 v173, v173, v237
    v_mul_f32 v238, v174, v238
    v_mul_f32 v239, v175, v239
    v_cvt_pk_bf16_f32 v174, v174, v238
    v_cvt_pk_bf16_f32 v175, v175, v239
    s_nop 1
    v_mfma_f32_32x32x16_bf16 v[80:95], v[96:99], v[160:163], v[80:95]
    v_mfma_f32_32x32x16_bf16 v[80:95], v[100:103], v[164:167], v[80:95]
    v_mfma_f32_32x32x16_bf16 v[80:95], v[104:107], v[168:171], v[80:95]
    v_mfma_f32_32x32x16_bf16 v[80:95], v[108:111], v[172:175], v[80:95]
    s_branch K2_DONE
K2_BODYP1C:
    s_waitcnt lgkmcnt(13)
    v_mfma_f32_32x32x16_bf16 v[80:95], v[96:99], v[128:131], v[80:95]
    v_exp_f32 v160, v160
    v_mul_f32 v208, v144, v208
    v_exp_f32 v161, v161
    v_mul_f32 v209, v145, v209
    v_add_f32 v160, 1.0, v160
    v_cvt_pk_bf16_f32 v144, v144, v208
    v_mfma_f32_32x32x16_bf16 v[80:95], v[100:103], v[132:135], v[80:95]
    v_add_f32 v161, 1.0, v161
    v_cvt_pk_bf16_f32 v145, v145, v209
    v_rcp_f32 v160, v160
    v_rcp_f32 v161, v161
    buffer_load_dword v192, v48, s[36:39], 0 offen offset:128
    buffer_load_dword v193, v49, s[36:39], 0 offen offset:128
    buffer_load_dword v194, v50, s[36:39], 0 offen offset:128
    buffer_load_dword v195, v51, s[36:39], 0 offen offset:128
    v_mfma_f32_32x32x16_bf16 v[80:95], v[104:107], v[136:139], v[80:95]
    v_cvt_pkrtz_f16_f32 v162, v162, v163
    v_mul_f32 v210, v146, v210
    v_and_b32_sdwa v163, s67, v162 dst_sel:DWORD dst_unused:UNUSED_PAD src0_sel:DWORD src1_sel:WORD_1
    v_mul_f32 v211, v147, v211
    v_and_b32 v162, s67, v162
    v_cvt_pk_bf16_f32 v146, v146, v210
    v_cvt_pk_bf16_f32 v147, v147, v211
    ds_read_u16_d16_hi v163, v163 offset:40960
    ds_read_u16_d16_hi v162, v162 offset:40960
    buffer_load_dword v196, v52, s[36:39], 0 offen offset:128
    buffer_load_dword v197, v53, s[36:39], 0 offen offset:128
    buffer_load_dword v198, v54, s[36:39], 0 offen offset:128
    buffer_load_dword v199, v55, s[36:39], 0 offen offset:128
    s_waitcnt lgkmcnt(4)
    v_mfma_f32_32x32x16_bf16 v[112:127], v[40:43], v[8:11], 0
    v_cvt_pkrtz_f16_f32 v164, v164, v165
    v_mul_f32 v212, v148, v212
    v_and_b32_sdwa v165, s67, v164 dst_sel:DWORD dst_unused:UNUSED_PAD src0_sel:DWORD src1_sel:WORD_1
    v_mul_f32 v213, v149, v213
    v_and_b32 v164, s67, v164
    v_cvt_pk_bf16_f32 v148, v148, v212
    v_cvt_pk_bf16_f32 v149, v149, v213
    ds_read_u16_d16_hi v165, v165 offset:40960
    ds_read_u16_d16_hi v164, v164 offset:40960
    buffer_load_dword v200, v56, s[36:39], 0 offen offset:128
    buffer_load_dword v201, v57, s[36:39], 0 offen offset:128
    buffer_load_dword v202, v58, s[36:39], 0 offen offset:128
    buffer_load_dword v203, v59, s[36:39], 0 offen offset:128
    v_mfma_f32_32x32x16_bf16 v[112:127], v[32:35], v[16:19], v[112:127]
    v_cvt_pkrtz_f16_f32 v166, v166, v167
    v_mul_f32 v214, v150, v214
    v_and_b32_sdwa v167, s67, v166 dst_sel:DWORD dst_unused:UNUSED_PAD src0_sel:DWORD src1_sel:WORD_1
    v_mul_f32 v215, v151, v215
    v_and_b32 v166, s67, v166
    v_cvt_pk_bf16_f32 v150, v150, v214
    v_cvt_pk_bf16_f32 v151, v151, v215
    ds_read_u16_d16_hi v167, v167 offset:40960
    ds_read_u16_d16_hi v166, v166 offset:40960
    buffer_load_dword v204, v60, s[36:39], 0 offen offset:128
    buffer_load_dword v205, v61, s[36:39], 0 offen offset:128
    buffer_load_dword v206, v62, s[36:39], 0 offen offset:128
    buffer_load_dword v207, v63, s[36:39], 0 offen offset:128
    s_waitcnt lgkmcnt(11)
    v_mfma_f32_32x32x16_bf16 v[80:95], v[108:111], v[140:143], v[80:95]
    v_cvt_pkrtz_f16_f32 v168, v168, v169
    v_mul_f32 v216, v152, v216
    v_and_b32_sdwa v169, s67, v168 dst_sel:DWORD dst_unused:UNUSED_PAD src0_sel:DWORD src1_sel:WORD_1
    v_mul_f32 v217, v153, v217
    v_and_b32 v168, s67, v168
    v_cvt_pk_bf16_f32 v152, v152, v216
    v_cvt_pk_bf16_f32 v153, v153, v217
    ds_read_u16_d16_hi v169, v169 offset:40960
    ds_read_u16_d16_hi v168, v168 offset:40960
    buffer_load_dword v240, v6, s[28:31], 0 offen offset:0
    buffer_load_dword v241, v6, s[28:31], 0 offen offset:256
    buffer_load_dword v242, v6, s[28:31], 0 offen offset:512
    buffer_load_dword v243, v6, s[28:31], 0 offen offset:768
    buffer_load_dword v244, v6, s[28:31], 0 offen offset:2048
    buffer_load_dword v245, v6, s[28:31], 0 offen offset:2304
    v_mfma_f32_32x32x16_bf16 v[96:111], v[36:39], v[28:31], 0
    v_cvt_pkrtz_f16_f32 v170, v170, v171
    v_mul_f32 v218, v154, v218
    v_and_b32_sdwa v171, s67, v170 dst_sel:DWORD dst_unused:UNUSED_PAD src0_sel:DWORD src1_sel:WORD_1
    v_mul_f32 v219, v155, v219
    s_waitcnt vmcnt(22)
    v_mfma_f32_4x4x4_16b_bf16 v[112:115], v[24:25], v[176:177], v[112:115]
    v_and_b32 v170, s67, v170
    v_mfma_f32_4x4x4_16b_bf16 v[116:119], v[24:25], v[180:181], v[116:119]
    v_cvt_pk_bf16_f32 v154, v154, v218
    v_cvt_pk_bf16_f32 v155, v155, v219
    ds_read_u16_d16_hi v171, v171 offset:40960
    ds_read_u16_d16_hi v170, v170 offset:40960
    s_waitcnt lgkmcnt(10)
    v_mfma_f32_4x4x4_16b_bf16 v[120:123], v[24:25], v[184:185], v[120:123]
    v_cvt_pkrtz_f16_f32 v172, v172, v173
    v_mfma_f32_4x4x4_16b_bf16 v[124:127], v[24:25], v[188:189], v[124:127]
    v_mul_f32 v220, v156, v220
    v_mfma_f32_4x4x4_16b_bf16 v[112:115], v[26:27], v[178:179], v[112:115]
    v_and_b32_sdwa v173, s67, v172 dst_sel:DWORD dst_unused:UNUSED_PAD src0_sel:DWORD src1_sel:WORD_1
    v_mfma_f32_4x4x4_16b_bf16 v[116:119], v[26:27], v[182:183], v[116:119]
    v_mul_f32 v221, v157, v221
    v_and_b32 v172, s67, v172
    v_cvt_pk_bf16_f32 v156, v156, v220
    v_cvt_pk_bf16_f32 v157, v157, v221
    ds_read_u16_d16_hi v173, v173 offset:40960
    ds_read_u16_d16_hi v172, v172 offset:40960
    v_mfma_f32_4x4x4_16b_bf16 v[120:123], v[26:27], v[186:187], v[120:123]
    v_cvt_pkrtz_f16_f32 v174, v174, v175
    v_mfma_f32_4x4x4_16b_bf16 v[124:127], v[26:27], v[190:191], v[124:127]
    v_mul_f32 v222, v158, v222
    v_and_b32_sdwa v175, s67, v174 dst_sel:DWORD dst_unused:UNUSED_PAD src0_sel:DWORD src1_sel:WORD_1
    v_mul_f32 v223, v159, v223
    v_and_b32 v174, s67, v174
    v_cvt_pk_bf16_f32 v158, v158, v222
    v_cvt_pk_bf16_f32 v159, v159, v223
    ds_read_u16_d16_hi v175, v175 offset:40960
    ds_read_u16_d16_hi v174, v174 offset:40960
K2_MIDP1C:
    s_waitcnt lgkmcnt(12)
    v_mfma_f32_32x32x16_bf16 v[64:79], v[96:99], v[144:147], v[64:79]
    v_exp_f32 v112, v112
    v_mul_f32 v224, v160, v224
    v_exp_f32 v113, v113
    v_mul_f32 v225, v161, v225
    v_add_f32 v112, 1.0, v112
    v_cvt_pk_bf16_f32 v160, v160, v224
    v_add_f32 v113, 1.0, v113
    v_cvt_pk_bf16_f32 v161, v161, v225
    v_rcp_f32 v112, v112
    v_rcp_f32 v113, v113
    v_mfma_f32_32x32x16_bf16 v[64:79], v[100:103], v[148:151], v[64:79]
    v_cvt_pkrtz_f16_f32 v114, v114, v115
    v_mul_f32 v226, v162, v226
    v_and_b32_sdwa v115, s67, v114 dst_sel:DWORD dst_unused:UNUSED_PAD src0_sel:DWORD src1_sel:WORD_1
    v_mul_f32 v227, v163, v227
    v_and_b32 v114, s67, v114
    v_cvt_pk_bf16_f32 v162, v162, v226
    v_cvt_pk_bf16_f32 v163, v163, v227
    ds_read_u16_d16_hi v115, v115 offset:40960
    ds_read_u16_d16_hi v114, v114 offset:40960
    s_waitcnt lgkmcnt(10)
    v_mfma_f32_32x32x16_bf16 v[128:143], v[40:43], v[12:15], 0
    v_cvt_pkrtz_f16_f32 v116, v116, v117
    v_mul_f32 v228, v164, v228
    v_and_b32_sdwa v117, s67, v116 dst_sel:DWORD dst_unused:UNUSED_PAD src0_sel:DWORD src1_sel:WORD_1
    v_mul_f32 v229, v165, v229
    v_and_b32 v116, s67, v116
    v_cvt_pk_bf16_f32 v164, v164, v228
    v_cvt_pk_bf16_f32 v165, v165, v229
    ds_read_u16_d16_hi v117, v117 offset:40960
    ds_read_u16_d16_hi v116, v116 offset:40960
    v_mfma_f32_32x32x16_bf16 v[128:143], v[32:35], v[20:23], v[128:143]
    v_cvt_pkrtz_f16_f32 v118, v118, v119
    v_mul_f32 v230, v166, v230
    v_and_b32_sdwa v119, s67, v118 dst_sel:DWORD dst_unused:UNUSED_PAD src0_sel:DWORD src1_sel:WORD_1
    v_mul_f32 v231, v167, v231
    v_and_b32 v118, s67, v118
    v_cvt_pk_bf16_f32 v166, v166, v230
    v_cvt_pk_bf16_f32 v167, v167, v231
    ds_read_u16_d16_hi v119, v119 offset:40960
    ds_read_u16_d16_hi v118, v118 offset:40960
    s_waitcnt lgkmcnt(10)
    v_mfma_f32_32x32x16_bf16 v[64:79], v[104:107], v[152:155], v[64:79]
    v_cvt_pkrtz_f16_f32 v120, v120, v121
    v_mul_f32 v232, v168, v232
    v_and_b32_sdwa v121, s67, v120 dst_sel:DWORD dst_unused:UNUSED_PAD src0_sel:DWORD src1_sel:WORD_1
    v_mul_f32 v233, v169, v233
    v_and_b32 v120, s67, v120
    v_cvt_pk_bf16_f32 v168, v168, v232
    v_cvt_pk_bf16_f32 v169, v169, v233
    ds_read_u16_d16_hi v121, v121 offset:40960
    ds_read_u16_d16_hi v120, v120 offset:40960
    v_mfma_f32_32x32x16_bf16 v[64:79], v[108:111], v[156:159], v[64:79]
    v_cvt_pkrtz_f16_f32 v122, v122, v123
    v_mul_f32 v234, v170, v234
    v_and_b32_sdwa v123, s67, v122 dst_sel:DWORD dst_unused:UNUSED_PAD src0_sel:DWORD src1_sel:WORD_1
    v_mul_f32 v235, v171, v235
    s_waitcnt vmcnt(6)
    v_mfma_f32_4x4x4_16b_bf16 v[128:131], v[24:25], v[192:193], v[128:131]
    v_and_b32 v122, s67, v122
    v_mfma_f32_4x4x4_16b_bf16 v[132:135], v[24:25], v[196:197], v[132:135]
    v_cvt_pk_bf16_f32 v170, v170, v234
    v_cvt_pk_bf16_f32 v171, v171, v235
    ds_read_u16_d16_hi v123, v123 offset:40960
    ds_read_u16_d16_hi v122, v122 offset:40960
    s_waitcnt lgkmcnt(10)
    v_mfma_f32_4x4x4_16b_bf16 v[136:139], v[24:25], v[200:201], v[136:139]
    v_cvt_pkrtz_f16_f32 v124, v124, v125
    v_mfma_f32_4x4x4_16b_bf16 v[140:143], v[24:25], v[204:205], v[140:143]
    v_mul_f32 v236, v172, v236
    v_mfma_f32_4x4x4_16b_bf16 v[128:131], v[26:27], v[194:195], v[128:131]
    v_and_b32_sdwa v125, s67, v124 dst_sel:DWORD dst_unused:UNUSED_PAD src0_sel:DWORD src1_sel:WORD_1
    v_mfma_f32_4x4x4_16b_bf16 v[132:135], v[26:27], v[198:199], v[132:135]
    v_mul_f32 v237, v173, v237
    v_and_b32 v124, s67, v124
    v_cvt_pk_bf16_f32 v172, v172, v236
    v_cvt_pk_bf16_f32 v173, v173, v237
    ds_read_u16_d16_hi v125, v125 offset:40960
    ds_read_u16_d16_hi v124, v124 offset:40960
    v_mfma_f32_4x4x4_16b_bf16 v[136:139], v[26:27], v[202:203], v[136:139]
    v_cvt_pkrtz_f16_f32 v126, v126, v127
    v_mfma_f32_4x4x4_16b_bf16 v[140:143], v[26:27], v[206:207], v[140:143]
    v_mul_f32 v238, v174, v238
    v_and_b32_sdwa v127, s67, v126 dst_sel:DWORD dst_unused:UNUSED_PAD src0_sel:DWORD src1_sel:WORD_1
    v_mul_f32 v239, v175, v239
    v_and_b32 v126, s67, v126
    v_cvt_pk_bf16_f32 v174, v174, v238
    v_cvt_pk_bf16_f32 v175, v175, v239
    ds_read_u16_d16_hi v127, v127 offset:40960
    ds_read_u16_d16_hi v126, v126 offset:40960
    s_cmp_eq_u32 s20, 2
    s_cbranch_scc1 K2_LAST0C2
    s_cmp_eq_u32 s20, 4
    s_cbranch_scc1 K2_LAST0C4
    s_cmp_eq_u32 s20, 6
    s_cbranch_scc1 K2_LAST0C6
K2_LAST0C8:
    s_waitcnt lgkmcnt(12)
    v_mfma_f32_32x32x16_bf16 v[80:95], v[96:99], v[160:163], v[80:95]
    v_exp_f32 v128, v128
    v_mul_f32 v176, v112, v176
    v_exp_f32 v129, v129
    v_mul_f32 v177, v113, v177
    v_add_f32 v128, 1.0, v128
    v_cvt_pk_bf16_f32 v112, v112, v176
    v_add_f32 v129, 1.0, v129
    v_cvt_pk_bf16_f32 v113, v113, v177
    v_rcp_f32 v128, v128
    v_rcp_f32 v129, v129
    v_mfma_f32_32x32x16_bf16 v[80:95], v[100:103], v[164:167], v[80:95]
    v_cvt_pkrtz_f16_f32 v130, v130, v131
    v_mul_f32 v178, v114, v178
    v_and_b32_sdwa v131, s67, v130 dst_sel:DWORD dst_unused:UNUSED_PAD src0_sel:DWORD src1_sel:WORD_1
    v_mul_f32 v179, v115, v179
    v_and_b32 v130, s67, v130
    v_cvt_pk_bf16_f32 v114, v114, v178
    v_cvt_pk_bf16_f32 v115, v115, v179
    ds_read_u16_d16_hi v131, v131 offset:40960
    ds_read_u16_d16_hi v130, v130 offset:40960
    s_waitcnt lgkmcnt(10)
    v_mfma_f32_32x32x16_bf16 v[80:95], v[104:107], v[168:171], v[80:95]
    v_cvt_pkrtz_f16_f32 v132, v132, v133
    v_mul_f32 v180, v116, v180
    v_and_b32_sdwa v133, s67, v132 dst_sel:DWORD dst_unused:UNUSED_PAD src0_sel:DWORD src1_sel:WORD_1
    v_mul_f32 v181, v117, v181
    v_and_b32 v132, s67, v132
    v_cvt_pk_bf16_f32 v116, v116, v180
    v_cvt_pk_bf16_f32 v117, v117, v181
    ds_read_u16_d16_hi v133, v133 offset:40960
    ds_read_u16_d16_hi v132, v132 offset:40960
    v_mfma_f32_32x32x16_bf16 v[80:95], v[108:111], v[172:175], v[80:95]
    v_cvt_pkrtz_f16_f32 v134, v134, v135
    v_mul_f32 v182, v118, v182
    v_and_b32_sdwa v135, s67, v134 dst_sel:DWORD dst_unused:UNUSED_PAD src0_sel:DWORD src1_sel:WORD_1
    v_mul_f32 v183, v119, v183
    v_and_b32 v134, s67, v134
    v_cvt_pk_bf16_f32 v118, v118, v182
    v_cvt_pk_bf16_f32 v119, v119, v183
    ds_read_u16_d16_hi v135, v135 offset:40960
    ds_read_u16_d16_hi v134, v134 offset:40960
    s_waitcnt lgkmcnt(10)
    v_mfma_f32_32x32x16_bf16 v[96:111], v[32:35], v[28:31], 0
    v_cvt_pkrtz_f16_f32 v136, v136, v137
    v_mul_f32 v184, v120, v184
    v_and_b32_sdwa v137, s67, v136 dst_sel:DWORD dst_unused:UNUSED_PAD src0_sel:DWORD src1_sel:WORD_1
    v_mul_f32 v185, v121, v185
    v_and_b32 v136, s67, v136
    v_cvt_pk_bf16_f32 v120, v120, v184
    v_cvt_pk_bf16_f32 v121, v121, v185
    ds_read_u16_d16_hi v137, v137 offset:40960
    ds_read_u16_d16_hi v136, v136 offset:40960
    v_cvt_pkrtz_f16_f32 v138, v138, v139
    v_mul_f32 v186, v122, v186
    v_and_b32_sdwa v139, s67, v138 dst_sel:DWORD dst_unused:UNUSED_PAD src0_sel:DWORD src1_sel:WORD_1
    v_mul_f32 v187, v123, v187
    v_and_b32 v138, s67, v138
    v_cvt_pk_bf16_f32 v122, v122, v186
    v_cvt_pk_bf16_f32 v123, v123, v187
    ds_read_u16_d16_hi v139, v139 offset:40960
    ds_read_u16_d16_hi v138, v138 offset:40960
    s_waitcnt lgkmcnt(10)
    v_cvt_pkrtz_f16_f32 v140, v140, v141
    v_mul_f32 v188, v124, v188
    v_and_b32_sdwa v141, s67, v140 dst_sel:DWORD dst_unused:UNUSED_PAD src0_sel:DWORD src1_sel:WORD_1
    v_mul_f32 v189, v125, v189
    v_and_b32 v140, s67, v140
    v_cvt_pk_bf16_f32 v124, v124, v188
    v_cvt_pk_bf16_f32 v125, v125, v189
    ds_read_u16_d16_hi v141, v141 offset:40960
    ds_read_u16_d16_hi v140, v140 offset:40960
    v_cvt_pkrtz_f16_f32 v142, v142, v143
    v_mul_f32 v190, v126, v190
    v_and_b32_sdwa v143, s67, v142 dst_sel:DWORD dst_unused:UNUSED_PAD src0_sel:DWORD src1_sel:WORD_1
    v_mul_f32 v191, v127, v191
    v_and_b32 v142, s67, v142
    v_cvt_pk_bf16_f32 v126, v126, v190
    v_cvt_pk_bf16_f32 v127, v127, v191
    ds_read_u16_d16_hi v143, v143 offset:40960
    ds_read_u16_d16_hi v142, v142 offset:40960
    s_waitcnt lgkmcnt(12)
    v_mfma_f32_32x32x16_bf16 v[64:79], v[96:99], v[112:115], v[64:79]
    v_mul_f32 v192, v128, v192
    v_mul_f32 v193, v129, v193
    v_cvt_pk_bf16_f32 v128, v128, v192
    v_cvt_pk_bf16_f32 v129, v129, v193
    v_mfma_f32_32x32x16_bf16 v[64:79], v[100:103], v[116:119], v[64:79]
    v_mul_f32 v194, v130, v194
    v_mul_f32 v195, v131, v195
    v_cvt_pk_bf16_f32 v130, v130, v194
    v_cvt_pk_bf16_f32 v131, v131, v195
    s_waitcnt lgkmcnt(8)
    v_mfma_f32_32x32x16_bf16 v[64:79], v[104:107], v[120:123], v[64:79]
    v_mul_f32 v196, v132, v196
    v_mul_f32 v197, v133, v197
    v_cvt_pk_bf16_f32 v132, v132, v196
    v_cvt_pk_bf16_f32 v133, v133, v197
    v_mfma_f32_32x32x16_bf16 v[64:79], v[108:111], v[124:127], v[64:79]
    v_mul_f32 v198, v134, v198
    v_mul_f32 v199, v135, v199
    v_cvt_pk_bf16_f32 v134, v134, v198
    v_cvt_pk_bf16_f32 v135, v135, v199
    s_waitcnt lgkmcnt(4)
    v_mul_f32 v200, v136, v200
    v_mul_f32 v201, v137, v201
    v_cvt_pk_bf16_f32 v136, v136, v200
    v_cvt_pk_bf16_f32 v137, v137, v201
    v_mul_f32 v202, v138, v202
    v_mul_f32 v203, v139, v203
    v_cvt_pk_bf16_f32 v138, v138, v202
    v_cvt_pk_bf16_f32 v139, v139, v203
    s_waitcnt lgkmcnt(0)
    v_mul_f32 v204, v140, v204
    v_mul_f32 v205, v141, v205
    v_cvt_pk_bf16_f32 v140, v140, v204
    v_cvt_pk_bf16_f32 v141, v141, v205
    v_mul_f32 v206, v142, v206
    v_mul_f32 v207, v143, v207
    v_cvt_pk_bf16_f32 v142, v142, v206
    v_cvt_pk_bf16_f32 v143, v143, v207
    s_nop 1
    v_mfma_f32_32x32x16_bf16 v[80:95], v[96:99], v[128:131], v[80:95]
    v_mfma_f32_32x32x16_bf16 v[80:95], v[100:103], v[132:135], v[80:95]
    v_mfma_f32_32x32x16_bf16 v[80:95], v[104:107], v[136:139], v[80:95]
    v_mfma_f32_32x32x16_bf16 v[80:95], v[108:111], v[140:143], v[80:95]
K2_DONE:
    s_cmp_lg_u32 s55, 0
    s_cbranch_scc1 K2_ROUND
K2_EPI:
    s_waitcnt vmcnt(0) lgkmcnt(0)
    s_mov_b32 s52, 0x358637bd
    s_mov_b32 s53, 0x358637bd
    v_lshlrev_b32 v112, 16, v246
    v_lshlrev_b32 v118, 16, v240
    v_lshlrev_b32 v113, 16, v247
    v_lshlrev_b32 v119, 16, v241
    v_lshlrev_b32 v114, 16, v248
    v_lshlrev_b32 v120, 16, v242
    v_lshlrev_b32 v115, 16, v249
    v_lshlrev_b32 v121, 16, v243
    v_lshlrev_b32 v116, 16, v250
    v_lshlrev_b32 v122, 16, v244
    v_lshlrev_b32 v117, 16, v251
    v_lshlrev_b32 v123, 16, v245
    v_and_b32 v124, 0xffff0000, v246
    v_and_b32 v130, 0xffff0000, v240
    v_and_b32 v125, 0xffff0000, v247
    v_and_b32 v131, 0xffff0000, v241
    v_and_b32 v126, 0xffff0000, v248
    v_and_b32 v132, 0xffff0000, v242
    v_and_b32 v127, 0xffff0000, v249
    v_and_b32 v133, 0xffff0000, v243
    v_and_b32 v128, 0xffff0000, v250
    v_and_b32 v134, 0xffff0000, v244
    v_and_b32 v129, 0xffff0000, v251
    v_and_b32 v135, 0xffff0000, v245
    v_pk_add_f32 v[64:65], v[64:65], s[52:53]
    v_pk_add_f32 v[66:67], v[66:67], s[52:53]
    v_pk_add_f32 v[68:69], v[68:69], s[52:53]
    v_rcp_f32 v64, v64
    v_rcp_f32 v65, v65
    v_rcp_f32 v66, v66
    v_rcp_f32 v67, v67
    v_rcp_f32 v68, v68
    v_rcp_f32 v69, v69
    v_pk_add_f32 v[80:81], v[80:81], s[52:53]
    v_pk_add_f32 v[82:83], v[82:83], s[52:53]
    v_pk_add_f32 v[84:85], v[84:85], s[52:53]
    v_rcp_f32 v80, v80
    v_rcp_f32 v81, v81
    v_rcp_f32 v82, v82
    v_rcp_f32 v83, v83
    v_rcp_f32 v84, v84
    v_rcp_f32 v85, v85
    v_pk_fma_f32 v[112:113], v[72:73], v[64:65], v[112:113]
    v_pk_fma_f32 v[114:115], v[74:75], v[66:67], v[114:115]
    v_pk_fma_f32 v[116:117], v[76:77], v[68:69], v[116:117]
    v_pk_fma_f32 v[124:125], v[88:89], v[80:81], v[124:125]
    v_pk_fma_f32 v[126:127], v[90:91], v[82:83], v[126:127]
    v_pk_fma_f32 v[128:129], v[92:93], v[84:85], v[128:129]
    v_max_f32 v112, 0, v112
    v_max_f32 v113, 0, v113
    v_max_f32 v114, 0, v114
    v_max_f32 v115, 0, v115
    v_max_f32 v116, 0, v116
    v_max_f32 v117, 0, v117
    v_max_f32 v124, 0, v124
    v_max_f32 v125, 0, v125
    v_max_f32 v126, 0, v126
    v_max_f32 v127, 0, v127
    v_max_f32 v128, 0, v128
    v_max_f32 v129, 0, v129
    v_pk_add_f32 v[112:113], v[112:113], v[118:119]
    v_pk_add_f32 v[114:115], v[114:115], v[120:121]
    v_pk_add_f32 v[116:117], v[116:117], v[122:123]
    v_pk_add_f32 v[124:125], v[124:125], v[130:131]
    v_pk_add_f32 v[126:127], v[126:127], v[132:133]
    v_pk_add_f32 v[128:129], v[128:129], v[134:135]
    v_lshl_or_b32 v104, v1, 27, v6
    s_cmp_gt_u32 s80, 5100
    s_cbranch_scc1 K2_PLAIN
    v_cvt_pk_bf16_f32 v96, v112, v124
    buffer_store_dword v96, v6, s[44:47], 0 offen offset:0 sc1
    v_cvt_pk_bf16_f32 v97, v113, v125
    buffer_store_dword v97, v6, s[44:47], 0 offen offset:256 sc1
    v_cvt_pk_bf16_f32 v98, v114, v126
    buffer_store_dword v98, v6, s[44:47], 0 offen offset:512 sc1
    v_cvt_pk_bf16_f32 v99, v115, v127
    buffer_store_dword v99, v6, s[44:47], 0 offen offset:768 sc1
    v_cvt_pk_bf16_f32 v100, v116, v128
    buffer_store_dword v100, v104, s[44:47], 0 offen offset:2048 sc1
    v_cvt_pk_bf16_f32 v101, v117, v129
    buffer_store_dword v101, v104, s[44:47], 0 offen offset:2304 sc1
    s_branch K2_OUT
K2_PLAIN:
    v_cvt_pk_bf16_f32 v96, v112, v124
    buffer_store_dword v96, v6, s[44:47], 0 offen offset:0
    v_cvt_pk_bf16_f32 v97, v113, v125
    buffer_store_dword v97, v6, s[44:47], 0 offen offset:256
    v_cvt_pk_bf16_f32 v98, v114, v126
    buffer_store_dword v98, v6, s[44:47], 0 offen offset:512
    v_cvt_pk_bf16_f32 v99, v115, v127
    buffer_store_dword v99, v6, s[44:47], 0 offen offset:768
    v_cvt_pk_bf16_f32 v100, v116, v128
    buffer_store_dword v100, v104, s[44:47], 0 offen offset:2048
    v_cvt_pk_bf16_f32 v101, v117, v129
    buffer_store_dword v101, v104, s[44:47], 0 offen offset:2304
K2_OUT:
K2_END:
    s_endpgm
K2_SLOW:
    s_mov_b32 s72, s8
    s_mov_b32 s73, s9
    s_mov_b32 s74, 1280000
    s_mov_b32 s75, 0x20000
    s_mov_b32 s68, s10
    s_mov_b32 s69, s11
    s_mov_b32 s70, 1280000
    s_mov_b32 s71, 0x20000
    s_mov_b32 s55, 1
    s_mov_b32 s66, -10
    s_waitcnt vmcnt(0) lgkmcnt(0)
    s_barrier
    v_mov_b32 v64, 0
    v_mov_b32 v65, 0
    v_mov_b32 v66, 0
    v_mov_b32 v67, 0
    v_mov_b32 v68, 0
    v_mov_b32 v69, 0
    v_mov_b32 v70, 0
    v_mov_b32 v71, 0
    v_mov_b32 v72, 0
    v_mov_b32 v73, 0
    v_mov_b32 v74, 0
    v_mov_b32 v75, 0
    v_mov_b32 v76, 0
    v_mov_b32 v77, 0
    v_mov_b32 v78, 0
    v_mov_b32 v79, 0
    v_mov_b32 v80, 0
    v_mov_b32 v81, 0
    v_mov_b32 v82, 0
    v_mov_b32 v83, 0
    v_mov_b32 v84, 0
    v_mov_b32 v85, 0
    v_mov_b32 v86, 0
    v_mov_b32 v87, 0
    v_mov_b32 v88, 0
    v_mov_b32 v89, 0
    v_mov_b32 v90, 0
    v_mov_b32 v91, 0
    v_mov_b32 v92, 0
    v_mov_b32 v93, 0
    v_mov_b32 v94, 0
    v_mov_b32 v95, 0
    v_and_b32 v160, 31, v0
    v_xor_b32 v2, 16, v1
    v_xor_b32 v3, 4, v160
    v_lshlrev_b32 v3, 2, v3
    v_add_u32 v2, s58, v2
    v_add_u32 v3, s58, v3
    s_mul_i32 s51, s49, 2560
    s_lshl_b32 s52, s50, 7
    s_add_u32 s51, s51, s52
    v_and_b32 v6, 17, v0
    v_lshlrev_b32 v6, 2, v6
    v_bfe_u32 v161, v0, 1, 1
    v_lshl_add_u32 v6, v161, 5, v6
    v_bfe_u32 v161, v0, 2, 2
    v_lshl_add_u32 v6, v161, 3, v6
    v_lshl_add_u32 v6, v253, 2, v6
    v_add_u32 v6, s51, v6
    v_bfe_u32 v7, v0, 1, 5
    v_lshlrev_b32 v7, 2, v7
    v_add_u32 v7, s58, v7
    v_lshlrev_b32 v252, 4, v0
    v_xor_b32 v252, v252, v0
    v_and_b32 v252, 16, v252
    v_lshlrev_b32 v254, 1, v0
    v_xor_b32 v254, v254, v1
    v_and_b32 v254, 16, v254
    v_add_u32 v254, 106496, v254
    s_lshl_b32 s51, s49, 2
    s_add_u32 s51, s51, 288
    v_mov_b32 v255, s51
    s_lshl_b32 s22, s58, 3
    s_add_u32 s22, s22, 106496
    s_mov_b32 s21, 0
    s_mov_b32 s23, 0
    s_mov_b32 s57, s54
    v_bfe_u32 v160, v0, 2, 2
    v_lshrrev_b32 v161, 1, v1
    v_add_u32 v160, v160, v161
    v_mul_u32_u24 v160, 272, v160
    v_bfe_u32 v162, v0, 4, 1
    v_lshl_add_u32 v160, v162, 5, v160
    v_and_b32 v162, 3, v0
    v_lshl_add_u32 v160, v162, 3, v160
    s_mul_i32 s51, s49, 2720
    s_lshl_b32 s52, s50, 7
    s_add_u32 s51, s51, s52
    v_add_u32 v160, s51, v160
    v_mul_u32_u24 v161, 136, v161
    v_and_b32 v162, 127, v6
    v_add3_u32 v161, v162, s51, v161
    ds_read_b64_tr_b16 v[16:17], v160 offset:14848
    ds_read_b64_tr_b16 v[18:19], v160 offset:15936
    ds_read_b64_tr_b16 v[20:21], v160 offset:14912
    ds_read_b64_tr_b16 v[22:23], v160 offset:16000
    ds_read_b32 v246, v161 offset:27904
    ds_read_b32 v247, v161 offset:28176
    ds_read_b32 v248, v161 offset:28448
    ds_read_b32 v249, v161 offset:28720
    ds_read_b32 v250, v161 offset:30080
    ds_read_b32 v251, v161 offset:30352
K2_ROUND:
    s_cmp_ge_u32 s56, 800
    s_cbranch_scc1 K2_EPI
    s_mul_i32 s51, s56, 400
    s_add_u32 s56, s56, 1
    v_add_u32 v110, s51, v0
    v_lshlrev_b32 v160, 2, v110
    buffer_load_dword v208, v160, s[68:71], 0 offen
    buffer_load_dword v209, v160, s[72:75], 0 offen
    v_lshlrev_b32 v110, 5, v110
    v_and_b32 v160, 63, v0
    v_lshlrev_b32 v160, 3, v160
    v_mov_b32 v164, 0
    v_mov_b32 v165, 0
    s_waitcnt lgkmcnt(0)
    s_barrier
    ds_write_b64 v160, v[164:165] offset:0
    v_mov_b32 v163, 4
    s_waitcnt vmcnt(0) lgkmcnt(0)
    s_barrier
    v_mul_u32_u24 v210, 53687, v208
    v_add_u32 v210, 52500, v210
    v_lshrrev_b32 v210, 21, v210
    v_mul_u32_u24 v160, 625, v210
    v_lshrrev_b32 v160, 4, v160
    v_sub_u32 v208, v208, v160
    v_mul_u32_u24 v160, 26, v208
    v_lshrrev_b32 v160, 8, v160
    v_mad_i32_i24 v208, v160, s66, v208
    v_lshl_or_b32 v208, v160, 30, v208
    v_cmp_eq_u32 vcc, s2, v210
    v_lshl_or_b32 v208, v209, 16, v208
    v_and_b32_sdwa v224, s63, v208 dst_sel:DWORD dst_unused:UNUSED_PAD src0_sel:DWORD src1_sel:BYTE_3
    s_mov_b64 s[78:79], vcc
    v_cmp_gt_u32 vcc, 400, v0
    s_and_b64 s[78:79], s[78:79], vcc
    s_mov_b64 exec, s[78:79]
    ds_add_rtn_u32 v112, v224, v163 offset:0
    s_mov_b64 exec, -1
    s_waitcnt lgkmcnt(0)
    s_barrier
    v_and_b32 v160, 63, v0
    v_lshlrev_b32 v161, 2, v160
    ds_read_b32 v96, v161 offset:0
    v_lshrrev_b32 v160, 4, v160
    v_mul_u32_u24 v160, 1664, v160
    v_and_b32 v162, 31, v0
    v_lshlrev_b32 v162, 2, v162
    v_mov_b32 v164, 0xfffffe
    s_waitcnt lgkmcnt(0)
    v_sub_u32 v160, v160, v96
    v_add_u32_dpp v96, v96, v96 row_shr:1 row_mask:0xf bank_mask:0xf bound_ctrl:0
    s_nop 1
    v_add_u32_dpp v96, v96, v96 row_shr:2 row_mask:0xf bank_mask:0xf bound_ctrl:0
    s_nop 1
    v_add_u32_dpp v96, v96, v96 row_shr:4 row_mask:0xf bank_mask:0xf bound_ctrl:0
    s_nop 1
    v_add_u32_dpp v96, v96, v96 row_shr:8 row_mask:0xf bank_mask:0xf bound_ctrl:0
    s_nop 1
    v_add_u32 v160, v160, v96
    v_cmp_lt_u32 vcc, 1664, v96
    ds_write2st64_b32 v161, v160, v96 offset0:2 offset1:3
    v_readlane_b32 s16, v96, 15
    v_readlane_b32 s17, v96, 31
    v_readlane_b32 s18, v96, 47
    v_readlane_b32 s19, v96, 63
    s_or_b32 s17, s17, 1
    s_or_b32 s18, s18, 2
    s_or_b32 s19, s19, 3
    s_bitcmp1_b32 s49, 0
    s_cselect_b32 s16, s17, s16
    s_cselect_b32 s18, s19, s18
    s_bitcmp1_b32 s49, 1
    s_cselect_b32 s51, s18, s16
    s_and_b32 s49, s51, 3
    s_andn2_b32 s51, s51, 3
    s_mul_i32 s58, s49, 1664
    s_add_u32 s54, s51, 127
    s_lshr_b32 s54, s54, 7
    s_add_u32 s20, s51, 124
    s_bfe_u32 s20, s20, 0x20005
    s_lshl_b32 s20, s20, 1
    s_add_u32 s20, s20, 2
    s_add_u32 s51, s51, s58
    v_add_u32 v162, s51, v162
    s_lshl_b32 s52, s54, 7
    s_add_u32 s52, s52, s58
    v_lshlrev_b32 v163, 3, v162
    v_and_b32 v163, 128, v163
    v_cmpx_gt_u32 vcc, s52, v162
    ds_write2st64_b32 v162, v163, v164 offset0:6 offset1:32
    s_mov_b64 exec, -1
    s_mov_b64 exec, s[78:79]
    ds_read_b32 v128, v224 offset:512
    s_waitcnt lgkmcnt(0)
    v_add_u32 v128, v128, v112
    v_bfe_u32 v160, v208, 16, 14
    v_lshlrev_b32 v161, 3, v128
    v_mad_u32_u16 v162, v208, 2, v110
    v_and_b32 v161, 128, v161
    v_mad_u32_u24 v160, v160, s64, v161
    ds_write2st64_b32 v128, v160, v162 offset0:6 offset1:32
    s_mov_b64 exec, -1
    v_and_b32 v160, 31, v0
    v_xor_b32 v2, 16, v1
    v_xor_b32 v3, 4, v160
    v_lshlrev_b32 v3, 2, v3
    v_add_u32 v2, s58, v2
    v_add_u32 v3, s58, v3
    s_mul_i32 s51, s49, 2560
    s_lshl_b32 s52, s50, 7
    s_add_u32 s51, s51, s52
    v_and_b32 v6, 17, v0
    v_lshlrev_b32 v6, 2, v6
    v_bfe_u32 v161, v0, 1, 1
    v_lshl_add_u32 v6, v161, 5, v6
    v_bfe_u32 v161, v0, 2, 2
    v_lshl_add_u32 v6, v161, 3, v6
    v_lshl_add_u32 v6, v253, 2, v6
    v_add_u32 v6, s51, v6
    v_bfe_u32 v7, v0, 1, 5
    v_lshlrev_b32 v7, 2, v7
    v_add_u32 v7, s58, v7
    v_lshlrev_b32 v252, 4, v0
    v_xor_b32 v252, v252, v0
    v_and_b32 v252, 16, v252
    v_lshlrev_b32 v254, 1, v0
    v_xor_b32 v254, v254, v1
    v_and_b32 v254, 16, v254
    v_add_u32 v254, 106496, v254
    s_lshl_b32 s51, s49, 2
    s_add_u32 s51, s51, 288
    v_mov_b32 v255, s51
    s_lshl_b32 s22, s58, 3
    s_add_u32 s22, s22, 106496
    s_mov_b32 s21, 0
    s_mov_b32 s23, 0
    s_mov_b32 s57, s54
    s_waitcnt lgkmcnt(0)
    s_barrier
    s_cmp_eq_u32 s50, 0
    s_cbranch_scc1 K2_REFILLP
    s_branch K2_REFILLC
K2_CODE_END:
.section .rodata,"a"
.p2align 6
.amdhsa_kernel k1_kernel
  .amdhsa_next_free_vgpr 240
  .amdhsa_next_free_sgpr 102
  .amdhsa_accum_offset 240
  .amdhsa_group_segment_fixed_size 0
  .amdhsa_kernarg_size 96
  .amdhsa_user_sgpr_count 2
  .amdhsa_user_sgpr_kernarg_segment_ptr 1
  .amdhsa_system_sgpr_workgroup_id_x 1
.end_amdhsa_kernel
.p2align 6
.amdhsa_kernel k2_kernel
  .amdhsa_next_free_vgpr 256
  .amdhsa_next_free_sgpr 102
  .amdhsa_accum_offset 256
  .amdhsa_group_segment_fixed_size 0
  .amdhsa_kernarg_size 96
  .amdhsa_user_sgpr_count 2
  .amdhsa_user_sgpr_kernarg_segment_ptr 1
  .amdhsa_system_sgpr_workgroup_id_x 1
.end_amdhsa_kernel
```
